```python
import torch

def _softmax(x, axis=-1):
    return torch.softmax(x, dim=axis)

def _gelu(x):
    return torch.nn.functional.gelu(x, approximate='tanh')

def _silu(x):
    return torch.nn.functional.silu(x)

def _sigmoid(x):
    return torch.sigmoid(x)

def _layernorm(x, axis=-1, eps=1e-05):
    m = x.mean(dim=axis, keepdim=True)
    v = x.var(dim=axis, keepdim=True, unbiased=False)
    return (x - m) / torch.sqrt(v + eps)

def _scatter_add(tgt, idx, src, axis=0):
    return tgt.clone().index_add_(axis, idx, src)

def _segment_sum(src, seg, n):
    out = torch.zeros((n,) + src.shape[1:], dtype=src.dtype)
    return out.index_add_(0, seg, src)

def _pad(x, pw):
    flat = tuple((v for pair in reversed(pw) for v in pair))
    return torch.nn.functional.pad(x, flat)
kernel_name = 'sequential_preLN__ssm_conv_s4d__mixer_gmlp__prompt'

def setup_inputs():

    _w = lambda a: (lambda t: t.to(torch.bfloat16) if t.is_floating_point() else t)(torch.as_tensor(a))

    def _A_setup():
        Bsz, L, D, N = (1, 2048, 640, 192)
        return {'u': _w((lambda *s: torch.randn(*s, dtype=torch.bfloat16) * 0.05)(Bsz, L, D)), 'log_A_real': _w((lambda *s: torch.randn(*s, dtype=torch.bfloat16) * 6.4)(D, N) * 0.5), 'A_imag': _w((lambda *s: torch.randn(*s, dtype=torch.bfloat16) * 0.05)(D, N) * 3.14), 'C_real': _w((lambda *s: torch.randn(*s, dtype=torch.bfloat16) * 0.05)(D, N) / N ** 0.5), 'C_imag': _w((lambda *s: torch.randn(*s, dtype=torch.bfloat16) * 0.05)(D, N) / N ** 0.5), 'log_dt': _w((lambda *s: torch.randn(*s, dtype=torch.bfloat16) * 0.05)(D) * 0.5 - 4.0), 'D_skip': _w((lambda *s: torch.randn(*s, dtype=torch.bfloat16) * 0.05)(D))}
    _A_in = _A_setup()

    def _B_setup():
        B, S, D, F = (1, 2048, 640, 1536)
        Fh = F // 2
        return {'x': _w((lambda *s: torch.randn(*s, dtype=torch.bfloat16) * 0.05)(B, S, D)), 'w_in': _w((lambda *s: torch.randn(*s, dtype=torch.bfloat16) * 0.4)(D, 2 * Fh)), 'w_sp': _w(0.01 * (lambda *s: torch.randn(*s, dtype=torch.bfloat16) * 0.4)(S, S)), 'b_sp': _w(1.0 + 0.01 * (lambda *s: torch.randn(*s, dtype=torch.bfloat16) * 0.05)(S)), 'w_out': _w((lambda *s: torch.randn(*s, dtype=torch.bfloat16) * 0.05)(Fh, D))}
    _B_in = _B_setup()
    return {'A_u': _A_in['u'], 'A_log_A_real': _A_in['log_A_real'], 'A_A_imag': _A_in['A_imag'], 'A_C_real': _A_in['C_real'], 'A_C_imag': _A_in['C_imag'], 'A_log_dt': _A_in['log_dt'], 'A_D_skip': _A_in['D_skip'], 'B_x': _B_in['x'], 'B_w_in': _B_in['w_in'], 'B_w_sp': _B_in['w_sp'], 'B_b_sp': _B_in['b_sp'], 'B_w_out': _B_in['w_out']}

def reference(A_u, A_log_A_real, A_A_imag, A_C_real, A_C_imag, A_log_dt, A_D_skip, B_x, B_w_in, B_w_sp, B_b_sp, B_w_out):

    def _A_ref(u, log_A_real, A_imag, C_real, C_imag, log_dt, D_skip):
        L = u.shape[1]
        dt = torch.exp(log_dt)
        A = -torch.exp(log_A_real) + 1j * A_imag
        C = (C_real + 1j * C_imag) * dt[:, None]
        pos = (lambda x, dt: x.to(dt))(torch.arange(L), log_dt.dtype)
        P = torch.exp((A * dt[:, None])[:, :, None] * pos[None, None, :])
        K = 2.0 * torch.einsum('dn,dnl->dl', C, P).real
        L2 = 2 * L
        u_t = (lambda x, *d: x.permute(*d))(u, 0, 2, 1)
        Kf = (lambda x, *a, **k: torch.fft.rfft(x.float(), *a, **k))(K, L2)
        Uf = (lambda x, *a, **k: torch.fft.rfft(x.float(), *a, **k))(u_t, L2)
        y = (lambda x, *a, **k: torch.fft.irfft(x, *a, **k).to(torch.bfloat16))(Uf * Kf[None, :, :], L2)[:, :, :L]
        y = (lambda x, *d: x.permute(*d))(y, 0, 2, 1)
        return y + u * D_skip[None, None, :]

    def _B_ref(x, w_in, w_sp, b_sp, w_out):
        B, S, D = x.shape
        F = w_in.shape[-1]
        Fh = F // 2
        z = _gelu(torch.einsum('bsd,df->bsf', x, w_in))
        z1 = z[..., :Fh].clone()
        z2 = _layernorm(z[..., Fh:], axis=-1)
        g = torch.einsum('ts,bsf->btf', w_sp, z2) + b_sp[None, :, None]
        return torch.einsum('bsf,fd->bsd', z1 * g, w_out)
    x = A_u
    h = x + _A_ref(_layernorm(x, axis=-1), A_log_A_real, A_A_imag, A_C_real, A_C_imag, A_log_dt, A_D_skip)
    h2 = h + _B_ref(_layernorm(h, axis=-1), B_w_in, B_w_sp, B_b_sp, B_w_out)
    return h2
```

```asm
; @launch grid=(256,1,1) block=(256,1,1) lds=163840
.amdgcn_target "amdgcn-amd-amdhsa--gfx950"
.text
.globl sequential_preLN__ssm_conv_s4d__mixer_gmlp__prompt_kernel
.p2align 8
.type sequential_preLN__ssm_conv_s4d__mixer_gmlp__prompt_kernel,@function
sequential_preLN__ssm_conv_s4d__mixer_gmlp__prompt_kernel:
s_cmp_ge_u32 s2, 256
s_cbranch_scc1 Lks_end
s_nop 0
s_load_dwordx16 s[44:59], s[0:1], 0
s_load_dwordx2 s[6:7], s[0:1], 112
s_load_dwordx4 s[28:31], s[0:1], 96
s_load_dwordx8 s[20:27], s[0:1], 64
s_memrealtime s[4:5]
s_getpc_b64 s[18:19]
Lks_pc:
s_lshr_b32 s17, s2, 3
s_lshl_b32 s17, s17, 11
v_lshrrev_b32 v2, 4, v0
v_lshl_add_u32 v2, v2, 7, s17
v_min_u32 v2, Lcode_end-Lks_pc-4, v2
global_load_dword v239, v2, s[18:19]
v_lshrrev_b32 v9, 5, v0
v_and_b32 v10, 31, v0
v_lshlrev_b32_e64 v10, 3, v10
v_mul_u32_u24 v50, 1280, v9
s_mul_i32 s3, s2, 10240
v_add3_u32 v50, v50, v10, s3
v_lshrrev_b32 v5, 6, v0
v_and_b32 v1, 63, v0
v_readfirstlane_b32 s16, v5
v_lshlrev_b32 v5, 4, v1
v_and_b32 v7, 15, v1
v_lshrrev_b32 v8, 4, v1
v_mul_u32_u24 v51, 1344, v9
v_add_u32 v51, v51, v10
v_add_u32 v51, 4096, v51
v_lshrrev_b32 v2, 5, v1
v_bfe_u32 v3, v1, 4, 1
v_bfe_u32 v4, v1, 2, 2
v_and_b32_e64 v6, 3, v1
v_lshl_add_u32 v52, v2, 3, v4
v_mul_u32_u24 v52, 1344, v52
v_lshl_add_u32 v52, v3, 5, v52
v_lshl_add_u32 v52, v6, 3, v52
s_mul_i32 s17, s16, 320
s_add_u32 s17, s17, 4096
v_add_u32 v52, s17, v52
v_lshlrev_b32 v53, 9, v3
v_lshl_add_u32 v53, v4, 7, v53
v_lshl_add_u32 v53, v2, 6, v53
v_lshl_add_u32 v53, v6, 4, v53
s_mul_i32 s17, s16, 5120
v_add_u32 v53, s17, v53
v_add_u32 v55, 4096, v53
v_mov_b32 v56, 0
v_mov_b32 v57, 0
v_mov_b32 v58, 0
v_mov_b32 v59, 0
v_mov_b32 v60, 0
v_mov_b32 v61, 0
v_mov_b32 v62, 0
v_mov_b32 v63, 0
v_mov_b32 v64, 0
v_mov_b32 v65, 0
v_mov_b32 v66, 0
v_mov_b32 v67, 0
v_mov_b32 v68, 0
s_lshl_b32 s3, s2, 2
s_add_u32 s3, s3, s16
s_mul_i32 s17, s3, 384
v_lshl_add_u32 v2, v1, 1, s17
s_lshl_b32 s17, s3, 1
v_mov_b32_e64 v3, s17
s_waitcnt lgkmcnt(0)
global_load_dwordx2 v[12:13], v50, s[44:45] offset:0
global_load_dwordx2 v[14:15], v50, s[44:45] offset:256
global_load_dwordx2 v[16:17], v50, s[44:45] offset:512
global_load_dwordx2 v[18:19], v50, s[44:45] offset:768
global_load_dwordx2 v[20:21], v50, s[44:45] offset:1024
s_cmp_lg_u32 s3, 0
s_cbranch_scc1 Lks_nnw1
s_or_b32 s4, s4, 1
v_mov_b32 v4, 0
v_mov_b32 v6, s4
s_mov_b64 exec, 1
global_store_dword v4, v6, s[30:31] sc1
s_mov_b64 exec, -1
Lks_nnw1:
s_cmp_ge_u32 s2, 160
s_cbranch_scc1 Lks_h0
global_load_short_d16_hi v68, v3, s[54:55]
global_load_short_d16_hi v56, v2, s[46:47] offset:0
global_load_short_d16_hi v57, v2, s[48:49] offset:0
global_load_short_d16_hi v58, v2, s[50:51] offset:0
global_load_short_d16_hi v59, v2, s[52:53] offset:0
global_load_short_d16_hi v60, v2, s[46:47] offset:128
global_load_short_d16_hi v61, v2, s[48:49] offset:128
global_load_short_d16_hi v62, v2, s[50:51] offset:128
global_load_short_d16_hi v63, v2, s[52:53] offset:128
global_load_short_d16_hi v64, v2, s[46:47] offset:256
global_load_short_d16_hi v65, v2, s[48:49] offset:256
global_load_short_d16_hi v66, v2, s[50:51] offset:256
global_load_short_d16_hi v67, v2, s[52:53] offset:256
s_lshl_b32 s34, s3, 1
s_and_b32 s34, s34, -4
s_load_dword s35, s[56:57], s34
v_mov_b32 v190, 0
v_mov_b32 v191, 0
s_mov_b32 s8, s6
s_mov_b32 s9, s7
s_mov_b32 s10, 0x1400000
s_mov_b32 s11, 0x20000
s_mov_b32 s12, s22
s_mov_b32 s13, s23
s_mov_b32 s14, 0x800000
s_mov_b32 s15, 0x20000
s_mov_b32 s40, s28
s_mov_b32 s41, s29
s_mov_b32 s42, 0x280000
s_mov_b32 s43, 0x20000
s_mov_b64 s[32:33], s[30:31]
s_mov_b64 s[38:39], s[24:25]
s_and_b32 s17, s2, 7
s_lshr_b32 s17, s17, 1
s_lshl_b32 s17, s17, 3
s_lshr_b32 s18, s2, 5
s_add_u32 s17, s17, s18
s_and_b32 s18, s2, 1
s_lshl_b32 s18, s18, 2
s_lshr_b32 s19, s2, 3
s_and_b32 s19, s19, 3
s_add_u32 s18, s18, s19
s_lshr_b32 s19, s16, 1
s_and_b32 s20, s16, 1
s_lshl_b32 s25, s16, 1
s_add_u32 s26, s16, 2
s_cmp_lt_u32 s16, 2
s_cselect_b32 s22, s25, s26
s_add_u32 s22, s22, 48
s_add_u32 s26, s25, 49
s_sub_u32 s27, s25, 2
s_cmp_lt_u32 s16, 2
s_cselect_b32 s23, s26, s27
s_sub_u32 s27, s25, 1
s_cmp_lt_u32 s16, 2
s_cselect_b32 s24, s16, s27
s_mul_i32 s25, s18, 6
s_add_u32 s22, s22, s25
s_lshl_b32 s57, s22, 6
s_add_u32 s57, s57, 0x980000
s_mul_i32 s22, s22, 20480
s_add_u32 s22, s22, 0xa00000
s_add_u32 s23, s23, s25
s_lshl_b32 s58, s23, 6
s_add_u32 s58, s58, 0x980000
s_mul_i32 s23, s23, 20480
s_add_u32 s23, s23, 0xa00000
s_add_u32 s24, s24, s25
s_lshl_b32 s59, s24, 6
s_add_u32 s59, s59, 0x980000
s_mul_i32 s24, s24, 20480
s_add_u32 s24, s24, 0xa00000
s_lshl_b32 s29, s17, 12
s_add_u32 s29, s29, 0x990000
s_lshl_b32 s27, s18, 9
s_add_u32 s27, s27, s29
s_lshl_b32 s26, s16, 7
s_add_u32 s27, s27, s26
v_lshlrev_b32 v2, 3, v7
v_mov_b32 v10, -1.0
v_mov_b32 v11, -1.0
buffer_store_dwordx2 v[10:11], v2, s[8:11], s27 offen sc1
v_lshrrev_b32 v3, 3, v1
v_and_b32 v4, 7, v1
v_lshl_add_u32 v2, v3, 5, v4
v_lshlrev_b32 v184, 7, v2
v_lshrrev_b32 v6, 1, v3
v_xor_b32 v4, v4, v6
s_lshl_b32 s44, s20, 2
v_xor_b32 v4, s44, v4
v_mul_u32_u24 v3, 20480, v3
v_lshl_add_u32 v183, v4, 4, v3
v_lshlrev_b32 v254, 7, v1
v_and_b32 v2, 31, v1
v_lshlrev_b32_e64 v2, 7, v2
v_add_u32 v255, 8192, v2
s_mul_i32 s46, s16, 3072
s_add_u32 s46, s46, 55296
s_lshl_b32 s47, s2, 7
s_mul_i32 s48, s16, 163840
s_add_u32 s47, s47, s48
s_lshl_b32 s49, s16, 10
s_add_u32 s49, s49, 4096
s_lshl_b32 s48, s16, 10
s_add_u32 s48, s48, 0x9c8000
v_lshlrev_b32 v6, 4, v0
v_mov_b32 v72, 0
v_mov_b32 v73, 0
v_mov_b32 v74, 0
v_mov_b32 v75, 0
ds_write_b128 v6, v[72:75]
v_add_u32 v2, s46, v5
ds_write_b128 v2, v[72:75] offset:0
ds_write_b128 v2, v[72:75] offset:1024
ds_write_b128 v2, v[72:75] offset:2048
s_mul_i32 s55, s16, 4608
s_add_u32 s55, s55, 36864
v_mul_u32_u24 v2, 288, v7
v_lshl_add_u32 v2, v8, 4, v2
v_add_u32 v144, s55, v2
v_lshrrev_b32 v9, 1, v8
v_and_b32 v10, 1, v8
v_lshlrev_b32 v3, 4, v7
v_lshl_add_u32 v2, v9, 8, v3
v_lshl_add_u32 v2, v10, 3, v2
s_add_u32 s44, s46, 1080
v_sub_u32_e64 v145, s44, v2
v_lshl_add_u32 v2, v10, 8, v3
s_add_u32 s44, s46, 552
v_sub_u32 v146, s44, v2
v_lshrrev_b32 v2, 1, v7
v_lshl_add_u32 v2, v10, 4, v2
v_lshlrev_b32 v2, 2, v2
v_and_b32 v3, 1, v7
v_lshlrev_b32 v3, 8, v3
v_sub_u32 v2, v3, v2
s_add_u32 s44, s46, 2396
v_add_u32 v147, s44, v2
v_and_b32 v2, 7, v7
v_lshlrev_b32_e64 v2, 5, v2
v_lshl_add_u32 v2, v8, 3, v2
s_add_u32 s44, s46, 3000
v_sub_u32 v148, s44, v2
v_mov_b32 v149, s46
s_waitcnt vmcnt(14)
s_branch Lks_ln
Lks_h0:
v_mov_b32 v183, 0
v_mov_b32 v184, 0
v_mov_b32 v250, 0
v_mov_b32 v132, 0
v_mov_b32 v133, 0
v_mov_b32 v134, 0
v_mov_b32_e64 v135, 0
s_mov_b64 s[46:47], s[20:21]
s_mov_b64 s[48:49], s[26:27]
s_sub_u32 s44, s2, 160
s_mov_b32 s8, s6
s_mov_b32 s9, s7
s_mov_b32 s10, 0x1400000
s_mov_b32 s11, 0x20000
s_mov_b32 s12, s22
s_mov_b32 s13, s23
s_mov_b32 s14, 0x800000
s_mov_b32 s15, 0x20000
s_mov_b32 s40, s28
s_mov_b32 s41, s29
s_mov_b32 s42, 0x280000
s_mov_b32 s43, 0x20000
s_mov_b64 s[32:33], s[30:31]
s_mov_b64 s[38:39], s[24:25]
s_and_b32 s17, s2, 7
s_lshr_b32 s17, s17, 1
s_lshl_b32 s17, s17, 3
s_lshr_b32 s18, s2, 5
s_add_u32 s17, s17, s18
s_and_b32 s18, s2, 1
s_lshl_b32 s18, s18, 2
s_lshr_b32 s19, s2, 3
s_and_b32 s19, s19, 3
s_add_u32 s18, s18, s19
s_lshr_b32 s19, s16, 1
s_and_b32 s20, s16, 1
s_lshl_b32 s25, s16, 1
s_add_u32 s26, s16, 2
s_cmp_lt_u32 s16, 2
s_cselect_b32 s22, s25, s26
s_add_u32 s22, s22, 48
s_add_u32 s26, s25, 49
s_sub_u32 s27, s25, 2
s_cmp_lt_u32 s16, 2
s_cselect_b32 s23, s26, s27
s_sub_u32 s27, s25, 1
s_cmp_lt_u32 s16, 2
s_cselect_b32 s24, s16, s27
s_mul_i32 s25, s18, 6
s_add_u32 s22, s22, s25
s_lshl_b32 s57, s22, 6
s_add_u32 s57, s57, 0x980000
s_mul_i32 s22, s22, 20480
s_add_u32 s22, s22, 0xa00000
s_add_u32 s23, s23, s25
s_lshl_b32 s58, s23, 6
s_add_u32 s58, s58, 0x980000
s_mul_i32 s23, s23, 20480
s_add_u32 s23, s23, 0xa00000
s_add_u32 s24, s24, s25
s_lshl_b32 s59, s24, 6
s_add_u32 s59, s59, 0x980000
s_mul_i32 s24, s24, 20480
s_add_u32 s24, s24, 0xa00000
s_lshl_b32 s29, s17, 12
s_add_u32 s29, s29, 0x990000
s_lshl_b32 s27, s18, 9
s_add_u32 s27, s27, s29
s_lshl_b32 s26, s16, 7
s_add_u32 s27, s27, s26
v_lshlrev_b32 v2, 3, v7
v_mov_b32 v10, -1.0
v_mov_b32 v11, -1.0
buffer_store_dwordx2 v[10:11], v2, s[8:11], s27 offen sc1
v_lshlrev_b32 v254, 7, v1
v_and_b32 v2, 31, v1
v_lshlrev_b32 v2, 7, v2
v_add_u32 v255, 8192, v2
v_lshrrev_b32 v2, 3, v0
v_and_b32 v3, 7, v0
v_lshlrev_b32 v3, 4, v3
s_and_b32 s45, s44, 3
s_mul_i32 s45, s45, 491520
s_lshr_b32 s27, s44, 2
s_lshl_b32 s27, s27, 7
s_add_u32 s45, s45, s27
v_mul_u32_u24 v4, 3072, v2
v_add3_u32 v190, v4, v3, s45
s_min_u32 s27, s44, 79
s_and_b32 s45, s27, 7
s_mul_i32 s45, s45, 122880
s_lshr_b32 s27, s27, 3
s_lshl_b32 s27, s27, 7
s_add_u32 s45, s45, s27
v_mul_u32_u24 v4, 1280, v2
v_add3_u32 v191, v4, v3, s45
v_mul_u32_u24 v56, 160, v2
v_add_u32_e64 v56, v56, v3
s_waitcnt vmcnt(1)
Lks_ln:
ds_write_b64 v51, v[12:13] offset:10752
ds_write_b64 v51, v[14:15] offset:11008
ds_write_b64 v51, v[16:17] offset:11264
ds_write_b64 v51, v[18:19] offset:11520
ds_write_b64 v51, v[20:21] offset:11776
v_lshlrev_b32 v22, 16, v12
v_and_b32 v23, 0xffff0000, v12
v_lshlrev_b32 v24, 16, v13
v_and_b32 v25, 0xffff0000, v13
v_lshlrev_b32 v26, 16, v14
v_and_b32 v27, 0xffff0000, v14
v_lshlrev_b32 v28, 16, v15
v_and_b32 v29, 0xffff0000, v15
v_lshlrev_b32 v30, 16, v16
v_and_b32 v31, 0xffff0000, v16
v_lshlrev_b32 v32, 16, v17
v_and_b32 v33, 0xffff0000, v17
v_lshlrev_b32 v34, 16, v18
v_and_b32 v35, 0xffff0000, v18
v_lshlrev_b32 v36, 16, v19
v_and_b32 v37, 0xffff0000, v19
v_lshlrev_b32 v38, 16, v20
v_and_b32 v39, 0xffff0000, v20
v_lshlrev_b32 v40, 16, v21
v_and_b32 v41, 0xffff0000, v21
v_pk_add_f32 v[42:43], v[22:23], v[24:25]
v_pk_mul_f32 v[44:45], v[22:23], v[22:23]
v_pk_fma_f32 v[44:45], v[24:25], v[24:25], v[44:45]
v_pk_add_f32 v[42:43], v[42:43], v[26:27]
v_pk_fma_f32 v[44:45], v[26:27], v[26:27], v[44:45]
v_pk_add_f32 v[42:43], v[42:43], v[28:29]
v_pk_fma_f32 v[44:45], v[28:29], v[28:29], v[44:45]
v_pk_add_f32 v[42:43], v[42:43], v[30:31]
v_pk_fma_f32 v[44:45], v[30:31], v[30:31], v[44:45]
v_pk_add_f32 v[42:43], v[42:43], v[32:33]
v_pk_fma_f32 v[44:45], v[32:33], v[32:33], v[44:45]
v_pk_add_f32 v[42:43], v[42:43], v[34:35]
v_pk_fma_f32 v[44:45], v[34:35], v[34:35], v[44:45]
v_pk_add_f32 v[42:43], v[42:43], v[36:37]
v_pk_fma_f32 v[44:45], v[36:37], v[36:37], v[44:45]
v_pk_add_f32 v[42:43], v[42:43], v[38:39]
v_pk_fma_f32 v[44:45], v[38:39], v[38:39], v[44:45]
v_pk_add_f32 v[42:43], v[42:43], v[40:41]
v_pk_fma_f32 v[44:45], v[40:41], v[40:41], v[44:45]
v_add_f32 v42, v42, v43
v_add_f32 v44, v44, v45
v_mov_b32 v47, 0x3acccccd
v_add_f32_dpp v42, v42, v42 row_ror:8 row_mask:0xf bank_mask:0xf
v_add_f32_dpp v44, v44, v44 row_ror:8 row_mask:0xf bank_mask:0xf
s_nop 0
v_add_f32_dpp v42, v42, v42 row_ror:4 row_mask:0xf bank_mask:0xf
v_add_f32_dpp v44, v44, v44 row_ror:4 row_mask:0xf bank_mask:0xf
s_nop 0
v_add_f32_dpp v42, v42, v42 row_ror:2 row_mask:0xf bank_mask:0xf
v_add_f32_dpp v44, v44, v44 row_ror:2 row_mask:0xf bank_mask:0xf
s_nop 0
v_add_f32_dpp v42, v42, v42 row_ror:1 row_mask:0xf bank_mask:0xf
v_add_f32_dpp v44, v44, v44 row_ror:1 row_mask:0xf bank_mask:0xf
v_mov_b32 v43, v42
v_mov_b32 v45, v44
s_nop 0
v_permlane16_swap_b32 v42, v43
v_permlane16_swap_b32 v44, v45
v_add_f32 v42, v42, v43
v_add_f32 v44, v44, v45
v_mul_f32 v42, v47, v42
v_mul_f32 v43, v42, v42
v_fma_f32 v44, v44, v47, -v43
v_max_f32 v44, 0, v44
v_cvt_pk_bf16_f32 v46, v42, v44
v_lshlrev_b32 v42, 16, v46
v_pk_add_f32 v[22:23], v[22:23], v[42:43] op_sel_hi:[1,0] neg_lo:[0,1] neg_hi:[0,1]
v_and_b32 v44, 0xffff0000, v46
v_cvt_pk_bf16_f32 v23, v22, v23
v_lshlrev_b32_e64 v22, 16, v23
v_and_b32 v23, 0xffff0000, v23
v_pk_add_f32 v[24:25], v[24:25], v[42:43] op_sel_hi:[1,0] neg_lo:[0,1] neg_hi:[0,1]
v_add_f32 v44, 0x3727c5ac, v44
v_cvt_pk_bf16_f32 v25, v24, v25
v_lshlrev_b32_e64 v24, 16, v25
v_and_b32 v25, 0xffff0000, v25
v_pk_add_f32 v[26:27], v[26:27], v[42:43] op_sel_hi:[1,0] neg_lo:[0,1] neg_hi:[0,1]
v_cvt_pk_bf16_f32 v44, v44, v44
v_cvt_pk_bf16_f32 v27, v26, v27
v_lshlrev_b32_e64 v26, 16, v27
v_and_b32 v27, 0xffff0000, v27
v_pk_add_f32 v[28:29], v[28:29], v[42:43] op_sel_hi:[1,0] neg_lo:[0,1] neg_hi:[0,1]
v_and_b32 v44, 0xffff0000, v44
v_cvt_pk_bf16_f32 v29, v28, v29
v_lshlrev_b32_e64 v28, 16, v29
v_and_b32 v29, 0xffff0000, v29
v_pk_add_f32 v[30:31], v[30:31], v[42:43] op_sel_hi:[1,0] neg_lo:[0,1] neg_hi:[0,1]
v_sqrt_f32 v44, v44
v_cvt_pk_bf16_f32 v31, v30, v31
v_lshlrev_b32 v30, 16, v31
v_and_b32 v31, 0xffff0000, v31
v_pk_add_f32 v[32:33], v[32:33], v[42:43] op_sel_hi:[1,0] neg_lo:[0,1] neg_hi:[0,1]
v_cvt_pk_bf16_f32 v44, v44, v44
v_cvt_pk_bf16_f32 v33, v32, v33
v_lshlrev_b32_e64 v32, 16, v33
v_and_b32 v33, 0xffff0000, v33
v_pk_add_f32 v[34:35], v[34:35], v[42:43] op_sel_hi:[1,0] neg_lo:[0,1] neg_hi:[0,1]
v_and_b32 v44, 0xffff0000, v44
v_cvt_pk_bf16_f32 v35, v34, v35
v_lshlrev_b32_e64 v34, 16, v35
v_and_b32 v35, 0xffff0000, v35
v_pk_add_f32 v[36:37], v[36:37], v[42:43] op_sel_hi:[1,0] neg_lo:[0,1] neg_hi:[0,1]
v_rcp_f32 v44, v44
v_cvt_pk_bf16_f32 v37, v36, v37
v_lshlrev_b32 v36, 16, v37
v_and_b32 v37, 0xffff0000, v37
v_pk_add_f32 v[38:39], v[38:39], v[42:43] op_sel_hi:[1,0] neg_lo:[0,1] neg_hi:[0,1]
v_cvt_pk_bf16_f32 v39, v38, v39
v_lshlrev_b32_e64 v38, 16, v39
v_and_b32 v39, 0xffff0000, v39
v_pk_add_f32 v[40:41], v[40:41], v[42:43] op_sel_hi:[1,0] neg_lo:[0,1] neg_hi:[0,1]
v_cvt_pk_bf16_f32 v41, v40, v41
v_lshlrev_b32 v40, 16, v41
v_and_b32 v41, 0xffff0000, v41
v_mov_b32 v2, 0
global_load_dword v54, v2, s[32:33] sc1
v_pk_mul_f32 v[22:23], v[22:23], v[44:45] op_sel_hi:[1,0]
v_cvt_pk_bf16_f32 v12, v22, v23
v_pk_mul_f32 v[24:25], v[24:25], v[44:45] op_sel_hi:[1,0]
v_cvt_pk_bf16_f32 v13, v24, v25
v_pk_mul_f32 v[26:27], v[26:27], v[44:45] op_sel_hi:[1,0]
v_cvt_pk_bf16_f32 v14, v26, v27
v_pk_mul_f32 v[28:29], v[28:29], v[44:45] op_sel_hi:[1,0]
v_cvt_pk_bf16_f32 v15, v28, v29
v_pk_mul_f32 v[30:31], v[30:31], v[44:45] op_sel_hi:[1,0]
v_cvt_pk_bf16_f32 v16, v30, v31
v_pk_mul_f32 v[32:33], v[32:33], v[44:45] op_sel_hi:[1,0]
v_cvt_pk_bf16_f32 v17, v32, v33
v_pk_mul_f32 v[34:35], v[34:35], v[44:45] op_sel_hi:[1,0]
v_cvt_pk_bf16_f32 v18, v34, v35
v_pk_mul_f32 v[36:37], v[36:37], v[44:45] op_sel_hi:[1,0]
v_cvt_pk_bf16_f32 v19, v36, v37
v_pk_mul_f32 v[38:39], v[38:39], v[44:45] op_sel_hi:[1,0]
v_cvt_pk_bf16_f32 v20, v38, v39
v_pk_mul_f32 v[40:41], v[40:41], v[44:45] op_sel_hi:[1,0]
v_cvt_pk_bf16_f32 v21, v40, v41
ds_write_b64 v51, v[12:13] offset:0
ds_write_b64 v51, v[14:15] offset:256
ds_write_b64 v51, v[16:17] offset:512
ds_write_b64 v51, v[18:19] offset:768
ds_write_b64 v51, v[20:21] offset:1024
s_mul_i32 s30, s2, 20480
s_waitcnt lgkmcnt(0)
s_barrier
ds_read_b64_tr_b16 v[24:25], v52 offset:0
ds_read_b64_tr_b16 v[26:27], v52 offset:5376
ds_read_b64_tr_b16 v[28:29], v52 offset:64
ds_read_b64_tr_b16 v[30:31], v52 offset:5440
ds_read_b64_tr_b16 v[32:33], v52 offset:128
ds_read_b64_tr_b16 v[34:35], v52 offset:5504
ds_read_b64_tr_b16 v[36:37], v52 offset:192
ds_read_b64_tr_b16 v[38:39], v52 offset:5568
ds_read_b64_tr_b16 v[40:41], v52 offset:256
ds_read_b64_tr_b16 v[42:43], v52 offset:5632
s_waitcnt lgkmcnt(8)
buffer_store_dwordx4 v[24:27], v53, s[8:11], s30 offen offset:0 sc1
s_waitcnt lgkmcnt(6)
buffer_store_dwordx4 v[28:31], v53, s[8:11], s30 offen offset:1024 sc1
s_waitcnt lgkmcnt(4)
buffer_store_dwordx4 v[32:35], v53, s[8:11], s30 offen offset:2048 sc1
s_waitcnt lgkmcnt(2)
buffer_store_dwordx4 v[36:39], v53, s[8:11], s30 offen offset:3072 sc1
s_waitcnt lgkmcnt(0)
buffer_store_dwordx4 v[40:43], v55, s[8:11], s30 offen sc1
s_lshl_b32 s30, s2, 7
s_add_u32 s30, s30, 0x9c8000
s_cmp_ge_u32 s2, 160
s_cbranch_scc1 Lks_h1
s_and_b32 s50, s3, 1
s_xor_b32 s50, s50, 1
s_lshl_b32 s50, s50, 4
s_lshl_b32 s51, s35, s50
s_lshr_b32 s51, s51, 16
s_waitcnt vmcnt(7)
v_mov_b32 v185, 0
s_mov_b32 s45, 0
s_mov_b32 m0, s55
v_mul_f32 v68, 0x3fb8aa3b, v68
v_exp_f32 v68, v68
s_nop 0
v_cvt_pk_bf16_f32 v68, v68, v68
v_and_b32 v68, 0xffff0000, v68
v_add_f32 v69, v68, v68
v_mov_b32 v120, 0
v_mov_b32 v121, 0
v_mov_b32 v122, 0
v_mov_b32 v123, 0
v_mov_b32 v124, 0
v_mov_b32 v125, 0
v_mov_b32 v126, 0
v_mov_b32 v127, 0
v_mov_b32 v128, 0
v_mov_b32 v129, 0
v_mov_b32 v130, 0
v_mov_b32 v131, 0
s_mov_b32 s44, 0
s_mov_b64 vcc, 0
s_mov_b32 s54, s26
s_mov_b32 s56, s28
v_mul_f32 v12, 0x3fb8aa3b, v56
v_mul_f32 v13, v57, v68
v_exp_f32 v12, v12
v_mul_f32 v13, 0x3e22f983, v13
v_mul_f32_e64 v70, v58, v69
v_mul_f32 v71, v59, -v69
v_cvt_pk_bf16_f32 v12, v12, v12
v_and_b32 v12, 0xffff0000, v12
v_mul_f32_e64 v12, v12, v68
v_mul_f32 v15, 0x41000000, v13
v_mul_f32 v17, 0x43000000, v13
v_mul_f32 v12, 0xbfb8aa3b, v12
v_fract_f32 v15, v15
v_fract_f32 v13, v13
v_fract_f32_e64 v17, v17
v_mul_f32 v14, 0x41000000, v12
v_mul_f32 v16, 0x43000000, v12
v_exp_f32 v14, v14
v_cos_f32 v22, v15
v_sin_f32 v23, v15
v_exp_f32 v12, v12
v_cos_f32 v20, v13
v_sin_f32 v21, v13
v_exp_f32 v16, v16
v_cos_f32 v24, v17
v_sin_f32_e64 v25, v17
Lks_kg2:
v_pk_mul_f32 v[22:23], v[22:23], v[14:15] op_sel_hi:[1,0]
v_pk_mul_f32 v[20:21], v[20:21], v[12:13] op_sel_hi:[1,0] neg_hi:[0,1]
v_pk_mul_f32 v[24:25], v[24:25], v[16:17] op_sel_hi:[1,0] neg_hi:[0,1]
v_mov_b32 v36, 0x3f80
v_cvt_pk_bf16_f32 v37, v22, v23
v_pk_mul_f32 v[26:27], v[22:23], v[22:23] op_sel:[0,0] op_sel_hi:[1,0]
v_pk_fma_f32 v[32:33], v[22:23], v[22:23], v[26:27] op_sel:[1,1,0] op_sel_hi:[0,1,1] neg_lo:[1,0,0]
v_cvt_pk_bf16_f32 v38, v32, v33
v_pk_mul_f32 v[28:29], v[32:33], v[22:23] op_sel:[0,0] op_sel_hi:[1,0]
v_pk_fma_f32 v[32:33], v[32:33], v[22:23], v[28:29] op_sel:[1,1,0] op_sel_hi:[0,1,1] neg_lo:[1,0,0]
v_cvt_pk_bf16_f32 v39, v32, v33
ds_write_addtid_b32 v36 offset:0
ds_write_addtid_b32 v37 offset:288
ds_write_addtid_b32 v38 offset:576
ds_write_addtid_b32 v39 offset:864
v_pk_mul_f32 v[30:31], v[32:33], v[22:23] op_sel:[0,0] op_sel_hi:[1,0]
v_pk_fma_f32 v[32:33], v[32:33], v[22:23], v[30:31] op_sel:[1,1,0] op_sel_hi:[0,1,1] neg_lo:[1,0,0]
v_cvt_pk_bf16_f32 v40, v32, v33
v_pk_mul_f32 v[26:27], v[32:33], v[22:23] op_sel:[0,0] op_sel_hi:[1,0]
v_pk_fma_f32 v[32:33], v[32:33], v[22:23], v[26:27] op_sel:[1,1,0] op_sel_hi:[0,1,1] neg_lo:[1,0,0]
v_cvt_pk_bf16_f32 v41, v32, v33
v_pk_mul_f32 v[28:29], v[32:33], v[22:23] op_sel:[0,0] op_sel_hi:[1,0]
v_pk_fma_f32 v[32:33], v[32:33], v[22:23], v[28:29] op_sel:[1,1,0] op_sel_hi:[0,1,1] neg_lo:[1,0,0]
v_cvt_pk_bf16_f32 v42, v32, v33
v_pk_mul_f32 v[30:31], v[32:33], v[22:23] op_sel:[0,0] op_sel_hi:[1,0]
v_pk_fma_f32 v[32:33], v[32:33], v[22:23], v[30:31] op_sel:[1,1,0] op_sel_hi:[0,1,1] neg_lo:[1,0,0]
v_cvt_pk_bf16_f32 v43, v32, v33
ds_write_addtid_b32 v40 offset:1152
ds_write_addtid_b32 v41 offset:1440
ds_write_addtid_b32 v42 offset:1728
ds_write_addtid_b32 v43 offset:2016
v_pk_mul_f32 v[26:27], v[32:33], v[22:23] op_sel:[0,0] op_sel_hi:[1,0]
v_pk_fma_f32 v[32:33], v[32:33], v[22:23], v[26:27] op_sel:[1,1,0] op_sel_hi:[0,1,1] neg_lo:[1,0,0]
v_cvt_pk_bf16_f32 v44, v32, v33
v_pk_mul_f32 v[28:29], v[32:33], v[22:23] op_sel:[0,0] op_sel_hi:[1,0]
v_pk_fma_f32 v[32:33], v[32:33], v[22:23], v[28:29] op_sel:[1,1,0] op_sel_hi:[0,1,1] neg_lo:[1,0,0]
v_cvt_pk_bf16_f32 v45, v32, v33
v_pk_mul_f32 v[30:31], v[32:33], v[22:23] op_sel:[0,0] op_sel_hi:[1,0]
v_pk_fma_f32 v[32:33], v[32:33], v[22:23], v[30:31] op_sel:[1,1,0] op_sel_hi:[0,1,1] neg_lo:[1,0,0]
v_cvt_pk_bf16_f32 v46, v32, v33
v_pk_mul_f32 v[26:27], v[32:33], v[22:23] op_sel:[0,0] op_sel_hi:[1,0]
v_pk_fma_f32 v[32:33], v[32:33], v[22:23], v[26:27] op_sel:[1,1,0] op_sel_hi:[0,1,1] neg_lo:[1,0,0]
v_cvt_pk_bf16_f32 v47, v32, v33
ds_write_addtid_b32 v44 offset:2304
ds_write_addtid_b32 v45 offset:2592
ds_write_addtid_b32 v46 offset:2880
ds_write_addtid_b32 v47 offset:3168
v_pk_mul_f32 v[28:29], v[32:33], v[22:23] op_sel:[0,0] op_sel_hi:[1,0]
v_pk_fma_f32 v[32:33], v[32:33], v[22:23], v[28:29] op_sel:[1,1,0] op_sel_hi:[0,1,1] neg_lo:[1,0,0]
v_cvt_pk_bf16_f32 v48, v32, v33
v_pk_mul_f32 v[30:31], v[32:33], v[22:23] op_sel:[0,0] op_sel_hi:[1,0]
v_pk_fma_f32 v[32:33], v[32:33], v[22:23], v[30:31] op_sel:[1,1,0] op_sel_hi:[0,1,1] neg_lo:[1,0,0]
v_cvt_pk_bf16_f32 v49, v32, v33
v_pk_mul_f32 v[26:27], v[32:33], v[22:23] op_sel:[0,0] op_sel_hi:[1,0]
v_pk_fma_f32 v[32:33], v[32:33], v[22:23], v[26:27] op_sel:[1,1,0] op_sel_hi:[0,1,1] neg_lo:[1,0,0]
v_cvt_pk_bf16_f32 v50, v32, v33
v_pk_mul_f32 v[28:29], v[32:33], v[22:23] op_sel:[0,0] op_sel_hi:[1,0]
v_pk_fma_f32 v[32:33], v[32:33], v[22:23], v[28:29] op_sel:[1,1,0] op_sel_hi:[0,1,1] neg_lo:[1,0,0]
v_cvt_pk_bf16_f32 v51, v32, v33
ds_write_addtid_b32 v48 offset:3456
ds_write_addtid_b32 v49 offset:3744
ds_write_addtid_b32 v50 offset:4032
ds_write_addtid_b32 v51 offset:4320
ds_read_b128 v[88:91], v144 offset:0
ds_read_b128 v[92:95], v144 offset:64
ds_read_b128 v[96:99], v144 offset:128
ds_read_b128 v[100:103], v144 offset:192
v_cvt_pk_bf16_f32 v36, v70, v71
v_pk_mul_f32 v[30:31], v[70:71], v[20:21] op_sel:[0,0] op_sel_hi:[1,0]
v_pk_fma_f32 v[72:73], v[70:71], v[20:21], v[30:31] op_sel:[1,1,0] op_sel_hi:[0,1,1] neg_lo:[1,0,0]
v_cvt_pk_bf16_f32 v37, v72, v73
v_pk_mul_f32 v[26:27], v[72:73], v[20:21] op_sel:[0,0] op_sel_hi:[1,0]
v_pk_fma_f32 v[74:75], v[72:73], v[20:21], v[26:27] op_sel:[1,1,0] op_sel_hi:[0,1,1] neg_lo:[1,0,0]
v_cvt_pk_bf16_f32 v38, v74, v75
v_pk_mul_f32 v[28:29], v[74:75], v[20:21] op_sel:[0,0] op_sel_hi:[1,0]
v_pk_fma_f32 v[76:77], v[74:75], v[20:21], v[28:29] op_sel:[1,1,0] op_sel_hi:[0,1,1] neg_lo:[1,0,0]
v_cvt_pk_bf16_f32 v39, v76, v77
ds_write_addtid_b32 v36 offset:0
ds_write_addtid_b32 v37 offset:288
ds_write_addtid_b32 v38 offset:576
ds_write_addtid_b32 v39 offset:864
v_pk_mul_f32 v[30:31], v[76:77], v[20:21] op_sel:[0,0] op_sel_hi:[1,0]
v_pk_fma_f32 v[78:79], v[76:77], v[20:21], v[30:31] op_sel:[1,1,0] op_sel_hi:[0,1,1] neg_lo:[1,0,0]
v_cvt_pk_bf16_f32 v40, v78, v79
v_pk_mul_f32 v[26:27], v[78:79], v[20:21] op_sel:[0,0] op_sel_hi:[1,0]
v_pk_fma_f32 v[80:81], v[78:79], v[20:21], v[26:27] op_sel:[1,1,0] op_sel_hi:[0,1,1] neg_lo:[1,0,0]
v_cvt_pk_bf16_f32 v41, v80, v81
v_pk_mul_f32 v[28:29], v[80:81], v[20:21] op_sel:[0,0] op_sel_hi:[1,0]
v_pk_fma_f32 v[82:83], v[80:81], v[20:21], v[28:29] op_sel:[1,1,0] op_sel_hi:[0,1,1] neg_lo:[1,0,0]
v_cvt_pk_bf16_f32 v42, v82, v83
v_pk_mul_f32 v[30:31], v[82:83], v[20:21] op_sel:[0,0] op_sel_hi:[1,0]
v_pk_fma_f32 v[84:85], v[82:83], v[20:21], v[30:31] op_sel:[1,1,0] op_sel_hi:[0,1,1] neg_lo:[1,0,0]
v_cvt_pk_bf16_f32 v43, v84, v85
ds_write_addtid_b32 v40 offset:1152
ds_write_addtid_b32 v41 offset:1440
ds_write_addtid_b32 v42 offset:1728
ds_write_addtid_b32 v43 offset:2016
v_pk_mul_f32 v[26:27], v[84:85], v[20:21] op_sel:[0,0] op_sel_hi:[1,0]
v_pk_fma_f32 v[86:87], v[84:85], v[20:21], v[26:27] op_sel:[1,1,0] op_sel_hi:[0,1,1] neg_lo:[1,0,0]
v_pk_mul_f32 v[28:29], v[70:71], v[24:25] op_sel:[0,0] op_sel_hi:[1,0]
v_pk_fma_f32 v[70:71], v[70:71], v[24:25], v[28:29] op_sel:[1,1,0] op_sel_hi:[0,1,1] neg_lo:[1,0,0]
v_cvt_pk_bf16_f32 v44, v70, v71
v_pk_mul_f32 v[30:31], v[72:73], v[24:25] op_sel:[0,0] op_sel_hi:[1,0]
v_pk_fma_f32 v[72:73], v[72:73], v[24:25], v[30:31] op_sel:[1,1,0] op_sel_hi:[0,1,1] neg_lo:[1,0,0]
v_cvt_pk_bf16_f32 v45, v72, v73
v_pk_mul_f32 v[26:27], v[74:75], v[24:25] op_sel:[0,0] op_sel_hi:[1,0]
v_pk_fma_f32 v[74:75], v[74:75], v[24:25], v[26:27] op_sel:[1,1,0] op_sel_hi:[0,1,1] neg_lo:[1,0,0]
v_cvt_pk_bf16_f32 v46, v74, v75
v_pk_mul_f32 v[28:29], v[76:77], v[24:25] op_sel:[0,0] op_sel_hi:[1,0]
v_pk_fma_f32 v[76:77], v[76:77], v[24:25], v[28:29] op_sel:[1,1,0] op_sel_hi:[0,1,1] neg_lo:[1,0,0]
v_cvt_pk_bf16_f32 v47, v76, v77
ds_write_addtid_b32 v44 offset:2304
ds_write_addtid_b32 v45 offset:2592
ds_write_addtid_b32 v46 offset:2880
ds_write_addtid_b32 v47 offset:3168
v_pk_mul_f32 v[30:31], v[78:79], v[24:25] op_sel:[0,0] op_sel_hi:[1,0]
v_pk_fma_f32 v[78:79], v[78:79], v[24:25], v[30:31] op_sel:[1,1,0] op_sel_hi:[0,1,1] neg_lo:[1,0,0]
v_cvt_pk_bf16_f32 v48, v78, v79
v_pk_mul_f32 v[26:27], v[80:81], v[24:25] op_sel:[0,0] op_sel_hi:[1,0]
v_pk_fma_f32 v[80:81], v[80:81], v[24:25], v[26:27] op_sel:[1,1,0] op_sel_hi:[0,1,1] neg_lo:[1,0,0]
v_cvt_pk_bf16_f32 v49, v80, v81
v_pk_mul_f32 v[28:29], v[82:83], v[24:25] op_sel:[0,0] op_sel_hi:[1,0]
v_pk_fma_f32 v[82:83], v[82:83], v[24:25], v[28:29] op_sel:[1,1,0] op_sel_hi:[0,1,1] neg_lo:[1,0,0]
v_cvt_pk_bf16_f32 v50, v82, v83
v_pk_mul_f32 v[30:31], v[84:85], v[24:25] op_sel:[0,0] op_sel_hi:[1,0]
v_pk_fma_f32 v[84:85], v[84:85], v[24:25], v[30:31] op_sel:[1,1,0] op_sel_hi:[0,1,1] neg_lo:[1,0,0]
v_cvt_pk_bf16_f32 v51, v84, v85
ds_write_addtid_b32 v48 offset:3456
ds_write_addtid_b32 v49 offset:3744
ds_write_addtid_b32 v50 offset:4032
ds_write_addtid_b32 v51 offset:4320
ds_read_b128 v[104:107], v144 offset:0
ds_read_b128 v[108:111], v144 offset:64
ds_read_b128 v[112:115], v144 offset:128
ds_read_b128 v[116:119], v144 offset:192
v_pk_mul_f32 v[26:27], v[86:87], v[24:25] op_sel:[0,0] op_sel_hi:[1,0]
v_pk_fma_f32 v[86:87], v[86:87], v[24:25], v[26:27] op_sel:[1,1,0] op_sel_hi:[0,1,1] neg_lo:[1,0,0]
v_pk_mul_f32 v[28:29], v[70:71], v[24:25] op_sel:[0,0] op_sel_hi:[1,0]
v_pk_fma_f32 v[70:71], v[70:71], v[24:25], v[28:29] op_sel:[1,1,0] op_sel_hi:[0,1,1] neg_lo:[1,0,0]
v_pk_mul_f32 v[30:31], v[74:75], v[24:25] op_sel:[0,0] op_sel_hi:[1,0]
v_pk_fma_f32 v[74:75], v[74:75], v[24:25], v[30:31] op_sel:[1,1,0] op_sel_hi:[0,1,1] neg_lo:[1,0,0]
v_cvt_pk_bf16_f32 v36, v74, v75
v_pk_mul_f32 v[26:27], v[78:79], v[24:25] op_sel:[0,0] op_sel_hi:[1,0]
v_pk_fma_f32 v[78:79], v[78:79], v[24:25], v[26:27] op_sel:[1,1,0] op_sel_hi:[0,1,1] neg_lo:[1,0,0]
v_cvt_pk_bf16_f32 v37, v78, v79
v_pk_mul_f32 v[28:29], v[82:83], v[24:25] op_sel:[0,0] op_sel_hi:[1,0]
v_pk_fma_f32 v[82:83], v[82:83], v[24:25], v[28:29] op_sel:[1,1,0] op_sel_hi:[0,1,1] neg_lo:[1,0,0]
v_cvt_pk_bf16_f32 v38, v82, v83
v_pk_mul_f32 v[30:31], v[86:87], v[24:25] op_sel:[0,0] op_sel_hi:[1,0]
v_pk_fma_f32 v[86:87], v[86:87], v[24:25], v[30:31] op_sel:[1,1,0] op_sel_hi:[0,1,1] neg_lo:[1,0,0]
v_cvt_pk_bf16_f32 v39, v86, v87
ds_write_addtid_b32 v36 offset:0
ds_write_addtid_b32 v37 offset:288
ds_write_addtid_b32 v38 offset:576
ds_write_addtid_b32 v39 offset:864
v_pk_mul_f32 v[26:27], v[74:75], v[24:25] op_sel:[0,0] op_sel_hi:[1,0]
v_pk_fma_f32 v[74:75], v[74:75], v[24:25], v[26:27] op_sel:[1,1,0] op_sel_hi:[0,1,1] neg_lo:[1,0,0]
v_cvt_pk_bf16_f32 v40, v74, v75
v_pk_mul_f32 v[28:29], v[78:79], v[24:25] op_sel:[0,0] op_sel_hi:[1,0]
v_pk_fma_f32 v[78:79], v[78:79], v[24:25], v[28:29] op_sel:[1,1,0] op_sel_hi:[0,1,1] neg_lo:[1,0,0]
v_cvt_pk_bf16_f32 v41, v78, v79
v_pk_mul_f32 v[30:31], v[82:83], v[24:25] op_sel:[0,0] op_sel_hi:[1,0]
v_pk_fma_f32 v[82:83], v[82:83], v[24:25], v[30:31] op_sel:[1,1,0] op_sel_hi:[0,1,1] neg_lo:[1,0,0]
v_cvt_pk_bf16_f32 v42, v82, v83
v_pk_mul_f32 v[26:27], v[86:87], v[24:25] op_sel:[0,0] op_sel_hi:[1,0]
v_pk_fma_f32 v[86:87], v[86:87], v[24:25], v[26:27] op_sel:[1,1,0] op_sel_hi:[0,1,1] neg_lo:[1,0,0]
v_cvt_pk_bf16_f32 v43, v86, v87
ds_write_addtid_b32 v40 offset:1152
ds_write_addtid_b32 v41 offset:1440
ds_write_addtid_b32 v42 offset:1728
ds_write_addtid_b32 v43 offset:2016
v_pk_mul_f32 v[28:29], v[78:79], v[24:25] op_sel:[0,0] op_sel_hi:[1,0]
v_pk_fma_f32 v[78:79], v[78:79], v[24:25], v[28:29] op_sel:[1,1,0] op_sel_hi:[0,1,1] neg_lo:[1,0,0]
v_cvt_pk_bf16_f32 v44, v78, v79
v_pk_mul_f32 v[30:31], v[86:87], v[24:25] op_sel:[0,0] op_sel_hi:[1,0]
v_pk_fma_f32 v[86:87], v[86:87], v[24:25], v[30:31] op_sel:[1,1,0] op_sel_hi:[0,1,1] neg_lo:[1,0,0]
v_cvt_pk_bf16_f32 v45, v86, v87
v_pk_mul_f32 v[26:27], v[78:79], v[24:25] op_sel:[0,0] op_sel_hi:[1,0]
v_pk_fma_f32 v[78:79], v[78:79], v[24:25], v[26:27] op_sel:[1,1,0] op_sel_hi:[0,1,1] neg_lo:[1,0,0]
v_cvt_pk_bf16_f32 v46, v78, v79
v_pk_mul_f32 v[28:29], v[86:87], v[24:25] op_sel:[0,0] op_sel_hi:[1,0]
v_pk_fma_f32 v[86:87], v[86:87], v[24:25], v[28:29] op_sel:[1,1,0] op_sel_hi:[0,1,1] neg_lo:[1,0,0]
v_cvt_pk_bf16_f32 v47, v86, v87
ds_write_addtid_b32 v44 offset:2304
ds_write_addtid_b32 v45 offset:2592
ds_write_addtid_b32 v46 offset:2880
ds_write_addtid_b32 v47 offset:3168
v_pk_mul_f32 v[30:31], v[78:79], v[24:25] op_sel:[0,0] op_sel_hi:[1,0]
v_pk_fma_f32 v[78:79], v[78:79], v[24:25], v[30:31] op_sel:[1,1,0] op_sel_hi:[0,1,1] neg_lo:[1,0,0]
v_cvt_pk_bf16_f32 v48, v78, v79
v_pk_mul_f32 v[26:27], v[86:87], v[24:25] op_sel:[0,0] op_sel_hi:[1,0]
v_pk_fma_f32 v[86:87], v[86:87], v[24:25], v[26:27] op_sel:[1,1,0] op_sel_hi:[0,1,1] neg_lo:[1,0,0]
v_cvt_pk_bf16_f32 v49, v86, v87
v_pk_mul_f32 v[28:29], v[78:79], v[24:25] op_sel:[0,0] op_sel_hi:[1,0]
v_pk_fma_f32 v[78:79], v[78:79], v[24:25], v[28:29] op_sel:[1,1,0] op_sel_hi:[0,1,1] neg_lo:[1,0,0]
v_cvt_pk_bf16_f32 v50, v78, v79
v_pk_mul_f32 v[30:31], v[86:87], v[24:25] op_sel:[0,0] op_sel_hi:[1,0]
v_pk_fma_f32 v[86:87], v[86:87], v[24:25], v[30:31] op_sel:[1,1,0] op_sel_hi:[0,1,1] neg_lo:[1,0,0]
v_cvt_pk_bf16_f32 v51, v86, v87
ds_write_addtid_b32 v48 offset:3456
ds_write_addtid_b32 v49 offset:3744
ds_write_addtid_b32 v50 offset:4032
ds_write_addtid_b32 v51 offset:4320
ds_read_b128 v[192:195], v144 offset:0
ds_read_b128 v[196:199], v144 offset:64
ds_read_b128 v[200:203], v144 offset:128
ds_read_b128 v[204:207], v144 offset:192
s_cmp_eq_u32 s44, 0
s_cbranch_scc0 Lks_kb4
s_waitcnt vmcnt(0)
s_mov_b32 s37, 0
Lks_nn5:
v_readfirstlane_b32 s6, v54
s_add_u32 s37, s37, 1
s_cmp_gt_u32 s37, 131072
s_cbranch_scc1 Lks_nok6
s_cmp_lg_u32 s6, 0
s_cbranch_scc1 Lks_nok6
v_mov_b32 v2, 0
global_load_dword v54, v2, s[32:33] sc1
s_waitcnt vmcnt(0)
s_branch Lks_nn5
Lks_nok6:
s_barrier
s_cmp_lg_u32 s16, 0
s_cbranch_scc1 Lks_sig7
v_mov_b32 v2, 0
v_mov_b32 v3, s6
s_mov_b64 exec, 1
buffer_store_dword v3, v2, s[8:11], s30 offen sc1
s_mov_b64 exec, -1
Lks_sig7:
Lks_kb4:
s_cmp_eq_u32 s44, 1
s_cbranch_scc0 Lks_kb9
buffer_load_dword v185, v184, s[8:11], s48 offen sc1
Lks_kb9:
s_cmp_eq_u32 s44, 2
s_cbranch_scc0 Lks_kb11
s_waitcnt vmcnt(0)
s_cmp_lg_u32 s45, 0
s_cbranch_scc1 Lks_uxs12
s_waitcnt vmcnt(0)
v_cmp_ne_u32_e64 vcc, s6, v185
s_cbranch_vccnz Lks_uxr13
s_add_u32 m0, s49, 0
s_add_u32 s27, s47, 0
buffer_load_dwordx4 v183, s[8:11], s27 offen sc1 lds
s_add_u32 m0, s49, 4096
s_add_u32 s27, s47, 655360
buffer_load_dwordx4 v183, s[8:11], s27 offen sc1 lds
s_add_u32 m0, s49, 8192
s_add_u32 s27, s47, 1310720
buffer_load_dwordx4 v183, s[8:11], s27 offen sc1 lds
s_add_u32 m0, s49, 12288
s_add_u32 s27, s47, 1966080
buffer_load_dwordx4 v183, s[8:11], s27 offen sc1 lds
s_add_u32 m0, s49, 16384
s_add_u32 s27, s47, 2621440
buffer_load_dwordx4 v183, s[8:11], s27 offen sc1 lds
s_add_u32 m0, s49, 20480
s_add_u32 s27, s47, 3276800
buffer_load_dwordx4 v183, s[8:11], s27 offen sc1 lds
s_add_u32 m0, s49, 24576
s_add_u32 s27, s47, 3932160
buffer_load_dwordx4 v183, s[8:11], s27 offen sc1 lds
s_add_u32 m0, s49, 28672
s_add_u32 s27, s47, 4587520
buffer_load_dwordx4 v183, s[8:11], s27 offen sc1 lds
s_mov_b32 s45, 1
s_mov_b32 m0, s55
s_branch Lks_uxs12
Lks_uxr13:
s_nop 0
buffer_load_dword v185, v184, s[8:11], s48 offen sc1
Lks_uxs12:
Lks_kb11:
v_cvt_pk_bf16_f32 v44, v70, v71
v_pk_mul_f32 v[26:27], v[86:87], v[24:25] op_sel:[0,0] op_sel_hi:[1,0]
v_pk_fma_f32 v[86:87], v[86:87], v[24:25], v[26:27] op_sel:[1,1,0] op_sel_hi:[0,1,1] neg_lo:[1,0,0]
v_cvt_pk_bf16_f32 v36, v86, v87
v_pk_mul_f32 v[28:29], v[86:87], v[24:25] op_sel:[0,0] op_sel_hi:[1,0]
v_pk_fma_f32 v[86:87], v[86:87], v[24:25], v[28:29] op_sel:[1,1,0] op_sel_hi:[0,1,1] neg_lo:[1,0,0]
v_cvt_pk_bf16_f32 v37, v86, v87
v_pk_mul_f32 v[30:31], v[86:87], v[24:25] op_sel:[0,0] op_sel_hi:[1,0]
v_pk_fma_f32 v[86:87], v[86:87], v[24:25], v[30:31] op_sel:[1,1,0] op_sel_hi:[0,1,1] neg_lo:[1,0,0]
v_cvt_pk_bf16_f32 v38, v86, v87
v_pk_mul_f32 v[26:27], v[86:87], v[24:25] op_sel:[0,0] op_sel_hi:[1,0]
v_pk_fma_f32 v[86:87], v[86:87], v[24:25], v[26:27] op_sel:[1,1,0] op_sel_hi:[0,1,1] neg_lo:[1,0,0]
v_cvt_pk_bf16_f32 v39, v86, v87
ds_write_addtid_b32 v36 offset:0
ds_write_addtid_b32 v37 offset:288
ds_write_addtid_b32 v38 offset:576
ds_write_addtid_b32 v39 offset:864
v_pk_mul_f32 v[28:29], v[86:87], v[24:25] op_sel:[0,0] op_sel_hi:[1,0]
v_pk_fma_f32 v[86:87], v[86:87], v[24:25], v[28:29] op_sel:[1,1,0] op_sel_hi:[0,1,1] neg_lo:[1,0,0]
v_cvt_pk_bf16_f32 v40, v86, v87
v_pk_mul_f32 v[30:31], v[86:87], v[24:25] op_sel:[0,0] op_sel_hi:[1,0]
v_pk_fma_f32 v[86:87], v[86:87], v[24:25], v[30:31] op_sel:[1,1,0] op_sel_hi:[0,1,1] neg_lo:[1,0,0]
v_cvt_pk_bf16_f32 v41, v86, v87
v_pk_mul_f32 v[26:27], v[86:87], v[24:25] op_sel:[0,0] op_sel_hi:[1,0]
v_pk_fma_f32 v[86:87], v[86:87], v[24:25], v[26:27] op_sel:[1,1,0] op_sel_hi:[0,1,1] neg_lo:[1,0,0]
v_cvt_pk_bf16_f32 v42, v86, v87
v_pk_mul_f32 v[28:29], v[86:87], v[24:25] op_sel:[0,0] op_sel_hi:[1,0]
v_pk_fma_f32 v[86:87], v[86:87], v[24:25], v[28:29] op_sel:[1,1,0] op_sel_hi:[0,1,1] neg_lo:[1,0,0]
v_cvt_pk_bf16_f32 v43, v86, v87
ds_write_addtid_b32 v40 offset:1152
ds_write_addtid_b32 v41 offset:1440
ds_write_addtid_b32 v42 offset:1728
ds_write_addtid_b32 v43 offset:2016
ds_write_addtid_b32 v44 offset:2304
ds_read_b128 v[208:211], v144 offset:0
ds_read_b128 v[212:215], v144 offset:64
ds_read_b128 v[216:219], v144 offset:128
ds_read_b128 v[220:223], v144 offset:192
s_add_u32 s54, s26, 8192
s_add_u32 s56, s28, 256
s_cmp_eq_u32 s44, 1
s_cselect_b64 vcc, -1, 0
s_add_u32 s44, s44, 1
s_cmp_lt_u32 s44, 3
s_waitcnt lgkmcnt(13)
v_mfma_f32_16x16x32_bf16 v[120:123], v[104:107], v[88:91], v[120:123]
v_mul_f32 v12, 0x3fb8aa3b, v60
v_mul_f32 v13, v61, v68
v_mfma_f32_16x16x32_bf16 v[120:123], v[108:111], v[92:95], v[120:123]
v_exp_f32 v12, v12
v_mul_f32 v13, 0x3e22f983, v13
v_mfma_f32_16x16x32_bf16 v[120:123], v[112:115], v[96:99], v[120:123]
v_mul_f32_e64 v70, v62, v69
v_mul_f32 v71, v63, -v69
v_mfma_f32_16x16x32_bf16 v[120:123], v[116:119], v[100:103], v[120:123]
v_mov_b32 v60, v64
v_mov_b32 v61, v65
v_mfma_f32_16x16x32_bf16 v[124:127], v[192:195], v[88:91], v[124:127]
v_mov_b32 v62, v66
v_mov_b32 v63, v67
v_mfma_f32_16x16x32_bf16 v[124:127], v[196:199], v[92:95], v[124:127]
v_cvt_pk_bf16_f32 v12, v12, v12
v_and_b32 v12, 0xffff0000, v12
v_mfma_f32_16x16x32_bf16 v[124:127], v[200:203], v[96:99], v[124:127]
v_mul_f32_e64 v12, v12, v68
v_mul_f32 v15, 0x41000000, v13
v_mfma_f32_16x16x32_bf16 v[124:127], v[204:207], v[100:103], v[124:127]
v_mul_f32 v17, 0x43000000, v13
v_mul_f32 v12, 0xbfb8aa3b, v12
s_waitcnt lgkmcnt(0)
v_mfma_f32_16x16x32_bf16 v[128:131], v[88:91], v[208:211], v[128:131]
v_fract_f32 v15, v15
v_fract_f32 v13, v13
v_mfma_f32_16x16x32_bf16 v[128:131], v[92:95], v[212:215], v[128:131]
v_fract_f32 v17, v17
v_mul_f32 v14, 0x41000000, v12
v_mfma_f32_16x16x32_bf16 v[128:131], v[96:99], v[216:219], v[128:131]
v_mul_f32 v16, 0x43000000, v12
v_exp_f32 v14, v14
v_mfma_f32_16x16x32_bf16 v[128:131], v[100:103], v[220:223], v[128:131]
v_cos_f32 v22, v15
v_sin_f32 v23, v15
v_exp_f32 v12, v12
v_cos_f32 v20, v13
v_sin_f32 v21, v13
v_exp_f32 v16, v16
v_cos_f32 v24, v17
v_sin_f32 v25, v17
s_cbranch_scc1 Lks_kg2
Lks_kj14:
v_cvt_pk_bf16_f32 v12, v123, v122
v_cvt_pk_bf16_f32 v13, v121, v120
v_cvt_pk_bf16_f32 v14, v122, v121
v_cvt_pk_bf16_f32 v15, v127, v127
v_cvt_pk_bf16_f32 v16, v127, v126
v_cvt_pk_bf16_f32 v17, v125, v125
v_cvt_pk_bf16_f32 v18, v125, v124
v_cvt_pk_bf16_f32 v19, v126, v125
v_cvt_pk_bf16_f32 v20, v124, v125
v_cvt_pk_bf16_f32 v21, v126, v127
v_cvt_pk_bf16_f32 v22, v130, v131
v_cvt_pk_bf16_f32 v23, v128, v129
v_cvt_pk_bf16_f32 v24, v128, v128
ds_write_b64 v145, v[12:13]
ds_write_b16 v145, v12 offset:1086
ds_write_b32 v145, v14 offset:1088
ds_write_b16_d16_hi v145, v13 offset:1092
v_add_u32 v25, 1088, v146
s_mov_b32 exec_hi, 0
s_nop 0
ds_write_b16 v146, v15 offset:2
ds_write2_b32 v146, v15, v16 offset0:1 offset1:2
ds_write2_b32 v146, v17, v18 offset0:3 offset1:4
ds_write2_b32 v25, v15, v15 offset0:0 offset1:1
ds_write2_b32 v25, v19, v17 offset0:2 offset1:3
ds_write_b16_d16_hi v25, v18 offset:16
s_mov_b32 exec_lo, 0x100
ds_write_b32 v149, v24 offset:572
ds_write_b16 v149, v24 offset:1658
ds_write_b16 v149, v24 offset:1660
s_mov_b32 exec_lo, 0
s_mov_b32 exec_hi, -1
ds_write2_b32 v147, v20, v21 offset0:8 offset1:0
s_mov_b32 exec_lo, 0x00ff00ff
s_mov_b32 exec_hi, 0x00ff00ff
ds_write_b64 v148, v[22:23]
s_mov_b64 exec, -1
s_cmp_lg_u32 s45, 0
s_cbranch_scc1 Lks_uxs15
s_waitcnt vmcnt(0)
v_cmp_ne_u32 vcc, s6, v185
s_cbranch_vccnz Lks_uxr16
s_add_u32 m0, s49, 0
s_add_u32 s27, s47, 0
buffer_load_dwordx4 v183, s[8:11], s27 offen sc1 lds
s_add_u32 m0, s49, 4096
s_add_u32 s27, s47, 655360
buffer_load_dwordx4 v183, s[8:11], s27 offen sc1 lds
s_add_u32 m0, s49, 8192
s_add_u32 s27, s47, 1310720
buffer_load_dwordx4 v183, s[8:11], s27 offen sc1 lds
s_add_u32 m0, s49, 12288
s_add_u32 s27, s47, 1966080
buffer_load_dwordx4 v183, s[8:11], s27 offen sc1 lds
s_add_u32 m0, s49, 16384
s_add_u32 s27, s47, 2621440
buffer_load_dwordx4 v183, s[8:11], s27 offen sc1 lds
s_add_u32 m0, s49, 20480
s_add_u32 s27, s47, 3276800
buffer_load_dwordx4 v183, s[8:11], s27 offen sc1 lds
s_add_u32 m0, s49, 24576
s_add_u32 s27, s47, 3932160
buffer_load_dwordx4 v183, s[8:11], s27 offen sc1 lds
s_add_u32 m0, s49, 28672
s_add_u32 s27, s47, 4587520
buffer_load_dwordx4 v183, s[8:11], s27 offen sc1 lds
s_mov_b32 s45, 1
s_mov_b32 m0, s55
s_branch Lks_uxs15
Lks_uxr16:
buffer_load_dword v185, v184, s[8:11], s48 offen sc1
Lks_uxs15:
v_lshl_add_u32 v9, v7, 1, v8
v_add_u32 v9, 14, v9
v_bfe_u32 v10, v9, 1, 3
v_xor_b32 v10, s16, v10
v_lshlrev_b32 v10, 4, v10
v_lshl_add_u32 v244, v9, 7, v10
v_lshl_add_u32 v9, v7, 1, v8
v_add_u32 v9, 10, v9
v_bfe_u32 v10, v9, 1, 3
v_xor_b32 v10, s16, v10
v_lshlrev_b32_e64 v10, 4, v10
v_lshl_add_u32 v245, v9, 7, v10
v_lshl_add_u32 v9, v7, 1, v8
v_add_u32 v9, 6, v9
v_bfe_u32 v10, v9, 1, 3
v_xor_b32 v10, s16, v10
v_lshlrev_b32_e64 v10, 4, v10
v_lshl_add_u32 v246, v9, 7, v10
v_lshl_add_u32 v9, v7, 1, v8
v_add_u32 v9, 2, v9
v_bfe_u32 v10, v9, 1, 3
v_xor_b32 v10, s16, v10
v_lshlrev_b32_e64 v10, 4, v10
v_lshl_add_u32 v247, v9, 7, v10
v_lshl_add_u32 v9, v7, 1, v8
v_add_u32 v9, 29, v9
v_bfe_u32 v10, v9, 1, 3
v_xor_b32 v10, s16, v10
v_lshlrev_b32 v10, 4, v10
v_lshl_add_u32 v248, v9, 7, v10
v_and_b32 v11, 1, v8
v_lshl_add_u32 v9, v7, 1, v11
v_add_u32 v9, 32, v9
v_bfe_u32 v10, v9, 1, 3
v_xor_b32 v10, s16, v10
v_lshlrev_b32 v10, 4, v10
v_lshl_add_u32 v249, v9, 7, v10
v_lshlrev_b32 v250, 5, v7
v_lshl_add_u32 v250, v11, 9, v250
v_lshrrev_b32 v11, 1, v8
v_lshl_add_u32 v250, v11, 4, v250
v_xor_b32 v11, 1, v11
v_lshlrev_b32 v11, 6, v11
v_xor_b32 v249, v11, v249
s_lshl_b32 s52, s3, 12
s_add_u32 s52, s52, 0x700000
v_lshlrev_b32 v9, 3, v8
v_sub_u32 v9, v9, v7
v_add_u32 v9, 15, v9
v_lshlrev_b32 v9, 1, v9
v_and_b32 v10, 1, v7
v_xor_b32_e64 v10, 1, v10
v_mul_u32_u24 v10, 1086, v10
v_add3_u32 v251, v9, v10, s46
v_add_u32 v252, 1024, v251
v_lshlrev_b32 v9, 2, v8
v_sub_u32 v9, v9, v7
v_add_u32 v9, 15, v9
v_lshlrev_b32 v9, 2, v9
s_add_u32 s53, s46, 2240
v_add_u32 v253, s53, v9
v_mov_b32 v9, s53
ds_read_u16 v11, v9 offset:322
ds_read2_b32 v[44:45], v252 offset0:0 offset1:1
ds_read2_b32 v[46:47], v252 offset0:2 offset1:3
ds_read2_b32 v[76:77], v251 offset0:128 offset1:129
ds_read2_b32 v[78:79], v251 offset0:130 offset1:131
ds_read2_b32 v[108:109], v251 offset0:0 offset1:1
ds_read2_b32 v[110:111], v251 offset0:2 offset1:3
v_lshlrev_b32 v6, 3, v8
v_mov_b32 v9, 0x3800
v_lshlrev_b32 v9, v7, v9
v_lshrrev_b32_e64 v9, v6, v9
v_and_b32 v10, 0xaa, v9
v_and_b32 v9, 0x55, v9
v_lshl_or_b32 v9, v10, 15, v9
v_and_b32 v156, 0x10001, v9
v_mul_u32_u24 v156, 0x3f80, v156
v_lshrrev_b32_e64 v10, 2, v9
v_and_b32 v157, 0x10001, v10
v_mul_u32_u24 v157, 0x3f80, v157
v_lshrrev_b32_e64 v10, 4, v9
v_and_b32 v158, 0x10001, v10
v_mul_u32_u24 v158, 0x3f80, v158
v_lshrrev_b32_e64 v10, 6, v9
ds_read2_b32 v[48:49], v251 offset0:240 offset1:241
ds_read2_b32 v[50:51], v251 offset0:242 offset1:243
ds_read2_b32 v[80:81], v251 offset0:112 offset1:113
ds_read2_b32 v[82:83], v251 offset0:114 offset1:115
ds_read2_b32 v[52:53], v251 offset0:224 offset1:225
ds_read2_b32 v[54:55], v251 offset0:226 offset1:227
v_and_b32 v159, 0x10001, v10
v_mul_u32_u24 v159, 0x3f80, v159
v_mov_b32 v9, 0x7c0
v_lshlrev_b32 v9, v7, v9
v_lshrrev_b32 v9, v6, v9
v_and_b32 v10, 0xaa, v9
v_and_b32 v9, 0x55, v9
v_lshl_or_b32 v9, v10, 15, v9
v_and_b32 v160, 0x10001, v9
v_mul_u32_u24 v160, 0x3f80, v160
v_lshrrev_b32_e64 v10, 2, v9
v_and_b32 v161, 0x10001, v10
v_mul_u32_u24 v161, 0x3f80, v161
v_lshrrev_b32_e64 v10, 4, v9
v_and_b32 v162, 0x10001, v10
v_mul_u32_u24 v162, 0x3f80, v162
ds_read2_b32 v[84:85], v251 offset0:96 offset1:97
ds_read2_b32 v[86:87], v251 offset0:98 offset1:99
ds_read2_b32 v[56:57], v251 offset0:208 offset1:209
ds_read2_b32 v[58:59], v251 offset0:210 offset1:211
ds_read2_b32 v[88:89], v251 offset0:80 offset1:81
ds_read2_b32 v[90:91], v251 offset0:82 offset1:83
v_lshrrev_b32_e64 v10, 6, v9
v_and_b32 v163, 0x10001, v10
v_mul_u32_u24 v163, 0x3f80, v163
v_mov_b32 v9, 0x38
v_lshlrev_b32 v9, v7, v9
v_lshrrev_b32_e64 v9, v6, v9
v_and_b32 v10, 0xaa, v9
v_and_b32 v9, 0x55, v9
v_lshl_or_b32 v9, v10, 15, v9
v_and_b32 v164, 0x10001, v9
v_mul_u32_u24 v164, 0x3f80, v164
v_lshrrev_b32_e64 v10, 2, v9
v_and_b32 v165, 0x10001, v10
v_mul_u32_u24 v165, 0x3f80, v165
v_lshrrev_b32_e64 v10, 4, v9
v_and_b32 v166, 0x10001, v10
ds_read2_b32 v[60:61], v251 offset0:192 offset1:193
ds_read2_b32 v[62:63], v251 offset0:194 offset1:195
ds_read2_b32 v[92:93], v251 offset0:64 offset1:65
ds_read2_b32 v[94:95], v251 offset0:66 offset1:67
ds_read2_b32 v[64:65], v251 offset0:176 offset1:177
ds_read2_b32 v[66:67], v251 offset0:178 offset1:179
v_mul_u32_u24 v166, 0x3f80, v166
v_lshrrev_b32_e64 v10, 6, v9
v_and_b32 v167, 0x10001, v10
v_mul_u32_u24 v167, 0x3f80, v167
v_mov_b32 v9, 0x7c0
v_lshlrev_b32 v9, v7, v9
v_lshrrev_b32 v9, v6, v9
v_and_b32 v10, 0xaa, v9
v_and_b32 v9, 0x55, v9
v_lshl_or_b32 v9, v10, 15, v9
v_and_b32 v168, 0x10001, v9
v_mul_u32_u24 v168, 0x3f80, v168
v_lshrrev_b32_e64 v10, 2, v9
v_and_b32 v169, 0x10001, v10
v_mul_u32_u24 v169, 0x3f80, v169
v_lshrrev_b32_e64 v10, 4, v9
ds_read2_b32 v[96:97], v251 offset0:48 offset1:49
ds_read2_b32 v[98:99], v251 offset0:50 offset1:51
ds_read2_b32 v[68:69], v251 offset0:160 offset1:161
ds_read2_b32 v[70:71], v251 offset0:162 offset1:163
ds_read2_b32 v[100:101], v251 offset0:32 offset1:33
ds_read2_b32 v[102:103], v251 offset0:34 offset1:35
v_and_b32 v170, 0x10001, v10
v_mul_u32_u24 v170, 0x3f80, v170
v_lshrrev_b32_e64 v10, 6, v9
v_and_b32 v171, 0x10001, v10
v_mul_u32_u24 v171, 0x3f80, v171
v_mov_b32 v9, 0xfe0
v_lshlrev_b32 v9, v7, v9
v_lshrrev_b32 v9, v6, v9
v_and_b32 v10, 0xaa, v9
v_and_b32 v9, 0x55, v9
v_lshl_or_b32 v9, v10, 15, v9
v_and_b32 v172, 0x10001, v9
v_mul_u32_u24 v172, 0x3f80, v172
v_lshrrev_b32_e64 v10, 2, v9
v_and_b32 v173, 0x10001, v10
v_mul_u32_u24 v173, 0x3f80, v173
ds_read2_b32 v[72:73], v251 offset0:144 offset1:145
ds_read2_b32 v[74:75], v251 offset0:146 offset1:147
ds_read2_b32 v[104:105], v251 offset0:16 offset1:17
ds_read2_b32 v[106:107], v251 offset0:18 offset1:19
ds_read2_b32 v[112:113], v253 offset0:32 offset1:33
ds_read2_b32 v[114:115], v253 offset0:34 offset1:35
v_lshrrev_b32_e64 v10, 4, v9
v_and_b32 v174, 0x10001, v10
v_mul_u32_u24 v174, 0x3f80, v174
v_lshrrev_b32_e64 v10, 6, v9
v_and_b32 v175, 0x10001, v10
v_mul_u32_u24 v175, 0x3f80, v175
v_mov_b32 v9, 0x1ff0
v_lshlrev_b32 v9, v7, v9
v_lshrrev_b32 v9, v6, v9
v_and_b32 v10, 0xaa, v9
v_and_b32 v9, 0x55, v9
v_lshl_or_b32 v9, v10, 15, v9
v_and_b32 v176, 0x10001, v9
v_mul_u32_u24 v176, 0x3f80, v176
v_lshrrev_b32_e64 v10, 2, v9
v_and_b32 v177, 0x10001, v10
ds_read2_b32 v[124:125], v253 offset0:96 offset1:97
ds_read2_b32 v[126:127], v253 offset0:98 offset1:99
ds_read2_b32 v[116:117], v253 offset0:16 offset1:17
ds_read2_b32 v[118:119], v253 offset0:18 offset1:19
ds_read2_b32 v[128:129], v253 offset0:80 offset1:81
ds_read2_b32 v[130:131], v253 offset0:82 offset1:83
v_mul_u32_u24 v177, 0x3f80, v177
v_lshrrev_b32_e64 v10, 4, v9
v_and_b32 v178, 0x10001, v10
v_mul_u32_u24 v178, 0x3f80, v178
v_lshrrev_b32_e64 v10, 6, v9
v_and_b32 v179, 0x10001, v10
v_mul_u32_u24 v179, 0x3f80, v179
v_mov_b32 v9, 0x3000
v_lshlrev_b32 v9, v7, v9
v_lshrrev_b32 v9, v6, v9
v_and_b32 v10, 0xaa, v9
v_and_b32 v9, 0x55, v9
v_lshl_or_b32 v9, v10, 15, v9
v_and_b32 v152, 0x10001, v9
v_lshrrev_b32_e64 v10, 2, v9
v_and_b32 v153, 0x10001, v10
ds_read2_b32 v[120:121], v253 offset0:0 offset1:1
ds_read2_b32 v[122:123], v253 offset0:2 offset1:3
ds_read2_b32 v[132:133], v253 offset0:64 offset1:65
ds_read2_b32 v[134:135], v253 offset0:66 offset1:67
ds_read2_b32 v[136:137], v253 offset0:176 offset1:177
ds_read2_b32 v[138:139], v253 offset0:178 offset1:179
v_lshrrev_b32 v10, 4, v9
v_and_b32 v154, 0x10001, v10
v_lshrrev_b32 v10, 6, v9
v_and_b32 v155, 0x10001, v10
v_mov_b32 v9, 0x10001
v_lshlrev_b32 v9, v7, v9
v_lshrrev_b32 v9, v6, v9
v_and_b32 v10, 0xaa, v9
v_and_b32 v9, 0x55, v9
v_lshl_or_b32 v9, v10, 15, v9
v_and_b32 v240, 0x10001, v9
v_lshrrev_b32 v10, 2, v9
v_and_b32 v241, 0x10001, v10
v_lshrrev_b32 v10, 4, v9
v_and_b32 v242, 0x10001, v10
v_lshrrev_b32_e64 v10, 6, v9
ds_read2_b32 v[140:141], v253 offset0:160 offset1:161
ds_read2_b32 v[142:143], v253 offset0:162 offset1:163
ds_read2_b32 v[144:145], v253 offset0:144 offset1:145
ds_read2_b32 v[146:147], v253 offset0:146 offset1:147
ds_read2_b32 v[148:149], v253 offset0:128 offset1:129
ds_read2_b32 v[150:151], v253 offset0:130 offset1:131
v_and_b32 v243, 0x10001, v10
v_mov_b32 v2, 0x3f80
v_mov_b32 v3, s51
v_cmp_gt_u32 vcc, 2, v8
s_nop 1
v_cndmask_b32 v2, v3, v2, vcc
v_mul_u32_u24 v240, v2, v240
v_mul_u32_u24 v241, v2, v241
v_mul_u32_u24 v242, v2, v242
v_mul_u32_u24 v243, v2, v243
s_waitcnt lgkmcnt(15)
v_mul_u32_u24 v152, v11, v152
v_mul_u32_u24 v153, v11, v153
v_mul_u32_u24 v154, v11, v154
v_mul_u32_u24 v155, v11, v155
s_cmp_lg_u32 s45, 0
s_cbranch_scc1 Lks_uxd17
s_mov_b32 s37, 0
Lks_poll18:
buffer_load_dword v3, v184, s[8:11], s48 offen sc1
s_add_u32 s37, s37, 1
s_cmp_gt_u32 s37, 131072
s_cbranch_scc1 Lks_pok19
s_waitcnt vmcnt(0)
v_cmp_ne_u32 vcc, s6, v3
s_cbranch_vccnz Lks_poll18
Lks_pok19:
s_waitcnt vmcnt(0)
s_add_u32 m0, s49, 0
s_add_u32 s27, s47, 0
buffer_load_dwordx4 v183, s[8:11], s27 offen sc1 lds
s_add_u32 m0, s49, 4096
s_add_u32 s27, s47, 655360
buffer_load_dwordx4 v183, s[8:11], s27 offen sc1 lds
s_add_u32 m0, s49, 8192
s_add_u32 s27, s47, 1310720
buffer_load_dwordx4 v183, s[8:11], s27 offen sc1 lds
s_add_u32 m0, s49, 12288
s_add_u32 s27, s47, 1966080
buffer_load_dwordx4 v183, s[8:11], s27 offen sc1 lds
s_add_u32 m0, s49, 16384
s_add_u32 s27, s47, 2621440
buffer_load_dwordx4 v183, s[8:11], s27 offen sc1 lds
s_add_u32 m0, s49, 20480
s_add_u32 s27, s47, 3276800
buffer_load_dwordx4 v183, s[8:11], s27 offen sc1 lds
s_add_u32 m0, s49, 24576
s_add_u32 s27, s47, 3932160
buffer_load_dwordx4 v183, s[8:11], s27 offen sc1 lds
s_add_u32 m0, s49, 28672
s_add_u32 s27, s47, 4587520
buffer_load_dwordx4 v183, s[8:11], s27 offen sc1 lds
s_mov_b32 s45, 1
Lks_uxd17:
s_mov_b32 s44, 0x9d0000
s_waitcnt vmcnt(0)
s_waitcnt lgkmcnt(0)
s_barrier
ds_read_b128 v[216:219], v244 offset:2048
ds_read_b128 v[220:223], v248 offset:0
ds_read_b128 v[224:227], v249 offset:0
ds_read_b128 v[228:231], v245 offset:2048
ds_read_b128 v[232:235], v246 offset:2048
ds_read_b128 v[236:239], v247 offset:2048
s_waitcnt lgkmcnt(4)
v_mfma_f32_16x16x32_bf16 v[180:183], v[216:219], v[156:159], 0
v_mfma_f32_16x16x32_bf16 v[184:187], v[216:219], v[160:163], 0
v_mfma_f32_16x16x32_bf16 v[188:191], v[216:219], v[164:167], 0
v_mfma_f32_16x16x32_bf16 v[196:199], v[216:219], v[172:175], 0
v_mfma_f32_16x16x32_bf16 v[192:195], v[220:223], v[168:171], 0
v_mfma_f32_16x16x32_bf16 v[200:203], v[220:223], v[176:179], 0
s_waitcnt lgkmcnt(2)
v_mfma_f32_16x16x32_bf16 v[12:15], v[240:243], v[224:227], 0
v_mfma_f32_16x16x32_bf16 v[12:15], v[44:47], v[216:219], v[12:15]
v_mfma_f32_16x16x32_bf16 v[16:19], v[76:79], v[216:219], 0
v_mfma_f32_16x16x32_bf16 v[20:23], v[108:111], v[216:219], 0
v_mfma_f32_16x16x32_bf16 v[28:31], v[152:155], v[216:219], 0
ds_read_b128 v[216:219], v244 offset:0
ds_read_b128 v[220:223], v245 offset:0
v_mfma_f32_16x16x32_bf16 v[12:15], v[48:51], v[228:231], v[12:15]
ds_read_b128 v[224:227], v246 offset:0
v_mfma_f32_16x16x32_bf16 v[16:19], v[80:83], v[228:231], v[16:19]
ds_read_b128 v[228:231], v247 offset:0
s_waitcnt lgkmcnt(4)
v_mfma_f32_16x16x32_bf16 v[12:15], v[52:55], v[232:235], v[12:15]
v_cvt_pk_bf16_f32 v204, v180, v184
v_mfma_f32_16x16x32_bf16 v[16:19], v[84:87], v[232:235], v[16:19]
ds_read_b128 v[232:235], v244 offset:6144
v_cvt_pk_bf16_f32 v205, v181, v185
v_mfma_f32_16x16x32_bf16 v[12:15], v[56:59], v[236:239], v[12:15]
s_nop 0
v_cvt_pk_bf16_f32 v206, v182, v186
v_cvt_pk_bf16_f32 v207, v183, v187
v_mfma_f32_16x16x32_bf16 v[16:19], v[88:91], v[236:239], v[16:19]
ds_read_b128 v[236:239], v248 offset:4096
v_cvt_pk_bf16_f32 v208, v188, v192
s_waitcnt lgkmcnt(4)
v_mfma_f32_16x16x32_bf16 v[12:15], v[60:63], v[216:219], v[12:15]
v_cvt_pk_bf16_f32 v209, v189, v193
v_mfma_f32_16x16x32_bf16 v[16:19], v[92:95], v[216:219], v[16:19]
ds_read_b128 v[216:219], v249 offset:4096
v_cvt_pk_bf16_f32 v210, v190, v194
v_mfma_f32_16x16x32_bf16 v[12:15], v[64:67], v[220:223], v[12:15]
s_nop 0
v_cvt_pk_bf16_f32 v211, v191, v195
v_cvt_pk_bf16_f32 v212, v196, v200
v_mfma_f32_16x16x32_bf16 v[16:19], v[96:99], v[220:223], v[16:19]
ds_read_b128 v[220:223], v245 offset:6144
v_cvt_pk_bf16_f32 v213, v197, v201
s_waitcnt lgkmcnt(4)
v_mfma_f32_16x16x32_bf16 v[12:15], v[68:71], v[224:227], v[12:15]
v_cvt_pk_bf16_f32 v214, v198, v202
v_mfma_f32_16x16x32_bf16 v[16:19], v[100:103], v[224:227], v[16:19]
ds_read_b128 v[224:227], v246 offset:6144
v_cvt_pk_bf16_f32 v215, v199, v203
v_mfma_f32_16x16x32_bf16 v[12:15], v[72:75], v[228:231], v[12:15]
v_mfma_f32_16x16x32_bf16 v[16:19], v[104:107], v[228:231], v[16:19]
ds_read_b128 v[228:231], v247 offset:6144
v_mfma_f32_16x16x32_bf16 v[20:23], v[204:207], v[112:115], v[20:23]
v_mfma_f32_16x16x32_bf16 v[20:23], v[208:211], v[124:127], v[20:23]
v_mfma_f32_16x16x32_bf16 v[24:27], v[204:207], v[116:119], 0
s_nop 2
v_cvt_pk_bf16_f32 v12, v12, v13
v_mfma_f32_16x16x32_bf16 v[24:27], v[208:211], v[128:131], v[24:27]
v_cvt_pk_bf16_f32 v13, v14, v15
v_mfma_f32_16x16x32_bf16 v[28:31], v[204:207], v[120:123], v[28:31]
v_mfma_f32_16x16x32_bf16 v[28:31], v[208:211], v[132:135], v[28:31]
v_mfma_f32_16x16x32_bf16 v[28:31], v[212:215], v[136:139], v[28:31]
v_mfma_f32_16x16x32_bf16 v[32:35], v[212:215], v[140:143], 0
v_mfma_f32_16x16x32_bf16 v[36:39], v[212:215], v[144:147], 0
v_mfma_f32_16x16x32_bf16 v[40:43], v[212:215], v[148:151], 0
s_waitcnt lgkmcnt(4)
v_mfma_f32_16x16x32_bf16 v[180:183], v[232:235], v[156:159], 0
v_mfma_f32_16x16x32_bf16 v[184:187], v[232:235], v[160:163], 0
v_mfma_f32_16x16x32_bf16 v[188:191], v[232:235], v[164:167], 0
v_mfma_f32_16x16x32_bf16 v[196:199], v[232:235], v[172:175], 0
buffer_load_dword v3, v254, s[8:11], s44 offen sc1
buffer_load_dword v4, v255, s[8:11], s44 offen sc1
v_mfma_f32_16x16x32_bf16 v[192:195], v[236:239], v[168:171], 0
v_mfma_f32_16x16x32_bf16 v[200:203], v[236:239], v[176:179], 0
s_waitcnt lgkmcnt(2)
v_mfma_f32_16x16x32_bf16 v[16:19], v[240:243], v[216:219], v[16:19]
v_mfma_f32_16x16x32_bf16 v[16:19], v[44:47], v[232:235], v[16:19]
v_mfma_f32_16x16x32_bf16 v[20:23], v[76:79], v[232:235], v[20:23]
v_mfma_f32_16x16x32_bf16 v[24:27], v[108:111], v[232:235], v[24:27]
v_mfma_f32_16x16x32_bf16 v[32:35], v[152:155], v[232:235], v[32:35]
ds_read_b128 v[232:235], v244 offset:4096
ds_read_b128 v[236:239], v245 offset:4096
v_mfma_f32_16x16x32_bf16 v[16:19], v[48:51], v[220:223], v[16:19]
ds_read_b128 v[216:219], v246 offset:4096
v_mfma_f32_16x16x32_bf16 v[20:23], v[80:83], v[220:223], v[20:23]
ds_read_b128 v[220:223], v247 offset:4096
s_waitcnt lgkmcnt(4)
v_mfma_f32_16x16x32_bf16 v[16:19], v[52:55], v[224:227], v[16:19]
v_cvt_pk_bf16_f32 v204, v180, v184
v_mfma_f32_16x16x32_bf16 v[20:23], v[84:87], v[224:227], v[20:23]
ds_read_b128 v[224:227], v244 offset:10240
v_cvt_pk_bf16_f32 v205, v181, v185
v_mfma_f32_16x16x32_bf16 v[16:19], v[56:59], v[228:231], v[16:19]
s_nop 0
v_cvt_pk_bf16_f32 v206, v182, v186
v_cvt_pk_bf16_f32 v207, v183, v187
v_mfma_f32_16x16x32_bf16 v[20:23], v[88:91], v[228:231], v[20:23]
ds_read_b128 v[228:231], v248 offset:8192
v_cvt_pk_bf16_f32 v208, v188, v192
s_waitcnt lgkmcnt(4)
v_mfma_f32_16x16x32_bf16 v[16:19], v[60:63], v[232:235], v[16:19]
v_cvt_pk_bf16_f32 v209, v189, v193
v_mfma_f32_16x16x32_bf16 v[20:23], v[92:95], v[232:235], v[20:23]
ds_read_b128 v[232:235], v249 offset:8192
v_cvt_pk_bf16_f32 v210, v190, v194
v_mfma_f32_16x16x32_bf16 v[16:19], v[64:67], v[236:239], v[16:19]
s_nop 0
v_cvt_pk_bf16_f32 v211, v191, v195
v_cvt_pk_bf16_f32 v212, v196, v200
v_mfma_f32_16x16x32_bf16 v[20:23], v[96:99], v[236:239], v[20:23]
ds_read_b128 v[236:239], v245 offset:10240
v_cvt_pk_bf16_f32 v213, v197, v201
s_waitcnt lgkmcnt(4)
v_mfma_f32_16x16x32_bf16 v[16:19], v[68:71], v[216:219], v[16:19]
v_cvt_pk_bf16_f32 v214, v198, v202
v_mfma_f32_16x16x32_bf16 v[20:23], v[100:103], v[216:219], v[20:23]
ds_read_b128 v[216:219], v246 offset:10240
v_cvt_pk_bf16_f32 v215, v199, v203
v_mfma_f32_16x16x32_bf16 v[16:19], v[72:75], v[220:223], v[16:19]
v_mfma_f32_16x16x32_bf16 v[20:23], v[104:107], v[220:223], v[20:23]
ds_read_b128 v[220:223], v247 offset:10240
v_mfma_f32_16x16x32_bf16 v[24:27], v[204:207], v[112:115], v[24:27]
v_mfma_f32_16x16x32_bf16 v[24:27], v[208:211], v[124:127], v[24:27]
v_mfma_f32_16x16x32_bf16 v[28:31], v[204:207], v[116:119], v[28:31]
s_nop 2
v_cvt_pk_bf16_f32 v14, v16, v17
v_mfma_f32_16x16x32_bf16 v[28:31], v[208:211], v[128:131], v[28:31]
v_cvt_pk_bf16_f32 v15, v18, v19
v_mfma_f32_16x16x32_bf16 v[32:35], v[204:207], v[120:123], v[32:35]
v_permlane16_swap_b32 v12, v14
v_permlane16_swap_b32 v13, v15
v_mfma_f32_16x16x32_bf16 v[32:35], v[208:211], v[132:135], v[32:35]
buffer_store_dwordx4 v[12:15], v250, s[8:11], s52 offen offset:0 sc1
v_mfma_f32_16x16x32_bf16 v[32:35], v[212:215], v[136:139], v[32:35]
v_mfma_f32_16x16x32_bf16 v[36:39], v[212:215], v[140:143], v[36:39]
v_mfma_f32_16x16x32_bf16 v[40:43], v[212:215], v[144:147], v[40:43]
s_waitcnt lgkmcnt(4)
v_mfma_f32_16x16x32_bf16 v[180:183], v[224:227], v[156:159], 0
v_mfma_f32_16x16x32_bf16 v[184:187], v[224:227], v[160:163], 0
v_mfma_f32_16x16x32_bf16 v[188:191], v[224:227], v[164:167], 0
v_mfma_f32_16x16x32_bf16 v[196:199], v[224:227], v[172:175], 0
v_mfma_f32_16x16x32_bf16 v[192:195], v[228:231], v[168:171], 0
v_mfma_f32_16x16x32_bf16 v[200:203], v[228:231], v[176:179], 0
s_waitcnt lgkmcnt(2)
v_mfma_f32_16x16x32_bf16 v[20:23], v[240:243], v[232:235], v[20:23]
v_mfma_f32_16x16x32_bf16 v[20:23], v[44:47], v[224:227], v[20:23]
v_mfma_f32_16x16x32_bf16 v[24:27], v[76:79], v[224:227], v[24:27]
v_mfma_f32_16x16x32_bf16 v[28:31], v[108:111], v[224:227], v[28:31]
s_waitcnt vmcnt(1)
v_cmp_ne_u32 vcc, s6, v3
s_cbranch_vccnz Lks_f0q21
v_cmp_ne_u32 vcc, s6, v4
s_cbranch_vccz Lks_f0b20
Lks_f0q21:
s_mov_b32 s37, 0
Lks_poll22:
buffer_load_dword v3, v254, s[8:11], s44 offen sc1
buffer_load_dword v4, v255, s[8:11], s44 offen sc1
s_add_u32 s37, s37, 1
s_cmp_gt_u32 s37, 131072
s_cbranch_scc1 Lks_pok23
s_waitcnt vmcnt(0)
v_cmp_ne_u32 vcc, s6, v3
s_cbranch_vccnz Lks_poll22
v_cmp_ne_u32_e64 vcc, s6, v4
s_cbranch_vccnz Lks_poll22
Lks_pok23:
s_waitcnt vmcnt(0)
Lks_f0b20:
s_add_u32 s27, s22, 0
v_mfma_f32_16x16x32_bf16 v[36:39], v[152:155], v[224:227], v[36:39]
buffer_load_dwordx4 a[0:3], v5, s[8:11], s27 offen offset:0 sc1
v_mfma_f32_16x16x32_bf16 v[20:23], v[48:51], v[236:239], v[20:23]
ds_read_b128 v[224:227], v244 offset:8192
ds_read_b128 v[228:231], v245 offset:8192
v_mfma_f32_16x16x32_bf16 v[24:27], v[80:83], v[236:239], v[24:27]
ds_read_b128 v[232:235], v246 offset:8192
ds_read_b128 v[236:239], v247 offset:8192
s_waitcnt lgkmcnt(4)
v_mfma_f32_16x16x32_bf16 v[20:23], v[52:55], v[216:219], v[20:23]
v_mfma_f32_16x16x32_bf16 v[24:27], v[84:87], v[216:219], v[24:27]
ds_read_b128 v[216:219], v244 offset:14336
v_mfma_f32_16x16x32_bf16 v[20:23], v[56:59], v[220:223], v[20:23]
s_nop 0
buffer_load_dwordx4 a[4:7], v5, s[8:11], s27 offen offset:1024 sc1
v_cvt_pk_bf16_f32 v204, v180, v184
v_mfma_f32_16x16x32_bf16 v[24:27], v[88:91], v[220:223], v[24:27]
ds_read_b128 v[220:223], v248 offset:12288
v_cvt_pk_bf16_f32 v205, v181, v185
s_waitcnt lgkmcnt(4)
v_mfma_f32_16x16x32_bf16 v[20:23], v[60:63], v[224:227], v[20:23]
v_cvt_pk_bf16_f32 v206, v182, v186
v_mfma_f32_16x16x32_bf16 v[24:27], v[92:95], v[224:227], v[24:27]
ds_read_b128 v[224:227], v249 offset:12288
v_cvt_pk_bf16_f32 v207, v183, v187
v_mfma_f32_16x16x32_bf16 v[20:23], v[64:67], v[228:231], v[20:23]
s_nop 0
v_cvt_pk_bf16_f32 v208, v188, v192
v_cvt_pk_bf16_f32 v209, v189, v193
v_mfma_f32_16x16x32_bf16 v[24:27], v[96:99], v[228:231], v[24:27]
buffer_load_dwordx4 a[8:11], v5, s[8:11], s27 offen offset:2048 sc1
ds_read_b128 v[228:231], v245 offset:14336
s_waitcnt lgkmcnt(4)
v_mfma_f32_16x16x32_bf16 v[20:23], v[68:71], v[232:235], v[20:23]
v_cvt_pk_bf16_f32 v210, v190, v194
v_mfma_f32_16x16x32_bf16 v[24:27], v[100:103], v[232:235], v[24:27]
ds_read_b128 v[232:235], v246 offset:14336
v_cvt_pk_bf16_f32 v211, v191, v195
v_mfma_f32_16x16x32_bf16 v[20:23], v[72:75], v[236:239], v[20:23]
v_cvt_pk_bf16_f32 v212, v196, v200
v_cvt_pk_bf16_f32 v213, v197, v201
v_mfma_f32_16x16x32_bf16 v[24:27], v[104:107], v[236:239], v[24:27]
ds_read_b128 v[236:239], v247 offset:14336
v_cvt_pk_bf16_f32 v214, v198, v202
v_cvt_pk_bf16_f32 v215, v199, v203
v_mfma_f32_16x16x32_bf16 v[28:31], v[204:207], v[112:115], v[28:31]
buffer_load_dwordx4 a[12:15], v5, s[8:11], s27 offen offset:3072 sc1
v_mfma_f32_16x16x32_bf16 v[28:31], v[208:211], v[124:127], v[28:31]
v_mfma_f32_16x16x32_bf16 v[32:35], v[204:207], v[116:119], v[32:35]
v_mfma_f32_16x16x32_bf16 v[32:35], v[208:211], v[128:131], v[32:35]
v_cvt_pk_bf16_f32 v20, v20, v21
v_cvt_pk_bf16_f32 v21, v22, v23
v_mfma_f32_16x16x32_bf16 v[36:39], v[204:207], v[120:123], v[36:39]
s_add_u32 s27, s23, 0
v_mfma_f32_16x16x32_bf16 v[36:39], v[208:211], v[132:135], v[36:39]
buffer_load_dwordx4 a[80:83], v5, s[8:11], s27 offen offset:0 sc1
v_mfma_f32_16x16x32_bf16 v[36:39], v[212:215], v[136:139], v[36:39]
v_mfma_f32_16x16x32_bf16 v[40:43], v[212:215], v[140:143], v[40:43]
s_waitcnt lgkmcnt(4)
v_mfma_f32_16x16x32_bf16 v[180:183], v[216:219], v[156:159], 0
v_mfma_f32_16x16x32_bf16 v[184:187], v[216:219], v[160:163], 0
v_mfma_f32_16x16x32_bf16 v[188:191], v[216:219], v[164:167], 0
buffer_load_dwordx4 a[84:87], v5, s[8:11], s27 offen offset:1024 sc1
v_mfma_f32_16x16x32_bf16 v[196:199], v[216:219], v[172:175], 0
v_mfma_f32_16x16x32_bf16 v[192:195], v[220:223], v[168:171], 0
v_mfma_f32_16x16x32_bf16 v[200:203], v[220:223], v[176:179], 0
s_waitcnt lgkmcnt(2)
v_mfma_f32_16x16x32_bf16 v[24:27], v[240:243], v[224:227], v[24:27]
v_mfma_f32_16x16x32_bf16 v[24:27], v[44:47], v[216:219], v[24:27]
buffer_load_dwordx4 a[88:91], v5, s[8:11], s27 offen offset:2048 sc1
v_mfma_f32_16x16x32_bf16 v[28:31], v[76:79], v[216:219], v[28:31]
v_mfma_f32_16x16x32_bf16 v[32:35], v[108:111], v[216:219], v[32:35]
v_mfma_f32_16x16x32_bf16 v[40:43], v[152:155], v[216:219], v[40:43]
ds_read_b128 v[216:219], v244 offset:12288
ds_read_b128 v[220:223], v245 offset:12288
v_mfma_f32_16x16x32_bf16 v[24:27], v[48:51], v[228:231], v[24:27]
ds_read_b128 v[224:227], v246 offset:12288
v_mfma_f32_16x16x32_bf16 v[28:31], v[80:83], v[228:231], v[28:31]
buffer_load_dwordx4 a[92:95], v5, s[8:11], s27 offen offset:3072 sc1
ds_read_b128 v[228:231], v247 offset:12288
s_waitcnt lgkmcnt(4)
v_mfma_f32_16x16x32_bf16 v[24:27], v[52:55], v[232:235], v[24:27]
v_mfma_f32_16x16x32_bf16 v[28:31], v[84:87], v[232:235], v[28:31]
ds_read_b128 v[232:235], v244 offset:18432
v_cvt_pk_bf16_f32 v204, v180, v184
v_mfma_f32_16x16x32_bf16 v[24:27], v[56:59], v[236:239], v[24:27]
s_nop 0
v_cvt_pk_bf16_f32 v205, v181, v185
v_cvt_pk_bf16_f32 v206, v182, v186
v_mfma_f32_16x16x32_bf16 v[28:31], v[88:91], v[236:239], v[28:31]
ds_read_b128 v[236:239], v248 offset:16384
v_cvt_pk_bf16_f32 v207, v183, v187
s_waitcnt lgkmcnt(4)
s_add_u32 s27, s22, 4096
v_mfma_f32_16x16x32_bf16 v[24:27], v[60:63], v[216:219], v[24:27]
buffer_load_dwordx4 a[16:19], v5, s[8:11], s27 offen offset:0 sc1
v_mfma_f32_16x16x32_bf16 v[28:31], v[92:95], v[216:219], v[28:31]
ds_read_b128 v[216:219], v249 offset:16384
v_cvt_pk_bf16_f32 v208, v188, v192
v_mfma_f32_16x16x32_bf16 v[24:27], v[64:67], v[220:223], v[24:27]
s_nop 0
v_cvt_pk_bf16_f32 v209, v189, v193
v_cvt_pk_bf16_f32 v210, v190, v194
v_mfma_f32_16x16x32_bf16 v[28:31], v[96:99], v[220:223], v[28:31]
ds_read_b128 v[220:223], v245 offset:18432
v_cvt_pk_bf16_f32 v211, v191, v195
s_waitcnt lgkmcnt(4)
v_mfma_f32_16x16x32_bf16 v[24:27], v[68:71], v[224:227], v[24:27]
v_cvt_pk_bf16_f32 v212, v196, v200
v_mfma_f32_16x16x32_bf16 v[28:31], v[100:103], v[224:227], v[28:31]
buffer_load_dwordx4 a[20:23], v5, s[8:11], s27 offen offset:1024 sc1
ds_read_b128 v[224:227], v246 offset:18432
v_mfma_f32_16x16x32_bf16 v[24:27], v[72:75], v[228:231], v[24:27]
v_cvt_pk_bf16_f32 v213, v197, v201
v_cvt_pk_bf16_f32 v214, v198, v202
v_mfma_f32_16x16x32_bf16 v[28:31], v[104:107], v[228:231], v[28:31]
ds_read_b128 v[228:231], v247 offset:18432
v_cvt_pk_bf16_f32 v215, v199, v203
v_mfma_f32_16x16x32_bf16 v[32:35], v[204:207], v[112:115], v[32:35]
v_mfma_f32_16x16x32_bf16 v[32:35], v[208:211], v[124:127], v[32:35]
v_mfma_f32_16x16x32_bf16 v[36:39], v[204:207], v[116:119], v[36:39]
buffer_load_dwordx4 a[24:27], v5, s[8:11], s27 offen offset:2048 sc1
v_mfma_f32_16x16x32_bf16 v[36:39], v[208:211], v[128:131], v[36:39]
v_cvt_pk_bf16_f32 v22, v24, v25
v_cvt_pk_bf16_f32 v23, v26, v27
v_mfma_f32_16x16x32_bf16 v[40:43], v[204:207], v[120:123], v[40:43]
v_permlane16_swap_b32 v20, v22
v_mfma_f32_16x16x32_bf16 v[40:43], v[208:211], v[132:135], v[40:43]
v_permlane16_swap_b32 v21, v23
buffer_store_dwordx4 v[20:23], v250, s[8:11], s52 offen offset:1024 sc1
v_mfma_f32_16x16x32_bf16 v[40:43], v[212:215], v[136:139], v[40:43]
s_waitcnt lgkmcnt(4)
v_mfma_f32_16x16x32_bf16 v[180:183], v[232:235], v[156:159], 0
buffer_load_dwordx4 a[28:31], v5, s[8:11], s27 offen offset:3072 sc1
v_mfma_f32_16x16x32_bf16 v[184:187], v[232:235], v[160:163], 0
v_mfma_f32_16x16x32_bf16 v[188:191], v[232:235], v[164:167], 0
v_mfma_f32_16x16x32_bf16 v[192:195], v[236:239], v[168:171], 0
s_waitcnt lgkmcnt(2)
v_mfma_f32_16x16x32_bf16 v[28:31], v[240:243], v[216:219], v[28:31]
s_add_u32 s27, s23, 4096
v_mfma_f32_16x16x32_bf16 v[28:31], v[44:47], v[232:235], v[28:31]
buffer_load_dwordx4 a[96:99], v5, s[8:11], s27 offen offset:0 sc1
v_mfma_f32_16x16x32_bf16 v[32:35], v[76:79], v[232:235], v[32:35]
v_mfma_f32_16x16x32_bf16 v[36:39], v[108:111], v[232:235], v[36:39]
ds_read_b128 v[232:235], v244 offset:16384
ds_read_b128 v[236:239], v245 offset:16384
v_mfma_f32_16x16x32_bf16 v[28:31], v[48:51], v[220:223], v[28:31]
ds_read_b128 v[216:219], v246 offset:16384
v_mfma_f32_16x16x32_bf16 v[32:35], v[80:83], v[220:223], v[32:35]
ds_read_b128 v[220:223], v247 offset:16384
s_waitcnt lgkmcnt(4)
v_mfma_f32_16x16x32_bf16 v[28:31], v[52:55], v[224:227], v[28:31]
buffer_load_dwordx4 a[100:103], v5, s[8:11], s27 offen offset:1024 sc1
v_mfma_f32_16x16x32_bf16 v[32:35], v[84:87], v[224:227], v[32:35]
ds_read_b128 v[224:227], v244 offset:22528
v_cvt_pk_bf16_f32 v204, v180, v184
v_mfma_f32_16x16x32_bf16 v[28:31], v[56:59], v[228:231], v[28:31]
v_cvt_pk_bf16_f32 v205, v181, v185
v_cvt_pk_bf16_f32 v206, v182, v186
v_mfma_f32_16x16x32_bf16 v[32:35], v[88:91], v[228:231], v[32:35]
ds_read_b128 v[228:231], v248 offset:20480
v_cvt_pk_bf16_f32 v207, v183, v187
s_waitcnt lgkmcnt(4)
v_mfma_f32_16x16x32_bf16 v[28:31], v[60:63], v[232:235], v[28:31]
v_cvt_pk_bf16_f32 v208, v188, v192
v_mfma_f32_16x16x32_bf16 v[32:35], v[92:95], v[232:235], v[32:35]
buffer_load_dwordx4 a[104:107], v5, s[8:11], s27 offen offset:2048 sc1
ds_read_b128 v[232:235], v249 offset:20480
v_mfma_f32_16x16x32_bf16 v[28:31], v[64:67], v[236:239], v[28:31]
s_nop 0
v_cvt_pk_bf16_f32 v209, v189, v193
v_cvt_pk_bf16_f32 v210, v190, v194
v_mfma_f32_16x16x32_bf16 v[32:35], v[96:99], v[236:239], v[32:35]
ds_read_b128 v[236:239], v245 offset:22528
v_cvt_pk_bf16_f32 v211, v191, v195
s_waitcnt lgkmcnt(4)
v_mfma_f32_16x16x32_bf16 v[28:31], v[68:71], v[216:219], v[28:31]
v_mfma_f32_16x16x32_bf16 v[32:35], v[100:103], v[216:219], v[32:35]
ds_read_b128 v[216:219], v246 offset:22528
v_mfma_f32_16x16x32_bf16 v[28:31], v[72:75], v[220:223], v[28:31]
buffer_load_dwordx4 a[108:111], v5, s[8:11], s27 offen offset:3072 sc1
v_mfma_f32_16x16x32_bf16 v[32:35], v[104:107], v[220:223], v[32:35]
ds_read_b128 v[220:223], v247 offset:22528
v_mfma_f32_16x16x32_bf16 v[36:39], v[204:207], v[112:115], v[36:39]
v_mfma_f32_16x16x32_bf16 v[36:39], v[208:211], v[124:127], v[36:39]
v_mfma_f32_16x16x32_bf16 v[40:43], v[204:207], v[116:119], v[40:43]
s_nop 1
v_cvt_pk_bf16_f32 v28, v28, v29
s_add_u32 s27, s22, 8192
v_mfma_f32_16x16x32_bf16 v[40:43], v[208:211], v[128:131], v[40:43]
buffer_load_dwordx4 a[32:35], v5, s[8:11], s27 offen offset:0 sc1
s_waitcnt lgkmcnt(4)
v_mfma_f32_16x16x32_bf16 v[180:183], v[224:227], v[156:159], 0
v_cvt_pk_bf16_f32 v29, v30, v31
v_mfma_f32_16x16x32_bf16 v[184:187], v[224:227], v[160:163], 0
v_mfma_f32_16x16x32_bf16 v[188:191], v[224:227], v[164:167], 0
v_mfma_f32_16x16x32_bf16 v[192:195], v[228:231], v[168:171], 0
s_waitcnt lgkmcnt(2)
v_mfma_f32_16x16x32_bf16 v[32:35], v[240:243], v[232:235], v[32:35]
buffer_load_dwordx4 a[36:39], v5, s[8:11], s27 offen offset:1024 sc1
v_mfma_f32_16x16x32_bf16 v[32:35], v[44:47], v[224:227], v[32:35]
v_mfma_f32_16x16x32_bf16 v[36:39], v[76:79], v[224:227], v[36:39]
v_mfma_f32_16x16x32_bf16 v[40:43], v[108:111], v[224:227], v[40:43]
ds_read_b128 v[224:227], v244 offset:20480
ds_read_b128 v[228:231], v245 offset:20480
v_mfma_f32_16x16x32_bf16 v[32:35], v[48:51], v[236:239], v[32:35]
ds_read_b128 v[232:235], v246 offset:20480
v_mfma_f32_16x16x32_bf16 v[36:39], v[80:83], v[236:239], v[36:39]
buffer_load_dwordx4 a[40:43], v5, s[8:11], s27 offen offset:2048 sc1
ds_read_b128 v[236:239], v247 offset:20480
s_waitcnt lgkmcnt(4)
v_mfma_f32_16x16x32_bf16 v[32:35], v[52:55], v[216:219], v[32:35]
v_mfma_f32_16x16x32_bf16 v[36:39], v[84:87], v[216:219], v[36:39]
ds_read_b128 v[216:219], v249 offset:24576
v_cvt_pk_bf16_f32 v204, v180, v184
v_mfma_f32_16x16x32_bf16 v[32:35], v[56:59], v[220:223], v[32:35]
s_nop 0
v_cvt_pk_bf16_f32 v205, v181, v185
v_cvt_pk_bf16_f32 v206, v182, v186
v_mfma_f32_16x16x32_bf16 v[36:39], v[88:91], v[220:223], v[36:39]
ds_read_b128 v[220:223], v244 offset:26624
v_cvt_pk_bf16_f32 v207, v183, v187
s_waitcnt lgkmcnt(4)
v_mfma_f32_16x16x32_bf16 v[32:35], v[60:63], v[224:227], v[32:35]
buffer_load_dwordx4 a[44:47], v5, s[8:11], s27 offen offset:3072 sc1
v_mfma_f32_16x16x32_bf16 v[36:39], v[92:95], v[224:227], v[36:39]
ds_read_b128 v[224:227], v245 offset:26624
v_cvt_pk_bf16_f32 v208, v188, v192
v_mfma_f32_16x16x32_bf16 v[32:35], v[64:67], v[228:231], v[32:35]
s_nop 0
v_cvt_pk_bf16_f32 v209, v189, v193
v_cvt_pk_bf16_f32 v210, v190, v194
v_mfma_f32_16x16x32_bf16 v[36:39], v[96:99], v[228:231], v[36:39]
ds_read_b128 v[228:231], v246 offset:26624
v_cvt_pk_bf16_f32 v211, v191, v195
s_waitcnt lgkmcnt(4)
v_mfma_f32_16x16x32_bf16 v[32:35], v[68:71], v[232:235], v[32:35]
s_add_u32 s27, s23, 8192
v_mfma_f32_16x16x32_bf16 v[36:39], v[100:103], v[232:235], v[36:39]
buffer_load_dwordx4 a[112:115], v5, s[8:11], s27 offen offset:0 sc1
v_mfma_f32_16x16x32_bf16 v[32:35], v[72:75], v[236:239], v[32:35]
ds_read_b128 v[232:235], v247 offset:26624
v_mfma_f32_16x16x32_bf16 v[36:39], v[104:107], v[236:239], v[36:39]
ds_read_b128 v[236:239], v244 offset:24576
v_mfma_f32_16x16x32_bf16 v[40:43], v[204:207], v[112:115], v[40:43]
v_mfma_f32_16x16x32_bf16 v[40:43], v[208:211], v[124:127], v[40:43]
s_waitcnt lgkmcnt(4)
v_mfma_f32_16x16x32_bf16 v[36:39], v[240:243], v[216:219], v[36:39]
buffer_load_dwordx4 a[116:119], v5, s[8:11], s27 offen offset:1024 sc1
v_mfma_f32_16x16x32_bf16 v[36:39], v[44:47], v[220:223], v[36:39]
ds_read_b128 v[216:219], v245 offset:24576
v_mfma_f32_16x16x32_bf16 v[40:43], v[76:79], v[220:223], v[40:43]
ds_read_b128 v[220:223], v246 offset:24576
v_cvt_pk_bf16_f32 v30, v32, v33
s_waitcnt lgkmcnt(4)
v_mfma_f32_16x16x32_bf16 v[36:39], v[48:51], v[224:227], v[36:39]
v_cvt_pk_bf16_f32 v31, v34, v35
v_mfma_f32_16x16x32_bf16 v[40:43], v[80:83], v[224:227], v[40:43]
ds_read_b128 v[224:227], v247 offset:24576
v_mfma_f32_16x16x32_bf16 v[36:39], v[52:55], v[228:231], v[36:39]
buffer_load_dwordx4 a[120:123], v5, s[8:11], s27 offen offset:2048 sc1
v_permlane16_swap_b32 v28, v30
v_mfma_f32_16x16x32_bf16 v[40:43], v[84:87], v[228:231], v[40:43]
ds_read_b128 v[228:231], v249 offset:28672
v_permlane16_swap_b32 v29, v31
s_waitcnt lgkmcnt(4)
v_mfma_f32_16x16x32_bf16 v[36:39], v[56:59], v[232:235], v[36:39]
buffer_store_dwordx4 v[28:31], v250, s[8:11], s52 offen offset:2048 sc1
v_mfma_f32_16x16x32_bf16 v[40:43], v[88:91], v[232:235], v[40:43]
ds_read_b128 v[232:235], v244 offset:30720
v_mfma_f32_16x16x32_bf16 v[36:39], v[60:63], v[236:239], v[36:39]
v_mfma_f32_16x16x32_bf16 v[40:43], v[92:95], v[236:239], v[40:43]
buffer_load_dwordx4 a[124:127], v5, s[8:11], s27 offen offset:3072 sc1
ds_read_b128 v[236:239], v245 offset:30720
s_waitcnt lgkmcnt(4)
v_mfma_f32_16x16x32_bf16 v[36:39], v[64:67], v[216:219], v[36:39]
v_mfma_f32_16x16x32_bf16 v[40:43], v[96:99], v[216:219], v[40:43]
ds_read_b128 v[216:219], v246 offset:30720
v_mfma_f32_16x16x32_bf16 v[36:39], v[68:71], v[220:223], v[36:39]
v_mfma_f32_16x16x32_bf16 v[40:43], v[100:103], v[220:223], v[40:43]
ds_read_b128 v[220:223], v247 offset:30720
s_waitcnt lgkmcnt(4)
v_mfma_f32_16x16x32_bf16 v[36:39], v[72:75], v[224:227], v[36:39]
v_mfma_f32_16x16x32_bf16 v[40:43], v[104:107], v[224:227], v[40:43]
ds_read_b128 v[224:227], v244 offset:28672
v_mfma_f32_16x16x32_bf16 v[40:43], v[240:243], v[228:231], v[40:43]
ds_read_b128 v[228:231], v245 offset:28672
s_waitcnt lgkmcnt(4)
v_mfma_f32_16x16x32_bf16 v[40:43], v[44:47], v[232:235], v[40:43]
ds_read_b128 v[232:235], v246 offset:28672
v_mfma_f32_16x16x32_bf16 v[40:43], v[48:51], v[236:239], v[40:43]
ds_read_b128 v[236:239], v247 offset:28672
s_waitcnt lgkmcnt(4)
v_mfma_f32_16x16x32_bf16 v[40:43], v[52:55], v[216:219], v[40:43]
v_mfma_f32_16x16x32_bf16 v[40:43], v[56:59], v[220:223], v[40:43]
s_waitcnt lgkmcnt(2)
v_mfma_f32_16x16x32_bf16 v[40:43], v[60:63], v[224:227], v[40:43]
v_cvt_pk_bf16_f32 v36, v36, v37
v_mfma_f32_16x16x32_bf16 v[40:43], v[64:67], v[228:231], v[40:43]
v_cvt_pk_bf16_f32 v37, v38, v39
s_waitcnt lgkmcnt(1)
v_mfma_f32_16x16x32_bf16 v[40:43], v[68:71], v[232:235], v[40:43]
s_waitcnt lgkmcnt(0)
v_mfma_f32_16x16x32_bf16 v[40:43], v[72:75], v[236:239], v[40:43]
s_nop 7
v_cvt_pk_bf16_f32 v38, v40, v41
v_cvt_pk_bf16_f32 v39, v42, v43
s_nop 0
v_permlane16_swap_b32 v36, v38
v_permlane16_swap_b32 v37, v39
buffer_store_dwordx4 v[36:39], v250, s[8:11], s52 offen offset:3072 sc1
s_lshl_b32 s44, s2, 7
s_add_u32 s44, s44, 0x9b0000
s_waitcnt vmcnt(0)
s_barrier
s_cmp_lg_u32 s16, 0
s_cbranch_scc1 Lks_sig24
v_mov_b32 v2, 0
v_mov_b32 v3, s6
s_mov_b64 exec, 1
buffer_store_dword v3, v2, s[8:11], s44 offen sc1
s_mov_b64 exec, -1
Lks_sig24:
s_add_u32 s27, s22, 12288
buffer_load_dwordx4 a[48:51], v5, s[8:11], s27 offen offset:0 sc1
buffer_load_dwordx4 a[52:55], v5, s[8:11], s27 offen offset:1024 sc1
buffer_load_dwordx4 a[56:59], v5, s[8:11], s27 offen offset:2048 sc1
buffer_load_dwordx4 a[60:63], v5, s[8:11], s27 offen offset:3072 sc1
s_add_u32 s27, s23, 12288
buffer_load_dwordx4 a[128:131], v5, s[8:11], s27 offen offset:0 sc1
buffer_load_dwordx4 a[132:135], v5, s[8:11], s27 offen offset:1024 sc1
buffer_load_dwordx4 a[136:139], v5, s[8:11], s27 offen offset:2048 sc1
buffer_load_dwordx4 a[140:143], v5, s[8:11], s27 offen offset:3072 sc1
s_add_u32 s27, s22, 16384
buffer_load_dwordx4 a[64:67], v5, s[8:11], s27 offen offset:0 sc1
buffer_load_dwordx4 a[68:71], v5, s[8:11], s27 offen offset:1024 sc1
buffer_load_dwordx4 a[72:75], v5, s[8:11], s27 offen offset:2048 sc1
buffer_load_dwordx4 a[76:79], v5, s[8:11], s27 offen offset:3072 sc1
s_add_u32 s27, s23, 16384
buffer_load_dwordx4 a[144:147], v5, s[8:11], s27 offen offset:0 sc1
buffer_load_dwordx4 a[148:151], v5, s[8:11], s27 offen offset:1024 sc1
buffer_load_dwordx4 a[152:155], v5, s[8:11], s27 offen offset:2048 sc1
buffer_load_dwordx4 a[156:159], v5, s[8:11], s27 offen offset:3072 sc1
s_branch Lks_B
Lks_h1:
s_waitcnt vmcnt(5)
s_mov_b32 s37, 0
Lks_nn25:
v_readfirstlane_b32 s6, v54
s_add_u32 s37, s37, 1
s_cmp_gt_u32 s37, 131072
s_cbranch_scc1 Lks_nok26
s_cmp_lg_u32 s6, 0
s_cbranch_scc1 Lks_nok26
v_mov_b32_e64 v2, 0
global_load_dword v54, v2, s[32:33] sc1
s_waitcnt vmcnt(0)
s_branch Lks_nn25
Lks_nok26:
global_load_dwordx4 v[144:147], v190, s[46:47]
v_add_u32 v190, 98304, v190
global_load_dwordx4 v[148:151], v190, s[46:47]
v_add_u32 v190, 98304, v190
global_load_dwordx4 v[152:155], v190, s[46:47]
v_add_u32 v190, 98304, v190
global_load_dwordx4 v[156:159], v190, s[46:47]
v_add_u32 v190, 98304, v190
global_load_dwordx4 v[160:163], v190, s[46:47]
s_waitcnt vmcnt(5)
s_barrier
s_cmp_lg_u32 s16, 0
s_cbranch_scc1 Lks_sig27
v_mov_b32 v2, 0
v_mov_b32_e64 v3, s6
s_mov_b64 exec, 1
buffer_store_dword v3, v2, s[8:11], s30 offen sc1
s_mov_b64 exec, -1
Lks_sig27:
s_waitcnt vmcnt(0)
ds_write_b128 v56, v[144:147] offset:0
ds_write_b128 v56, v[148:151] offset:5120
ds_write_b128 v56, v[152:155] offset:10240
ds_write_b128 v56, v[156:159] offset:15360
ds_write_b128 v56, v[160:163] offset:20480
s_waitcnt lgkmcnt(0)
s_barrier
s_sub_u32 s44, s2, 160
v_lshrrev_b32 v2, 2, v1
v_and_b32 v3, 3, v1
v_mul_u32_u24 v2, 160, v2
v_lshl_add_u32 v2, v3, 3, v2
s_lshl_b32 s27, s16, 5
v_add_u32 v57, s27, v2
ds_read_b64_tr_b16 v[12:13], v57 offset:0
ds_read_b64_tr_b16 v[14:15], v57 offset:2560
ds_read_b64_tr_b16 v[16:17], v57 offset:5120
ds_read_b64_tr_b16 v[18:19], v57 offset:7680
ds_read_b64_tr_b16 v[20:21], v57 offset:10240
ds_read_b64_tr_b16 v[22:23], v57 offset:12800
ds_read_b64_tr_b16 v[24:25], v57 offset:15360
ds_read_b64_tr_b16 v[26:27], v57 offset:17920
ds_read_b64_tr_b16 v[28:29], v57 offset:20480
ds_read_b64_tr_b16 v[30:31], v57 offset:23040
v_mov_b32 v48, 0x3f803f80
v_mov_b32 v49, 0x3f803f80
v_mov_b32 v50, 0x3f803f80
v_mov_b32 v51, 0x3f803f80
s_and_b32 s45, s44, 3
s_and_b32 s46, s44, -4
s_add_u32 s46, s46, s16
s_mul_i32 s47, s46, 20
s_mul_i32 s50, s45, 5
s_add_u32 s47, s47, s50
s_lshl_b32 s47, s47, 10
s_add_u32 s47, s47, 0xa00000
s_add_u32 s50, s47, 4096
s_waitcnt lgkmcnt(8)
v_mfma_f32_16x16x32_bf16 v[44:47], v[12:15], v[48:51], 0
buffer_store_dwordx4 v[12:15], v5, s[8:11], s47 offen offset:0 sc1
s_waitcnt lgkmcnt(6)
v_mfma_f32_16x16x32_bf16 v[44:47], v[16:19], v[48:51], v[44:47]
buffer_store_dwordx4 v[16:19], v5, s[8:11], s47 offen offset:1024 sc1
s_waitcnt lgkmcnt(4)
v_mfma_f32_16x16x32_bf16 v[44:47], v[20:23], v[48:51], v[44:47]
buffer_store_dwordx4 v[20:23], v5, s[8:11], s47 offen offset:2048 sc1
s_waitcnt lgkmcnt(2)
v_mfma_f32_16x16x32_bf16 v[44:47], v[24:27], v[48:51], v[44:47]
buffer_store_dwordx4 v[24:27], v5, s[8:11], s47 offen offset:3072 sc1
s_waitcnt lgkmcnt(0)
v_mfma_f32_16x16x32_bf16 v[44:47], v[28:31], v[48:51], v[44:47]
buffer_store_dwordx4 v[28:31], v5, s[8:11], s50 offen sc1
s_mul_i32 s47, s45, 6144
s_lshl_b32 s50, s46, 6
s_add_u32 s47, s47, s50
s_add_u32 s47, s47, 0x980000
v_lshlrev_b32_e64 v2, 4, v8
s_mov_b32 exec_lo, 0x00010001
s_mov_b32 exec_hi, 0x00010001
buffer_store_dwordx4 v[44:47], v2, s[8:11], s47 offen sc1
s_mov_b64 exec, -1
s_nop 0
global_load_dwordx4 v[164:167], v191, s[48:49]
v_add_u32 v191, 40960, v191
global_load_dwordx4 v[168:171], v191, s[48:49]
v_add_u32 v191, 40960, v191
global_load_dwordx4 v[172:175], v191, s[48:49]
s_lshl_b32 s47, s44, 7
s_add_u32 s47, s47, 0x9d0000
s_waitcnt vmcnt(3)
s_barrier
s_cmp_lg_u32 s16, 0
s_cbranch_scc1 Lks_sig28
v_mov_b32 v2, 0
v_mov_b32 v3, s6
s_mov_b64 exec, 1
buffer_store_dword v3, v2, s[8:11], s47 offen sc1
s_mov_b64 exec, -1
Lks_sig28:
v_lshrrev_b32 v2, 1, v1
v_lshlrev_b32 v2, 10, v2
v_and_b32 v3, 1, v1
v_lshl_add_u32 v99, v3, 7, v2
s_lshr_b32 s45, s44, 3
s_lshl_b32 s45, s45, 2
s_add_u32 s45, s45, s16
s_and_b32 s46, s44, 1
s_mul_i32 s46, s46, 48
s_add_u32 s45, s45, s46
s_add_u32 s45, s45, 0
s_min_u32 s45, s45, 255
s_lshr_b32 s46, s45, 6
s_lshl_b32 s46, s46, 8
s_and_b32 s45, s45, 63
s_lshl_b32 s45, s45, 15
s_add_u32 s45, s45, s46
s_bfe_u32 s46, s44, 0x20001
s_lshl_b32 s46, s46, 21
s_add_u32 s45, s45, s46
buffer_load_dword v100, v99, s[12:15], s45 offen
s_lshr_b32 s45, s44, 3
s_lshl_b32 s45, s45, 2
s_add_u32 s45, s45, s16
s_and_b32 s46, s44, 1
s_mul_i32 s46, s46, 48
s_add_u32 s45, s45, s46
s_add_u32 s45, s45, 96
s_min_u32 s45, s45, 255
s_lshr_b32 s46, s45, 6
s_lshl_b32 s46, s46, 8
s_and_b32 s45, s45, 63
s_lshl_b32 s45, s45, 15
s_add_u32 s45, s45, s46
s_bfe_u32 s46, s44, 0x20001
s_lshl_b32 s46, s46, 21
s_add_u32 s45, s45, s46
buffer_load_dword v101, v99, s[12:15], s45 offen
s_lshr_b32 s45, s44, 3
s_lshl_b32 s45, s45, 2
s_add_u32 s45, s45, s16
s_and_b32 s46, s44, 1
s_mul_i32 s46, s46, 48
s_add_u32 s45, s45, s46
s_add_u32 s45, s45, 192
s_min_u32 s45, s45, 255
s_lshr_b32 s46, s45, 6
s_lshl_b32 s46, s46, 8
s_and_b32 s45, s45, 63
s_lshl_b32 s45, s45, 15
s_add_u32 s45, s45, s46
s_bfe_u32 s46, s44, 0x20001
s_lshl_b32 s46, s46, 21
s_add_u32 s45, s45, s46
buffer_load_dword v102, v99, s[12:15], s45 offen
s_mov_b32 s47, 0x9d0000
s_mov_b32 s37, 0
Lks_poll29:
buffer_load_dword v3, v254, s[8:11], s47 offen sc1
buffer_load_dword v4, v255, s[8:11], s47 offen sc1
s_add_u32 s37, s37, 1
s_cmp_gt_u32 s37, 131072
s_cbranch_scc1 Lks_pok30
s_waitcnt vmcnt(0)
v_cmp_ne_u32 vcc, s6, v3
s_cbranch_vccnz Lks_poll29
v_cmp_ne_u32 vcc, s6, v4
s_cbranch_vccnz Lks_poll29
Lks_pok30:
s_waitcnt vmcnt(0)
s_add_u32 s27, s22, 0
buffer_load_dwordx4 a[0:3], v5, s[8:11], s27 offen offset:0 sc1
buffer_load_dwordx4 a[4:7], v5, s[8:11], s27 offen offset:1024 sc1
buffer_load_dwordx4 a[8:11], v5, s[8:11], s27 offen offset:2048 sc1
buffer_load_dwordx4 a[12:15], v5, s[8:11], s27 offen offset:3072 sc1
s_add_u32 s27, s23, 0
s_nop 0
buffer_load_dwordx4 a[80:83], v5, s[8:11], s27 offen offset:0 sc1
buffer_load_dwordx4 a[84:87], v5, s[8:11], s27 offen offset:1024 sc1
buffer_load_dwordx4 a[88:91], v5, s[8:11], s27 offen offset:2048 sc1
buffer_load_dwordx4 a[92:95], v5, s[8:11], s27 offen offset:3072 sc1
s_add_u32 s27, s22, 4096
buffer_load_dwordx4 a[16:19], v5, s[8:11], s27 offen offset:0 sc1
buffer_load_dwordx4 a[20:23], v5, s[8:11], s27 offen offset:1024 sc1
buffer_load_dwordx4 a[24:27], v5, s[8:11], s27 offen offset:2048 sc1
buffer_load_dwordx4 a[28:31], v5, s[8:11], s27 offen offset:3072 sc1
s_add_u32 s27, s23, 4096
buffer_load_dwordx4 a[96:99], v5, s[8:11], s27 offen offset:0 sc1
buffer_load_dwordx4 a[100:103], v5, s[8:11], s27 offen offset:1024 sc1
buffer_load_dwordx4 a[104:107], v5, s[8:11], s27 offen offset:2048 sc1
buffer_load_dwordx4 a[108:111], v5, s[8:11], s27 offen offset:3072 sc1
s_add_u32 s27, s22, 8192
buffer_load_dwordx4 a[32:35], v5, s[8:11], s27 offen offset:0 sc1
buffer_load_dwordx4 a[36:39], v5, s[8:11], s27 offen offset:1024 sc1
buffer_load_dwordx4 a[40:43], v5, s[8:11], s27 offen offset:2048 sc1
buffer_load_dwordx4 a[44:47], v5, s[8:11], s27 offen offset:3072 sc1
s_add_u32 s27, s23, 8192
buffer_load_dwordx4 a[112:115], v5, s[8:11], s27 offen offset:0 sc1
buffer_load_dwordx4 a[116:119], v5, s[8:11], s27 offen offset:1024 sc1
buffer_load_dwordx4 a[120:123], v5, s[8:11], s27 offen offset:2048 sc1
buffer_load_dwordx4 a[124:127], v5, s[8:11], s27 offen offset:3072 sc1
s_add_u32 s27, s22, 12288
buffer_load_dwordx4 a[48:51], v5, s[8:11], s27 offen offset:0 sc1
buffer_load_dwordx4 a[52:55], v5, s[8:11], s27 offen offset:1024 sc1
buffer_load_dwordx4 a[56:59], v5, s[8:11], s27 offen offset:2048 sc1
buffer_load_dwordx4 a[60:63], v5, s[8:11], s27 offen offset:3072 sc1
s_add_u32 s27, s23, 12288
buffer_load_dwordx4 a[128:131], v5, s[8:11], s27 offen offset:0 sc1
buffer_load_dwordx4 a[132:135], v5, s[8:11], s27 offen offset:1024 sc1
buffer_load_dwordx4 a[136:139], v5, s[8:11], s27 offen offset:2048 sc1
buffer_load_dwordx4 a[140:143], v5, s[8:11], s27 offen offset:3072 sc1
s_add_u32 s27, s22, 16384
buffer_load_dwordx4 a[64:67], v5, s[8:11], s27 offen offset:0 sc1
buffer_load_dwordx4 a[68:71], v5, s[8:11], s27 offen offset:1024 sc1
buffer_load_dwordx4 a[72:75], v5, s[8:11], s27 offen offset:2048 sc1
buffer_load_dwordx4 a[76:79], v5, s[8:11], s27 offen offset:3072 sc1
s_add_u32 s27, s23, 16384
buffer_load_dwordx4 a[144:147], v5, s[8:11], s27 offen offset:0 sc1
buffer_load_dwordx4 a[148:151], v5, s[8:11], s27 offen offset:1024 sc1
buffer_load_dwordx4 a[152:155], v5, s[8:11], s27 offen offset:2048 sc1
buffer_load_dwordx4 a[156:159], v5, s[8:11], s27 offen offset:3072 sc1
ds_write_b128 v56, v[164:167] offset:0
ds_write_b128 v56, v[168:171] offset:5120
ds_write_b128 v56, v[172:175] offset:10240
s_lshr_b32 s47, s44, 3
s_lshl_b32 s47, s47, 2
s_add_u32 s47, s47, s16
s_mul_i32 s48, s47, 52
s_lshr_b32 s48, s48, 8
s_mul_i32 s49, s48, 5
s_sub_u32 s49, s47, s49
s_and_b32 s47, s44, 7
s_mul_i32 s50, s47, 5120
s_mul_i32 s48, s48, 120
s_add_u32 s47, s48, s49
s_lshl_b32 s47, s47, 10
s_add_u32 s47, s47, 0xc00000
s_add_u32 s47, s47, s50
s_add_u32 s51, s47, 81920
s_add_u32 s47, s47, s50
s_waitcnt lgkmcnt(0)
s_barrier
ds_read_b64_tr_b16 v[12:13], v57 offset:0
ds_read_b64_tr_b16 v[14:15], v57 offset:2560
ds_read_b64_tr_b16 v[16:17], v57 offset:5120
ds_read_b64_tr_b16 v[18:19], v57 offset:7680
ds_read_b64_tr_b16 v[20:21], v57 offset:10240
ds_read_b64_tr_b16 v[22:23], v57 offset:12800
s_waitcnt lgkmcnt(0)
s_barrier
s_cmp_ge_u32 s44, 80
s_cbranch_scc1 Lks_nwo31
buffer_store_dwordx4 v[12:15], v5, s[8:11], s47 offen sc1
s_add_u32 s47, s47, 5120
buffer_store_dwordx4 v[16:19], v5, s[8:11], s47 offen sc1
buffer_store_dwordx4 v[20:23], v5, s[8:11], s51 offen sc1
Lks_nwo31:
s_waitcnt vmcnt(28)
Lks_B:
v_mov_b32 v164, 0x3f803f80
v_mov_b32 v165, 0x3f803f80
v_mov_b32 v166, 0x3f803f80
v_mov_b32 v167, 0x3f803f80
v_lshrrev_b32 v2, 3, v1
v_and_b32 v3, 7, v1
v_and_b32 v4, 6, v2
v_xor_b32 v3, v3, v4
v_lshlrev_b32 v10, 12, v2
v_lshl_add_u32 v10, v3, 4, v10
v_add_u32 v2, 0, v8
v_xor_b32 v3, v2, v7
v_lshlrev_b32 v2, 12, v2
v_lshl_add_u32 v11, v3, 4, v2
v_add_u32 v2, 4, v8
v_xor_b32 v3, v2, v7
v_lshlrev_b32 v2, 12, v2
v_lshl_add_u32 v12, v3, 4, v2
v_add_u32 v2, 8, v8
v_xor_b32 v3, v2, v7
v_lshlrev_b32 v2, 12, v2
v_lshl_add_u32 v13, v3, 4, v2
v_add_u32 v2, 12, v8
v_xor_b32 v3, v2, v7
v_lshlrev_b32 v2, 12, v2
v_lshl_add_u32 v14, v3, 4, v2
s_lshl_b32 s26, s16, 14
s_add_u32 s26, s26, 81920
s_lshl_b32 s28, s17, 18
s_lshl_b32 s27, s19, 17
s_add_u32 s28, s28, s27
s_lshl_b32 s27, s16, 10
s_add_u32 s28, s28, s27
s_xor_b32 s4, s28, 0x20000
v_bfe_u32 v2, v1, 2, 2
v_and_b32 v3, 3, v1
v_lshl_add_u32 v4, v8, 2, v2
v_lshrrev_b32 v6, 1, v3
v_and_b32 v3, 1, v3
v_and_b32 v9, 6, v4
v_xor_b32 v6, v6, v9
v_lshlrev_b32_e64 v6, 4, v6
v_lshl_add_u32 v6, v4, 7, v6
v_lshl_add_u32 v6, v3, 3, v6
s_lshl_b32 s36, s20, 6
v_xor_b32 v16, s36, v6
v_xor_b32 v17, 32, v16
v_xor_b32 v18, 64, v16
v_xor_b32 v19, 96, v16
v_add_u32 v20, 40960, v16
v_add_u32 v21, 40960, v17
v_add_u32 v22, 40960, v18
v_add_u32 v23, 40960, v19
s_lshl_b32 s36, s16, 5
s_mul_i32 s35, s18, 10240
v_xor_b32 v24, s36, v6
v_add_u32 v24, s35, v24
s_lshl_b32 s36, s20, 12
v_xor_b32 v2, v8, v7
v_lshlrev_b32 v2, 4, v2
v_lshl_add_u32 v2, v7, 8, v2
v_add_u32 v2, s36, v2
v_xor_b32 v3, 0, v2
v_add_u32 v168, s26, v3
v_xor_b32 v3, 4096, v2
v_add_u32 v169, s26, v3
v_xor_b32 v3, 64, v2
v_add_u32 v170, s26, v3
v_xor_b32 v3, 4160, v2
v_add_u32 v171, s26, v3
v_xor_b32 v3, 128, v2
v_add_u32 v172, s26, v3
v_xor_b32 v3, 4224, v2
v_add_u32 v173, s26, v3
v_xor_b32 v3, 192, v2
v_add_u32 v174, s26, v3
v_xor_b32 v3, 4288, v2
v_add_u32 v175, s26, v3
s_lshl_b32 s21, s17, 7
s_lshl_b32 s36, s16, 16
s_add_u32 s21, s21, s36
s_add_u32 s21, s21, 0x700000
s_lshl_b32 s25, s16, 11
s_lshl_b32 s36, s20, 8
s_lshl_b32 s35, s16, 9
s_add_u32 s35, s35, 160768
v_lshlrev_b32 v9, 3, v1
v_xor_b32 v25, s36, v9
v_add_u32 v27, s35, v25
v_and_b32_e64 v2, 3, v7
v_bfe_u32 v3, v7, 2, 1
v_lshl_add_u32 v2, v3, 3, v2
v_bfe_u32 v3, v7, 3, 1
v_lshl_add_u32 v2, v3, 2, v2
v_lshlrev_b32 v2, 5, v2
v_lshl_add_u32 v2, v8, 3, v2
v_add_u32 v26, s26, v2
v_bfe_u32 v2, v1, 2, 2
v_and_b32 v3, 1, v8
v_lshl_add_u32 v2, v3, 2, v2
v_lshrrev_b32 v3, 1, v8
v_lshl_add_u32 v2, v3, 4, v2
v_and_b32 v3, 3, v1
v_lshlrev_b32 v3, 3, v3
v_lshl_add_u32 v2, v2, 5, v3
v_add_u32 v15, s26, v2
v_lshlrev_b32 v2, 4, v8
v_add_u32 v69, 6144, v2
v_add_u32 v70, 12288, v2
v_add_u32 v71, 18432, v2
buffer_load_dwordx4 v[28:31], v2, s[8:11], s57 offen sc1
buffer_load_dwordx4 v[116:119], v69, s[8:11], s57 offen sc1
buffer_load_dwordx4 v[120:123], v70, s[8:11], s57 offen sc1
buffer_load_dwordx4 v[124:127], v71, s[8:11], s57 offen sc1
buffer_load_dwordx4 v[32:35], v2, s[8:11], s58 offen sc1
buffer_load_dwordx4 v[128:131], v69, s[8:11], s58 offen sc1
buffer_load_dwordx4 v[132:135], v70, s[8:11], s58 offen sc1
buffer_load_dwordx4 v[136:139], v71, s[8:11], s58 offen sc1
buffer_load_dwordx4 v[36:39], v2, s[8:11], s59 offen sc1
buffer_load_dwordx4 v[140:143], v69, s[8:11], s59 offen sc1
buffer_load_dwordx4 v[144:147], v70, s[8:11], s59 offen sc1
buffer_load_dwordx4 v[148:151], v71, s[8:11], s59 offen sc1
v_min_u32 v2, 39, v1
v_lshrrev_b32 v3, 2, v2
v_and_b32 v2, 3, v2
v_lshl_add_u32 v2, v3, 4, v2
v_lshlrev_b32 v2, 7, v2
s_lshl_b32 s30, s16, 9
s_add_u32 s30, s30, 0x9b0000
s_mov_b32 s37, 0
Lks_poll32:
buffer_load_dword v3, v2, s[8:11], s30 offen sc1
s_add_u32 s37, s37, 1
s_cmp_gt_u32 s37, 131072
s_cbranch_scc1 Lks_pok33
s_waitcnt vmcnt(0)
v_cmp_ne_u32 vcc, s6, v3
s_cbranch_vccnz Lks_poll32
Lks_pok33:
s_waitcnt vmcnt(0)
s_cmp_ge_u32 s16, 2
s_cbranch_scc1 Lks_Bhi
s_add_u32 m0, s25, 0
s_add_u32 s27, s21, 0
buffer_load_dwordx4 v10, s[8:11], s27 offen sc1 lds
s_add_u32 m0, s25, 1024
s_add_u32 s27, s21, 32768
buffer_load_dwordx4 v10, s[8:11], s27 offen sc1 lds
s_add_u32 m0, s25, 8192
s_add_u32 s27, s21, 262144
buffer_load_dwordx4 v10, s[8:11], s27 offen sc1 lds
s_add_u32 m0, s25, 9216
s_add_u32 s27, s21, 294912
buffer_load_dwordx4 v10, s[8:11], s27 offen sc1 lds
s_add_u32 m0, s25, 16384
s_add_u32 s27, s21, 524288
buffer_load_dwordx4 v10, s[8:11], s27 offen sc1 lds
s_add_u32 m0, s25, 17408
s_add_u32 s27, s21, 557056
buffer_load_dwordx4 v10, s[8:11], s27 offen sc1 lds
s_add_u32 m0, s25, 24576
s_add_u32 s27, s21, 786432
buffer_load_dwordx4 v10, s[8:11], s27 offen sc1 lds
s_add_u32 m0, s25, 25600
s_add_u32 s27, s21, 819200
buffer_load_dwordx4 v10, s[8:11], s27 offen sc1 lds
s_add_u32 m0, s25, 32768
s_add_u32 s27, s21, 1048576
buffer_load_dwordx4 v10, s[8:11], s27 offen sc1 lds
s_add_u32 m0, s25, 33792
s_add_u32 s27, s21, 1081344
buffer_load_dwordx4 v10, s[8:11], s27 offen sc1 lds
s_add_u32 m0, s25, 40960
s_add_u32 s27, s21, 1310720
buffer_load_dwordx4 v10, s[8:11], s27 offen sc1 lds
s_add_u32 m0, s25, 41984
s_add_u32 s27, s21, 1343488
buffer_load_dwordx4 v10, s[8:11], s27 offen sc1 lds
v_pk_add_f32 v[28:29], v[28:29], v[116:117]
v_pk_add_f32 v[30:31], v[30:31], v[118:119]
v_pk_add_f32 v[28:29], v[28:29], v[120:121]
v_pk_add_f32 v[30:31], v[30:31], v[122:123]
v_pk_add_f32 v[28:29], v[28:29], v[124:125]
v_pk_add_f32 v[30:31], v[30:31], v[126:127]
v_pk_add_f32 v[32:33], v[32:33], v[128:129]
v_pk_add_f32 v[34:35], v[34:35], v[130:131]
v_pk_add_f32 v[32:33], v[32:33], v[132:133]
v_pk_add_f32 v[34:35], v[34:35], v[134:135]
v_pk_add_f32 v[32:33], v[32:33], v[136:137]
v_pk_add_f32 v[34:35], v[34:35], v[138:139]
v_pk_add_f32 v[36:37], v[36:37], v[140:141]
v_pk_add_f32 v[38:39], v[38:39], v[142:143]
v_pk_add_f32 v[36:37], v[36:37], v[144:145]
v_pk_add_f32 v[38:39], v[38:39], v[146:147]
v_pk_add_f32 v[36:37], v[36:37], v[148:149]
v_pk_add_f32 v[38:39], v[38:39], v[150:151]
s_waitcnt vmcnt(10)
s_barrier
s_lshl_b32 s36, s20, 9
v_lshlrev_b32 v3, 4, v7
v_add_u32_e64 v3, s36, v3
v_xor_b32 v4, 512, v3
v_add_u32 v50, 159744, v3
v_add_u32 v51, 159744, v4
ds_read_b64_tr_b16 v[68:69], v16 offset:0
ds_read_b64_tr_b16 v[70:71], v16 offset:2048
ds_read_b64_tr_b16 v[72:73], v17 offset:0
ds_read_b64_tr_b16 v[74:75], v17 offset:2048
ds_read_b64_tr_b16 v[76:77], v18 offset:0
ds_read_b64_tr_b16 v[78:79], v18 offset:2048
ds_read_b64_tr_b16 v[80:81], v19 offset:0
ds_read_b64_tr_b16 v[82:83], v19 offset:2048
ds_read_b64_tr_b16 v[84:85], v16 offset:4096
ds_read_b64_tr_b16 v[86:87], v16 offset:6144
ds_read_b64_tr_b16 v[88:89], v17 offset:4096
ds_read_b64_tr_b16 v[90:91], v17 offset:6144
ds_read_b64_tr_b16 v[92:93], v18 offset:4096
ds_read_b64_tr_b16 v[94:95], v18 offset:6144
ds_read_b64_tr_b16 v[96:97], v19 offset:4096
ds_read_b64_tr_b16 v[98:99], v19 offset:6144
s_waitcnt lgkmcnt(8)
s_waitcnt vmcnt(6)
s_barrier
v_mfma_f32_16x16x32_bf16 v[116:119], a[0:3], v[68:71], 0
ds_read_b64_tr_b16 v[100:101], v16 offset:8192
s_add_u32 m0, s25, 49152
s_add_u32 s27, s21, 1572864
v_mfma_f32_16x16x32_bf16 v[132:135], a[80:83], v[68:71], 0
buffer_load_dwordx4 v10, s[8:11], s27 offen sc1 lds
ds_read_b64_tr_b16 v[102:103], v16 offset:10240
v_mfma_f32_16x16x32_bf16 v[120:123], a[0:3], v[72:75], 0
ds_read_b64_tr_b16 v[104:105], v17 offset:8192
s_add_u32 m0, s25, 50176
s_add_u32 s27, s21, 1605632
v_mfma_f32_16x16x32_bf16 v[136:139], a[80:83], v[72:75], 0
buffer_load_dwordx4 v10, s[8:11], s27 offen sc1 lds
ds_read_b64_tr_b16 v[106:107], v17 offset:10240
v_mfma_f32_16x16x32_bf16 v[124:127], a[0:3], v[76:79], 0
s_nop 0
ds_read_b64_tr_b16 v[108:109], v18 offset:8192
s_add_u32 m0, s25, 57344
s_add_u32 s27, s21, 1835008
v_mfma_f32_16x16x32_bf16 v[140:143], a[80:83], v[76:79], 0
buffer_load_dwordx4 v10, s[8:11], s27 offen sc1 lds
ds_read_b64_tr_b16 v[110:111], v18 offset:10240
v_mfma_f32_16x16x32_bf16 v[128:131], a[0:3], v[80:83], 0
ds_read_b64_tr_b16 v[112:113], v19 offset:8192
s_add_u32 m0, s25, 58368
s_add_u32 s27, s21, 1867776
v_mfma_f32_16x16x32_bf16 v[144:147], a[80:83], v[80:83], 0
buffer_load_dwordx4 v10, s[8:11], s27 offen sc1 lds
ds_read_b64_tr_b16 v[114:115], v19 offset:10240
s_waitcnt lgkmcnt(8)
v_mfma_f32_16x16x32_bf16 v[116:119], a[4:7], v[84:87], v[116:119]
ds_read_b64_tr_b16 v[68:69], v16 offset:12288
s_add_u32 m0, s25, 65536
s_add_u32 s27, s21, 2097152
v_mfma_f32_16x16x32_bf16 v[132:135], a[84:87], v[84:87], v[132:135]
buffer_load_dwordx4 v10, s[8:11], s27 offen sc1 lds
ds_read_b64_tr_b16 v[70:71], v16 offset:14336
v_mfma_f32_16x16x32_bf16 v[120:123], a[4:7], v[88:91], v[120:123]
ds_read_b64_tr_b16 v[72:73], v17 offset:12288
s_add_u32 m0, s25, 66560
s_add_u32 s27, s21, 2129920
v_mfma_f32_16x16x32_bf16 v[136:139], a[84:87], v[88:91], v[136:139]
buffer_load_dwordx4 v10, s[8:11], s27 offen sc1 lds
ds_read_b64_tr_b16 v[74:75], v17 offset:14336
v_mfma_f32_16x16x32_bf16 v[124:127], a[4:7], v[92:95], v[124:127]
s_nop 0
ds_read_b64_tr_b16 v[76:77], v18 offset:12288
s_add_u32 m0, s25, 73728
s_add_u32 s27, s21, 2359296
v_mfma_f32_16x16x32_bf16 v[140:143], a[84:87], v[92:95], v[140:143]
buffer_load_dwordx4 v10, s[8:11], s27 offen sc1 lds
ds_read_b64_tr_b16 v[78:79], v18 offset:14336
v_mfma_f32_16x16x32_bf16 v[128:131], a[4:7], v[96:99], v[128:131]
ds_read_b64_tr_b16 v[80:81], v19 offset:12288
s_add_u32 m0, s25, 74752
s_add_u32 s27, s21, 2392064
v_mfma_f32_16x16x32_bf16 v[144:147], a[84:87], v[96:99], v[144:147]
buffer_load_dwordx4 v10, s[8:11], s27 offen sc1 lds
ds_read_b64_tr_b16 v[82:83], v19 offset:14336
s_waitcnt lgkmcnt(8)
v_mfma_f32_16x16x32_bf16 v[116:119], a[8:11], v[100:103], v[116:119]
ds_read_b64_tr_b16 v[84:85], v16 offset:16384
s_add_u32 m0, s26, 0
s_add_u32 s55, s28, 0
v_mfma_f32_16x16x32_bf16 v[132:135], a[88:91], v[100:103], v[132:135]
buffer_load_dwordx4 v11, s[12:15], s55 offen lds
ds_read_b64_tr_b16 v[86:87], v16 offset:18432
v_mfma_f32_16x16x32_bf16 v[120:123], a[8:11], v[104:107], v[120:123]
ds_read_b64_tr_b16 v[88:89], v17 offset:16384
s_add_u32 m0, s26, 1024
v_mfma_f32_16x16x32_bf16 v[136:139], a[88:91], v[104:107], v[136:139]
buffer_load_dwordx4 v12, s[12:15], s55 offen lds
ds_read_b64_tr_b16 v[90:91], v17 offset:18432
v_mfma_f32_16x16x32_bf16 v[124:127], a[8:11], v[108:111], v[124:127]
ds_read_b64_tr_b16 v[92:93], v18 offset:16384
s_add_u32 m0, s26, 2048
v_mfma_f32_16x16x32_bf16 v[140:143], a[88:91], v[108:111], v[140:143]
buffer_load_dwordx4 v13, s[12:15], s55 offen lds
ds_read_b64_tr_b16 v[94:95], v18 offset:18432
v_mfma_f32_16x16x32_bf16 v[128:131], a[8:11], v[112:115], v[128:131]
s_nop 0
ds_read_b64_tr_b16 v[96:97], v19 offset:16384
s_add_u32 m0, s26, 3072
v_mfma_f32_16x16x32_bf16 v[144:147], a[88:91], v[112:115], v[144:147]
buffer_load_dwordx4 v14, s[12:15], s55 offen lds
ds_read_b64_tr_b16 v[98:99], v19 offset:18432
s_waitcnt lgkmcnt(8)
v_mfma_f32_16x16x32_bf16 v[116:119], a[12:15], v[68:71], v[116:119]
ds_read_b64_tr_b16 v[100:101], v16 offset:20480
s_add_u32 m0, s26, 4096
s_add_u32 s55, s55, 65536
v_mfma_f32_16x16x32_bf16 v[132:135], a[92:95], v[68:71], v[132:135]
buffer_load_dwordx4 v11, s[12:15], s55 offen lds
ds_read_b64_tr_b16 v[102:103], v16 offset:22528
v_mfma_f32_16x16x32_bf16 v[120:123], a[12:15], v[72:75], v[120:123]
ds_read_b64_tr_b16 v[104:105], v17 offset:20480
s_add_u32 m0, s26, 5120
v_mfma_f32_16x16x32_bf16 v[136:139], a[92:95], v[72:75], v[136:139]
buffer_load_dwordx4 v12, s[12:15], s55 offen lds
ds_read_b64_tr_b16 v[106:107], v17 offset:22528
v_mfma_f32_16x16x32_bf16 v[124:127], a[12:15], v[76:79], v[124:127]
ds_read_b64_tr_b16 v[108:109], v18 offset:20480
s_add_u32 m0, s26, 6144
v_mfma_f32_16x16x32_bf16 v[140:143], a[92:95], v[76:79], v[140:143]
buffer_load_dwordx4 v13, s[12:15], s55 offen lds
ds_read_b64_tr_b16 v[110:111], v18 offset:22528
v_mfma_f32_16x16x32_bf16 v[128:131], a[12:15], v[80:83], v[128:131]
s_nop 0
ds_read_b64_tr_b16 v[112:113], v19 offset:20480
s_add_u32 m0, s26, 7168
v_mfma_f32_16x16x32_bf16 v[144:147], a[92:95], v[80:83], v[144:147]
buffer_load_dwordx4 v14, s[12:15], s55 offen lds
ds_read_b64_tr_b16 v[114:115], v19 offset:22528
s_waitcnt lgkmcnt(8)
s_waitcnt vmcnt(16)
s_barrier
v_mfma_f32_16x16x32_bf16 v[116:119], a[16:19], v[84:87], v[116:119]
ds_read_b64_tr_b16 v[68:69], v16 offset:24576
v_mfma_f32_16x16x32_bf16 v[132:135], a[96:99], v[84:87], v[132:135]
ds_read_b64_tr_b16 v[70:71], v16 offset:26624
v_mfma_f32_16x16x32_bf16 v[120:123], a[16:19], v[88:91], v[120:123]
ds_read_b64_tr_b16 v[72:73], v17 offset:24576
s_add_u32 m0, s26, 8192
s_add_u32 s55, s4, 0
v_mfma_f32_16x16x32_bf16 v[136:139], a[96:99], v[88:91], v[136:139]
buffer_load_dwordx4 v11, s[12:15], s55 offen lds
ds_read_b64_tr_b16 v[74:75], v17 offset:26624
v_mfma_f32_16x16x32_bf16 v[124:127], a[16:19], v[92:95], v[124:127]
ds_read_b64_tr_b16 v[76:77], v18 offset:24576
v_mfma_f32_16x16x32_bf16 v[140:143], a[96:99], v[92:95], v[140:143]
ds_read_b64_tr_b16 v[78:79], v18 offset:26624
v_mfma_f32_16x16x32_bf16 v[128:131], a[16:19], v[96:99], v[128:131]
ds_read_b64_tr_b16 v[80:81], v19 offset:24576
s_add_u32 m0, s26, 9216
v_mfma_f32_16x16x32_bf16 v[144:147], a[96:99], v[96:99], v[144:147]
buffer_load_dwordx4 v12, s[12:15], s55 offen lds
ds_read_b64_tr_b16 v[82:83], v19 offset:26624
s_waitcnt lgkmcnt(8)
v_mfma_f32_16x16x32_bf16 v[116:119], a[20:23], v[100:103], v[116:119]
ds_read_b64_tr_b16 v[84:85], v16 offset:28672
v_mfma_f32_16x16x32_bf16 v[132:135], a[100:103], v[100:103], v[132:135]
ds_read_b64_tr_b16 v[86:87], v16 offset:30720
v_mfma_f32_16x16x32_bf16 v[120:123], a[20:23], v[104:107], v[120:123]
ds_read_b64_tr_b16 v[88:89], v17 offset:28672
s_add_u32 m0, s26, 10240
v_mfma_f32_16x16x32_bf16 v[136:139], a[100:103], v[104:107], v[136:139]
buffer_load_dwordx4 v13, s[12:15], s55 offen lds
ds_read_b64_tr_b16 v[90:91], v17 offset:30720
v_mfma_f32_16x16x32_bf16 v[124:127], a[20:23], v[108:111], v[124:127]
ds_read_b64_tr_b16 v[92:93], v18 offset:28672
v_mfma_f32_16x16x32_bf16 v[140:143], a[100:103], v[108:111], v[140:143]
ds_read_b64_tr_b16 v[94:95], v18 offset:30720
v_mfma_f32_16x16x32_bf16 v[128:131], a[20:23], v[112:115], v[128:131]
s_nop 0
ds_read_b64_tr_b16 v[96:97], v19 offset:28672
s_add_u32 m0, s26, 11264
v_mfma_f32_16x16x32_bf16 v[144:147], a[100:103], v[112:115], v[144:147]
buffer_load_dwordx4 v14, s[12:15], s55 offen lds
ds_read_b64_tr_b16 v[98:99], v19 offset:30720
s_waitcnt lgkmcnt(8)
v_mfma_f32_16x16x32_bf16 v[116:119], a[24:27], v[68:71], v[116:119]
ds_read_b64_tr_b16 v[100:101], v16 offset:32768
v_mfma_f32_16x16x32_bf16 v[132:135], a[104:107], v[68:71], v[132:135]
ds_read_b64_tr_b16 v[102:103], v16 offset:34816
v_mfma_f32_16x16x32_bf16 v[120:123], a[24:27], v[72:75], v[120:123]
ds_read_b64_tr_b16 v[104:105], v17 offset:32768
s_add_u32 m0, s26, 12288
s_add_u32 s55, s55, 65536
v_mfma_f32_16x16x32_bf16 v[136:139], a[104:107], v[72:75], v[136:139]
buffer_load_dwordx4 v11, s[12:15], s55 offen lds
ds_read_b64_tr_b16 v[106:107], v17 offset:34816
v_mfma_f32_16x16x32_bf16 v[124:127], a[24:27], v[76:79], v[124:127]
ds_read_b64_tr_b16 v[108:109], v18 offset:32768
v_mfma_f32_16x16x32_bf16 v[140:143], a[104:107], v[76:79], v[140:143]
ds_read_b64_tr_b16 v[110:111], v18 offset:34816
v_mfma_f32_16x16x32_bf16 v[128:131], a[24:27], v[80:83], v[128:131]
s_nop 0
ds_read_b64_tr_b16 v[112:113], v19 offset:32768
s_add_u32 m0, s26, 13312
v_mfma_f32_16x16x32_bf16 v[144:147], a[104:107], v[80:83], v[144:147]
buffer_load_dwordx4 v12, s[12:15], s55 offen lds
ds_read_b64_tr_b16 v[114:115], v19 offset:34816
s_waitcnt lgkmcnt(8)
v_mfma_f32_16x16x32_bf16 v[116:119], a[28:31], v[84:87], v[116:119]
ds_read_b64_tr_b16 v[68:69], v16 offset:36864
v_mfma_f32_16x16x32_bf16 v[132:135], a[108:111], v[84:87], v[132:135]
ds_read_b64_tr_b16 v[70:71], v16 offset:38912
v_mfma_f32_16x16x32_bf16 v[120:123], a[28:31], v[88:91], v[120:123]
ds_read_b64_tr_b16 v[72:73], v17 offset:36864
s_add_u32 m0, s26, 14336
v_mfma_f32_16x16x32_bf16 v[136:139], a[108:111], v[88:91], v[136:139]
buffer_load_dwordx4 v13, s[12:15], s55 offen lds
ds_read_b64_tr_b16 v[74:75], v17 offset:38912
v_mfma_f32_16x16x32_bf16 v[124:127], a[28:31], v[92:95], v[124:127]
ds_read_b64_tr_b16 v[76:77], v18 offset:36864
v_mfma_f32_16x16x32_bf16 v[140:143], a[108:111], v[92:95], v[140:143]
ds_read_b64_tr_b16 v[78:79], v18 offset:38912
v_mfma_f32_16x16x32_bf16 v[128:131], a[28:31], v[96:99], v[128:131]
s_nop 0
ds_read_b64_tr_b16 v[80:81], v19 offset:36864
s_add_u32 m0, s26, 15360
v_mfma_f32_16x16x32_bf16 v[144:147], a[108:111], v[96:99], v[144:147]
buffer_load_dwordx4 v14, s[12:15], s55 offen lds
ds_read_b64_tr_b16 v[82:83], v19 offset:38912
s_waitcnt lgkmcnt(8)
v_mfma_f32_16x16x32_bf16 v[116:119], a[32:35], v[100:103], v[116:119]
ds_read_b64_tr_b16 v[84:85], v20 offset:0
v_mfma_f32_16x16x32_bf16 v[132:135], a[112:115], v[100:103], v[132:135]
ds_read_b64_tr_b16 v[86:87], v20 offset:2048
v_mfma_f32_16x16x32_bf16 v[120:123], a[32:35], v[104:107], v[120:123]
ds_read_b64_tr_b16 v[88:89], v21 offset:0
s_add_u32 s27, s24, 0
v_mfma_f32_16x16x32_bf16 v[136:139], a[112:115], v[104:107], v[136:139]
buffer_load_dwordx4 a[160:163], v5, s[8:11], s27 offen offset:0 sc1
ds_read_b64_tr_b16 v[90:91], v21 offset:2048
v_mfma_f32_16x16x32_bf16 v[124:127], a[32:35], v[108:111], v[124:127]
ds_read_b64_tr_b16 v[92:93], v22 offset:0
v_mfma_f32_16x16x32_bf16 v[140:143], a[112:115], v[108:111], v[140:143]
ds_read_b64_tr_b16 v[94:95], v22 offset:2048
v_mfma_f32_16x16x32_bf16 v[128:131], a[32:35], v[112:115], v[128:131]
ds_read_b64_tr_b16 v[96:97], v23 offset:0
v_mfma_f32_16x16x32_bf16 v[144:147], a[112:115], v[112:115], v[144:147]
buffer_load_dwordx4 a[164:167], v5, s[8:11], s27 offen offset:1024 sc1
ds_read_b64_tr_b16 v[98:99], v23 offset:2048
s_waitcnt lgkmcnt(8)
v_mfma_f32_16x16x32_bf16 v[116:119], a[36:39], v[68:71], v[116:119]
ds_read_b64_tr_b16 v[100:101], v20 offset:4096
v_mfma_f32_16x16x32_bf16 v[132:135], a[116:119], v[68:71], v[132:135]
ds_read_b64_tr_b16 v[102:103], v20 offset:6144
v_mfma_f32_16x16x32_bf16 v[120:123], a[36:39], v[72:75], v[120:123]
ds_read_b64_tr_b16 v[104:105], v21 offset:4096
v_mfma_f32_16x16x32_bf16 v[136:139], a[116:119], v[72:75], v[136:139]
buffer_load_dwordx4 a[168:171], v5, s[8:11], s27 offen offset:2048 sc1
ds_read_b64_tr_b16 v[106:107], v21 offset:6144
v_mfma_f32_16x16x32_bf16 v[124:127], a[36:39], v[76:79], v[124:127]
ds_read_b64_tr_b16 v[108:109], v22 offset:4096
v_mfma_f32_16x16x32_bf16 v[140:143], a[116:119], v[76:79], v[140:143]
ds_read_b64_tr_b16 v[110:111], v22 offset:6144
v_mfma_f32_16x16x32_bf16 v[128:131], a[36:39], v[80:83], v[128:131]
ds_read_b64_tr_b16 v[112:113], v23 offset:4096
v_mfma_f32_16x16x32_bf16 v[144:147], a[116:119], v[80:83], v[144:147]
buffer_load_dwordx4 a[172:175], v5, s[8:11], s27 offen offset:3072 sc1
ds_read_b64_tr_b16 v[114:115], v23 offset:6144
s_waitcnt lgkmcnt(8)
s_waitcnt vmcnt(20)
s_barrier
v_mfma_f32_16x16x32_bf16 v[116:119], a[40:43], v[84:87], v[116:119]
ds_read_b64_tr_b16 v[68:69], v20 offset:8192
v_mfma_f32_16x16x32_bf16 v[132:135], a[120:123], v[84:87], v[132:135]
ds_read_b64_tr_b16 v[70:71], v20 offset:10240
v_mfma_f32_16x16x32_bf16 v[120:123], a[40:43], v[88:91], v[120:123]
ds_read_b64_tr_b16 v[72:73], v21 offset:8192
s_add_u32 s27, s24, 4096
v_mfma_f32_16x16x32_bf16 v[136:139], a[120:123], v[88:91], v[136:139]
buffer_load_dwordx4 a[176:179], v5, s[8:11], s27 offen offset:0 sc1
ds_read_b64_tr_b16 v[74:75], v21 offset:10240
v_mfma_f32_16x16x32_bf16 v[124:127], a[40:43], v[92:95], v[124:127]
ds_read_b64_tr_b16 v[76:77], v22 offset:8192
v_mfma_f32_16x16x32_bf16 v[140:143], a[120:123], v[92:95], v[140:143]
ds_read_b64_tr_b16 v[78:79], v22 offset:10240
v_mfma_f32_16x16x32_bf16 v[128:131], a[40:43], v[96:99], v[128:131]
ds_read_b64_tr_b16 v[80:81], v23 offset:8192
v_mfma_f32_16x16x32_bf16 v[144:147], a[120:123], v[96:99], v[144:147]
buffer_load_dwordx4 a[180:183], v5, s[8:11], s27 offen offset:1024 sc1
ds_read_b64_tr_b16 v[82:83], v23 offset:10240
s_waitcnt lgkmcnt(8)
v_mfma_f32_16x16x32_bf16 v[116:119], a[44:47], v[100:103], v[116:119]
ds_read_b64_tr_b16 v[84:85], v20 offset:12288
v_mfma_f32_16x16x32_bf16 v[132:135], a[124:127], v[100:103], v[132:135]
ds_read_b64_tr_b16 v[86:87], v20 offset:14336
v_mfma_f32_16x16x32_bf16 v[120:123], a[44:47], v[104:107], v[120:123]
ds_read_b64_tr_b16 v[88:89], v21 offset:12288
v_mfma_f32_16x16x32_bf16 v[136:139], a[124:127], v[104:107], v[136:139]
buffer_load_dwordx4 a[184:187], v5, s[8:11], s27 offen offset:2048 sc1
ds_read_b64_tr_b16 v[90:91], v21 offset:14336
v_mfma_f32_16x16x32_bf16 v[124:127], a[44:47], v[108:111], v[124:127]
ds_read_b64_tr_b16 v[92:93], v22 offset:12288
v_mfma_f32_16x16x32_bf16 v[140:143], a[124:127], v[108:111], v[140:143]
ds_read_b64_tr_b16 v[94:95], v22 offset:14336
v_mfma_f32_16x16x32_bf16 v[128:131], a[44:47], v[112:115], v[128:131]
ds_read_b64_tr_b16 v[96:97], v23 offset:12288
v_mfma_f32_16x16x32_bf16 v[144:147], a[124:127], v[112:115], v[144:147]
buffer_load_dwordx4 a[188:191], v5, s[8:11], s27 offen offset:3072 sc1
ds_read_b64_tr_b16 v[98:99], v23 offset:14336
s_waitcnt lgkmcnt(8)
v_mfma_f32_16x16x32_bf16 v[116:119], a[48:51], v[68:71], v[116:119]
ds_read_b64_tr_b16 v[100:101], v20 offset:16384
v_mfma_f32_16x16x32_bf16 v[132:135], a[128:131], v[68:71], v[132:135]
ds_read_b64_tr_b16 v[102:103], v20 offset:18432
v_mfma_f32_16x16x32_bf16 v[120:123], a[48:51], v[72:75], v[120:123]
ds_read_b64_tr_b16 v[104:105], v21 offset:16384
s_add_u32 s27, s24, 8192
v_mfma_f32_16x16x32_bf16 v[136:139], a[128:131], v[72:75], v[136:139]
buffer_load_dwordx4 a[192:195], v5, s[8:11], s27 offen offset:0 sc1
ds_read_b64_tr_b16 v[106:107], v21 offset:18432
v_mfma_f32_16x16x32_bf16 v[124:127], a[48:51], v[76:79], v[124:127]
ds_read_b64_tr_b16 v[108:109], v22 offset:16384
v_mfma_f32_16x16x32_bf16 v[140:143], a[128:131], v[76:79], v[140:143]
ds_read_b64_tr_b16 v[110:111], v22 offset:18432
v_mfma_f32_16x16x32_bf16 v[128:131], a[48:51], v[80:83], v[128:131]
ds_read_b64_tr_b16 v[112:113], v23 offset:16384
v_mfma_f32_16x16x32_bf16 v[144:147], a[128:131], v[80:83], v[144:147]
buffer_load_dwordx4 a[196:199], v5, s[8:11], s27 offen offset:1024 sc1
ds_read_b64_tr_b16 v[114:115], v23 offset:18432
s_waitcnt lgkmcnt(8)
v_mfma_f32_16x16x32_bf16 v[116:119], a[52:55], v[84:87], v[116:119]
ds_read_b64_tr_b16 v[68:69], v20 offset:20480
v_mfma_f32_16x16x32_bf16 v[132:135], a[132:135], v[84:87], v[132:135]
ds_read_b64_tr_b16 v[70:71], v20 offset:22528
v_mfma_f32_16x16x32_bf16 v[120:123], a[52:55], v[88:91], v[120:123]
ds_read_b64_tr_b16 v[72:73], v21 offset:20480
v_mfma_f32_16x16x32_bf16 v[136:139], a[132:135], v[88:91], v[136:139]
buffer_load_dwordx4 a[200:203], v5, s[8:11], s27 offen offset:2048 sc1
ds_read_b64_tr_b16 v[74:75], v21 offset:22528
v_mfma_f32_16x16x32_bf16 v[124:127], a[52:55], v[92:95], v[124:127]
ds_read_b64_tr_b16 v[76:77], v22 offset:20480
v_mfma_f32_16x16x32_bf16 v[140:143], a[132:135], v[92:95], v[140:143]
ds_read_b64_tr_b16 v[78:79], v22 offset:22528
v_mfma_f32_16x16x32_bf16 v[128:131], a[52:55], v[96:99], v[128:131]
ds_read_b64_tr_b16 v[80:81], v23 offset:20480
v_mfma_f32_16x16x32_bf16 v[144:147], a[132:135], v[96:99], v[144:147]
buffer_load_dwordx4 a[204:207], v5, s[8:11], s27 offen offset:3072 sc1
ds_read_b64_tr_b16 v[82:83], v23 offset:22528
s_waitcnt vmcnt(20)
ds_read_b128 v[192:195], v168 offset:0
ds_read_b128 v[196:199], v169 offset:0
ds_read_b128 v[200:203], v170 offset:0
ds_read_b128 v[204:207], v171 offset:0
ds_read_b128 v[208:211], v172 offset:0
ds_read_b128 v[212:215], v173 offset:0
ds_read_b128 v[216:219], v174 offset:0
ds_read_b128 v[220:223], v175 offset:0
s_waitcnt lgkmcnt(15)
v_mfma_f32_16x16x32_bf16 v[116:119], a[56:59], v[100:103], v[116:119]
ds_read_b64_tr_b16 v[84:85], v20 offset:24576
v_mfma_f32_16x16x32_bf16 v[132:135], a[136:139], v[100:103], v[132:135]
ds_read_b64_tr_b16 v[86:87], v20 offset:26624
v_mfma_f32_16x16x32_bf16 v[120:123], a[56:59], v[104:107], v[120:123]
ds_read_b64_tr_b16 v[88:89], v21 offset:24576
s_add_u32 s27, s24, 12288
v_mfma_f32_16x16x32_bf16 v[136:139], a[136:139], v[104:107], v[136:139]
buffer_load_dwordx4 a[208:211], v5, s[8:11], s27 offen offset:0 sc1
ds_read_b64_tr_b16 v[90:91], v21 offset:26624
v_mfma_f32_16x16x32_bf16 v[124:127], a[56:59], v[108:111], v[124:127]
ds_read_b64_tr_b16 v[92:93], v22 offset:24576
v_mfma_f32_16x16x32_bf16 v[140:143], a[136:139], v[108:111], v[140:143]
ds_read_b64_tr_b16 v[94:95], v22 offset:26624
v_mfma_f32_16x16x32_bf16 v[128:131], a[56:59], v[112:115], v[128:131]
ds_read_b64_tr_b16 v[96:97], v23 offset:24576
v_mfma_f32_16x16x32_bf16 v[144:147], a[136:139], v[112:115], v[144:147]
buffer_load_dwordx4 a[212:215], v5, s[8:11], s27 offen offset:1024 sc1
ds_read_b64_tr_b16 v[98:99], v23 offset:26624
s_waitcnt lgkmcnt(15)
v_mfma_f32_16x16x32_bf16 v[116:119], a[60:63], v[68:71], v[116:119]
ds_read_b64_tr_b16 v[100:101], v20 offset:28672
v_mfma_f32_16x16x32_bf16 v[132:135], a[140:143], v[68:71], v[132:135]
ds_read_b64_tr_b16 v[102:103], v20 offset:30720
v_mfma_f32_16x16x32_bf16 v[120:123], a[60:63], v[72:75], v[120:123]
ds_read_b64_tr_b16 v[104:105], v21 offset:28672
v_mfma_f32_16x16x32_bf16 v[136:139], a[140:143], v[72:75], v[136:139]
buffer_load_dwordx4 a[216:219], v5, s[8:11], s27 offen offset:2048 sc1
ds_read_b64_tr_b16 v[106:107], v21 offset:30720
v_mfma_f32_16x16x32_bf16 v[124:127], a[60:63], v[76:79], v[124:127]
ds_read_b64_tr_b16 v[108:109], v22 offset:28672
v_mfma_f32_16x16x32_bf16 v[140:143], a[140:143], v[76:79], v[140:143]
ds_read_b64_tr_b16 v[110:111], v22 offset:30720
v_mfma_f32_16x16x32_bf16 v[128:131], a[60:63], v[80:83], v[128:131]
ds_read_b64_tr_b16 v[112:113], v23 offset:28672
v_mfma_f32_16x16x32_bf16 v[144:147], a[140:143], v[80:83], v[144:147]
buffer_load_dwordx4 a[220:223], v5, s[8:11], s27 offen offset:3072 sc1
ds_read_b64_tr_b16 v[114:115], v23 offset:30720
s_waitcnt lgkmcnt(8)
v_mfma_f32_16x16x32_bf16 v[116:119], a[64:67], v[84:87], v[116:119]
ds_read_b64_tr_b16 v[68:69], v20 offset:32768
v_mfma_f32_16x16x32_bf16 v[132:135], a[144:147], v[84:87], v[132:135]
ds_read_b64_tr_b16 v[70:71], v20 offset:34816
v_mfma_f32_16x16x32_bf16 v[120:123], a[64:67], v[88:91], v[120:123]
ds_read_b64_tr_b16 v[72:73], v21 offset:32768
s_add_u32 s27, s24, 16384
v_mfma_f32_16x16x32_bf16 v[136:139], a[144:147], v[88:91], v[136:139]
buffer_load_dwordx4 a[224:227], v5, s[8:11], s27 offen offset:0 sc1
ds_read_b64_tr_b16 v[74:75], v21 offset:34816
v_mfma_f32_16x16x32_bf16 v[124:127], a[64:67], v[92:95], v[124:127]
ds_read_b64_tr_b16 v[76:77], v22 offset:32768
v_mfma_f32_16x16x32_bf16 v[140:143], a[144:147], v[92:95], v[140:143]
ds_read_b64_tr_b16 v[78:79], v22 offset:34816
v_mfma_f32_16x16x32_bf16 v[128:131], a[64:67], v[96:99], v[128:131]
ds_read_b64_tr_b16 v[80:81], v23 offset:32768
v_mfma_f32_16x16x32_bf16 v[144:147], a[144:147], v[96:99], v[144:147]
buffer_load_dwordx4 a[228:231], v5, s[8:11], s27 offen offset:1024 sc1
ds_read_b64_tr_b16 v[82:83], v23 offset:34816
s_waitcnt vmcnt(18)
ds_read_b128 v[224:227], v168 offset:8192
ds_read_b128 v[228:231], v169 offset:8192
ds_read_b128 v[232:235], v170 offset:8192
ds_read_b128 v[236:239], v171 offset:8192
ds_read_b128 v[240:243], v172 offset:8192
ds_read_b128 v[244:247], v173 offset:8192
ds_read_b128 v[248:251], v174 offset:8192
ds_read_b128 v[252:255], v175 offset:8192
s_waitcnt lgkmcnt(15)
v_mfma_f32_16x16x32_bf16 v[116:119], a[68:71], v[100:103], v[116:119]
ds_read_b64_tr_b16 v[84:85], v20 offset:36864
v_mfma_f32_16x16x32_bf16 v[132:135], a[148:151], v[100:103], v[132:135]
ds_read_b64_tr_b16 v[86:87], v20 offset:38912
v_mfma_f32_16x16x32_bf16 v[120:123], a[68:71], v[104:107], v[120:123]
ds_read_b64_tr_b16 v[88:89], v21 offset:36864
v_mfma_f32_16x16x32_bf16 v[136:139], a[148:151], v[104:107], v[136:139]
buffer_load_dwordx4 a[232:235], v5, s[8:11], s27 offen offset:2048 sc1
ds_read_b64_tr_b16 v[90:91], v21 offset:38912
v_mfma_f32_16x16x32_bf16 v[124:127], a[68:71], v[108:111], v[124:127]
ds_read_b64_tr_b16 v[92:93], v22 offset:36864
v_mfma_f32_16x16x32_bf16 v[140:143], a[148:151], v[108:111], v[140:143]
ds_read_b64_tr_b16 v[94:95], v22 offset:38912
v_mfma_f32_16x16x32_bf16 v[128:131], a[68:71], v[112:115], v[128:131]
ds_read_b64_tr_b16 v[96:97], v23 offset:36864
v_mfma_f32_16x16x32_bf16 v[144:147], a[148:151], v[112:115], v[144:147]
buffer_load_dwordx4 a[236:239], v5, s[8:11], s27 offen offset:3072 sc1
ds_read_b64_tr_b16 v[98:99], v23 offset:38912
s_waitcnt lgkmcnt(15)
v_mfma_f32_16x16x32_bf16 v[116:119], a[72:75], v[68:71], v[116:119]
ds_read_b64_tr_b16 v[40:41], v24 offset:0
v_mfma_f32_16x16x32_bf16 v[132:135], a[152:155], v[68:71], v[132:135]
ds_read_b64_tr_b16 v[42:43], v24 offset:2048
v_mfma_f32_16x16x32_bf16 v[120:123], a[72:75], v[72:75], v[120:123]
v_mfma_f32_16x16x32_bf16 v[136:139], a[152:155], v[72:75], v[136:139]
ds_read_b64_tr_b16 v[44:45], v24 offset:4096
v_mfma_f32_16x16x32_bf16 v[124:127], a[72:75], v[76:79], v[124:127]
ds_read_b64_tr_b16 v[46:47], v24 offset:6144
v_mfma_f32_16x16x32_bf16 v[140:143], a[152:155], v[76:79], v[140:143]
v_mfma_f32_16x16x32_bf16 v[128:131], a[72:75], v[80:83], v[128:131]
ds_read_b64_tr_b16 v[48:49], v24 offset:8192
v_mfma_f32_16x16x32_bf16 v[144:147], a[152:155], v[80:83], v[144:147]
s_barrier
ds_read_b128 v[52:55], v50 offset:0
ds_read_b128 v[56:59], v50 offset:256
ds_read_b128 v[60:63], v51 offset:0
ds_read_b128 v[64:67], v51 offset:256
s_waitcnt lgkmcnt(9)
v_mfma_f32_16x16x32_bf16 v[116:119], a[76:79], v[84:87], v[116:119]
v_mfma_f32_16x16x32_bf16 v[132:135], a[156:159], v[84:87], v[132:135]
v_mfma_f32_16x16x32_bf16 v[120:123], a[76:79], v[88:91], v[120:123]
v_mfma_f32_16x16x32_bf16 v[136:139], a[156:159], v[88:91], v[136:139]
v_mfma_f32_16x16x32_bf16 v[124:127], a[76:79], v[92:95], v[124:127]
v_mfma_f32_16x16x32_bf16 v[140:143], a[156:159], v[92:95], v[140:143]
v_mfma_f32_16x16x32_bf16 v[128:131], a[76:79], v[96:99], v[128:131]
v_mfma_f32_16x16x32_bf16 v[144:147], a[156:159], v[96:99], v[144:147]
s_waitcnt lgkmcnt(0)
s_add_u32 m0, s26, 0
s_add_u32 s55, s28, 256
v_pk_fma_f32 v[116:117], v[28:29], v[52:53], v[116:117] op_sel_hi:[1,0,1] neg_lo:[0,1,0] neg_hi:[0,1,0]
buffer_load_dwordx4 v11, s[12:15], s55 offen lds
v_pk_fma_f32 v[118:119], v[30:31], v[52:53], v[118:119] op_sel_hi:[1,0,1] neg_lo:[0,1,0] neg_hi:[0,1,0]
v_pk_mul_f32 v[68:69], v[116:117], v[116:117]
v_pk_mul_f32 v[70:71], v[118:119], v[118:119]
v_pk_fma_f32 v[68:69], v[68:69], v[54:55], v[54:55] op_sel:[0,1,0] op_sel_hi:[1,1,0]
v_pk_fma_f32 v[70:71], v[70:71], v[54:55], v[54:55] op_sel:[0,1,0] op_sel_hi:[1,1,0]
v_pk_mul_f32 v[68:69], v[68:69], v[116:117]
v_pk_mul_f32 v[70:71], v[70:71], v[118:119]
v_exp_f32 v68, v68
v_exp_f32 v70, v70
v_exp_f32 v69, v69
v_exp_f32 v71, v71
v_pk_fma_f32 v[68:69], v[68:69], v[52:53], v[52:53] op_sel:[0,1,1] op_sel_hi:[1,1,1]
v_pk_fma_f32 v[70:71], v[70:71], v[52:53], v[52:53] op_sel:[0,1,1] op_sel_hi:[1,1,1]
v_rcp_f32 v68, v68
v_rcp_f32 v70, v70
v_rcp_f32 v69, v69
v_rcp_f32 v71, v71
v_pk_mul_f32 v[116:117], v[116:117], v[68:69]
v_pk_mul_f32 v[118:119], v[118:119], v[70:71]
s_add_u32 m0, s26, 1024
v_pk_fma_f32 v[120:121], v[28:29], v[56:57], v[120:121] op_sel_hi:[1,0,1] neg_lo:[0,1,0] neg_hi:[0,1,0]
buffer_load_dwordx4 v12, s[12:15], s55 offen lds
v_pk_fma_f32 v[122:123], v[30:31], v[56:57], v[122:123] op_sel_hi:[1,0,1] neg_lo:[0,1,0] neg_hi:[0,1,0]
v_pk_mul_f32 v[68:69], v[120:121], v[120:121]
v_pk_mul_f32 v[70:71], v[122:123], v[122:123]
v_pk_fma_f32 v[68:69], v[68:69], v[58:59], v[58:59] op_sel:[0,1,0] op_sel_hi:[1,1,0]
v_pk_fma_f32 v[70:71], v[70:71], v[58:59], v[58:59] op_sel:[0,1,0] op_sel_hi:[1,1,0]
v_pk_mul_f32 v[68:69], v[68:69], v[120:121]
v_pk_mul_f32 v[70:71], v[70:71], v[122:123]
v_exp_f32 v68, v68
v_exp_f32 v70, v70
v_exp_f32 v69, v69
v_exp_f32 v71, v71
v_pk_fma_f32 v[68:69], v[68:69], v[56:57], v[56:57] op_sel:[0,1,1] op_sel_hi:[1,1,1]
v_pk_fma_f32 v[70:71], v[70:71], v[56:57], v[56:57] op_sel:[0,1,1] op_sel_hi:[1,1,1]
v_rcp_f32 v68, v68
v_rcp_f32 v70, v70
v_rcp_f32 v69, v69
v_rcp_f32 v71, v71
v_pk_mul_f32 v[120:121], v[120:121], v[68:69]
v_pk_mul_f32 v[122:123], v[122:123], v[70:71]
s_add_u32 m0, s26, 2048
v_pk_fma_f32 v[124:125], v[28:29], v[60:61], v[124:125] op_sel_hi:[1,0,1] neg_lo:[0,1,0] neg_hi:[0,1,0]
buffer_load_dwordx4 v13, s[12:15], s55 offen lds
v_pk_fma_f32 v[126:127], v[30:31], v[60:61], v[126:127] op_sel_hi:[1,0,1] neg_lo:[0,1,0] neg_hi:[0,1,0]
v_pk_mul_f32 v[68:69], v[124:125], v[124:125]
v_pk_mul_f32 v[70:71], v[126:127], v[126:127]
v_pk_fma_f32 v[68:69], v[68:69], v[62:63], v[62:63] op_sel:[0,1,0] op_sel_hi:[1,1,0]
v_pk_fma_f32 v[70:71], v[70:71], v[62:63], v[62:63] op_sel:[0,1,0] op_sel_hi:[1,1,0]
v_pk_mul_f32 v[68:69], v[68:69], v[124:125]
v_pk_mul_f32 v[70:71], v[70:71], v[126:127]
v_exp_f32 v68, v68
v_exp_f32 v70, v70
v_exp_f32 v69, v69
v_exp_f32 v71, v71
v_pk_fma_f32 v[68:69], v[68:69], v[60:61], v[60:61] op_sel:[0,1,1] op_sel_hi:[1,1,1]
v_pk_fma_f32 v[70:71], v[70:71], v[60:61], v[60:61] op_sel:[0,1,1] op_sel_hi:[1,1,1]
v_rcp_f32 v68, v68
v_rcp_f32 v70, v70
v_rcp_f32 v69, v69
v_rcp_f32 v71, v71
v_pk_mul_f32 v[124:125], v[124:125], v[68:69]
v_pk_mul_f32 v[126:127], v[126:127], v[70:71]
s_add_u32 m0, s26, 3072
v_pk_fma_f32 v[128:129], v[28:29], v[64:65], v[128:129] op_sel_hi:[1,0,1] neg_lo:[0,1,0] neg_hi:[0,1,0]
buffer_load_dwordx4 v14, s[12:15], s55 offen lds
v_pk_fma_f32 v[130:131], v[30:31], v[64:65], v[130:131] op_sel_hi:[1,0,1] neg_lo:[0,1,0] neg_hi:[0,1,0]
v_pk_mul_f32 v[68:69], v[128:129], v[128:129]
v_pk_mul_f32 v[70:71], v[130:131], v[130:131]
v_pk_fma_f32 v[68:69], v[68:69], v[66:67], v[66:67] op_sel:[0,1,0] op_sel_hi:[1,1,0]
v_pk_fma_f32 v[70:71], v[70:71], v[66:67], v[66:67] op_sel:[0,1,0] op_sel_hi:[1,1,0]
v_pk_mul_f32 v[68:69], v[68:69], v[128:129]
v_pk_mul_f32 v[70:71], v[70:71], v[130:131]
v_exp_f32 v68, v68
v_exp_f32 v70, v70
v_exp_f32 v69, v69
v_exp_f32 v71, v71
v_pk_fma_f32 v[68:69], v[68:69], v[64:65], v[64:65] op_sel:[0,1,1] op_sel_hi:[1,1,1]
v_pk_fma_f32 v[70:71], v[70:71], v[64:65], v[64:65] op_sel:[0,1,1] op_sel_hi:[1,1,1]
v_rcp_f32 v68, v68
v_rcp_f32 v70, v70
v_rcp_f32 v69, v69
v_rcp_f32 v71, v71
v_pk_mul_f32 v[128:129], v[128:129], v[68:69]
v_pk_mul_f32 v[130:131], v[130:131], v[70:71]
s_add_u32 m0, s26, 4096
s_add_u32 s55, s55, 65536
v_pk_fma_f32 v[132:133], v[32:33], v[52:53], v[132:133] op_sel_hi:[1,0,1] neg_lo:[0,1,0] neg_hi:[0,1,0]
buffer_load_dwordx4 v11, s[12:15], s55 offen lds
v_pk_fma_f32 v[134:135], v[34:35], v[52:53], v[134:135] op_sel_hi:[1,0,1] neg_lo:[0,1,0] neg_hi:[0,1,0]
v_pk_mul_f32 v[68:69], v[132:133], v[132:133]
v_pk_mul_f32 v[70:71], v[134:135], v[134:135]
v_pk_fma_f32 v[68:69], v[68:69], v[54:55], v[54:55] op_sel:[0,1,0] op_sel_hi:[1,1,0]
v_pk_fma_f32 v[70:71], v[70:71], v[54:55], v[54:55] op_sel:[0,1,0] op_sel_hi:[1,1,0]
v_pk_mul_f32 v[68:69], v[68:69], v[132:133]
v_pk_mul_f32 v[70:71], v[70:71], v[134:135]
v_exp_f32 v68, v68
v_exp_f32 v70, v70
v_exp_f32 v69, v69
v_exp_f32 v71, v71
v_pk_fma_f32 v[68:69], v[68:69], v[52:53], v[52:53] op_sel:[0,1,1] op_sel_hi:[1,1,1]
v_pk_fma_f32 v[70:71], v[70:71], v[52:53], v[52:53] op_sel:[0,1,1] op_sel_hi:[1,1,1]
v_rcp_f32 v68, v68
v_rcp_f32 v70, v70
v_rcp_f32 v69, v69
v_rcp_f32 v71, v71
v_pk_mul_f32 v[132:133], v[132:133], v[68:69]
v_pk_mul_f32 v[134:135], v[134:135], v[70:71]
s_add_u32 m0, s26, 5120
v_pk_fma_f32 v[136:137], v[32:33], v[56:57], v[136:137] op_sel_hi:[1,0,1] neg_lo:[0,1,0] neg_hi:[0,1,0]
buffer_load_dwordx4 v12, s[12:15], s55 offen lds
v_pk_fma_f32 v[138:139], v[34:35], v[56:57], v[138:139] op_sel_hi:[1,0,1] neg_lo:[0,1,0] neg_hi:[0,1,0]
v_pk_mul_f32 v[68:69], v[136:137], v[136:137]
v_pk_mul_f32 v[70:71], v[138:139], v[138:139]
v_pk_fma_f32 v[68:69], v[68:69], v[58:59], v[58:59] op_sel:[0,1,0] op_sel_hi:[1,1,0]
v_pk_fma_f32 v[70:71], v[70:71], v[58:59], v[58:59] op_sel:[0,1,0] op_sel_hi:[1,1,0]
v_pk_mul_f32 v[68:69], v[68:69], v[136:137]
v_pk_mul_f32 v[70:71], v[70:71], v[138:139]
v_exp_f32 v68, v68
v_exp_f32 v70, v70
v_exp_f32 v69, v69
v_exp_f32 v71, v71
v_pk_fma_f32 v[68:69], v[68:69], v[56:57], v[56:57] op_sel:[0,1,1] op_sel_hi:[1,1,1]
v_pk_fma_f32 v[70:71], v[70:71], v[56:57], v[56:57] op_sel:[0,1,1] op_sel_hi:[1,1,1]
v_rcp_f32 v68, v68
v_rcp_f32 v70, v70
v_rcp_f32 v69, v69
v_rcp_f32 v71, v71
v_pk_mul_f32 v[136:137], v[136:137], v[68:69]
v_pk_mul_f32 v[138:139], v[138:139], v[70:71]
s_add_u32 m0, s26, 6144
v_pk_fma_f32 v[140:141], v[32:33], v[60:61], v[140:141] op_sel_hi:[1,0,1] neg_lo:[0,1,0] neg_hi:[0,1,0]
buffer_load_dwordx4 v13, s[12:15], s55 offen lds
v_pk_fma_f32 v[142:143], v[34:35], v[60:61], v[142:143] op_sel_hi:[1,0,1] neg_lo:[0,1,0] neg_hi:[0,1,0]
v_pk_mul_f32 v[68:69], v[140:141], v[140:141]
v_pk_mul_f32 v[70:71], v[142:143], v[142:143]
v_pk_fma_f32 v[68:69], v[68:69], v[62:63], v[62:63] op_sel:[0,1,0] op_sel_hi:[1,1,0]
v_pk_fma_f32 v[70:71], v[70:71], v[62:63], v[62:63] op_sel:[0,1,0] op_sel_hi:[1,1,0]
v_pk_mul_f32 v[68:69], v[68:69], v[140:141]
v_pk_mul_f32 v[70:71], v[70:71], v[142:143]
v_exp_f32 v68, v68
v_exp_f32 v70, v70
v_exp_f32 v69, v69
v_exp_f32 v71, v71
v_pk_fma_f32 v[68:69], v[68:69], v[60:61], v[60:61] op_sel:[0,1,1] op_sel_hi:[1,1,1]
v_pk_fma_f32 v[70:71], v[70:71], v[60:61], v[60:61] op_sel:[0,1,1] op_sel_hi:[1,1,1]
v_rcp_f32 v68, v68
v_rcp_f32 v70, v70
v_rcp_f32 v69, v69
v_rcp_f32 v71, v71
v_pk_mul_f32 v[140:141], v[140:141], v[68:69]
v_pk_mul_f32 v[142:143], v[142:143], v[70:71]
s_add_u32 m0, s26, 7168
v_pk_fma_f32 v[144:145], v[32:33], v[64:65], v[144:145] op_sel_hi:[1,0,1] neg_lo:[0,1,0] neg_hi:[0,1,0]
buffer_load_dwordx4 v14, s[12:15], s55 offen lds
v_pk_fma_f32 v[146:147], v[34:35], v[64:65], v[146:147] op_sel_hi:[1,0,1] neg_lo:[0,1,0] neg_hi:[0,1,0]
v_pk_mul_f32 v[68:69], v[144:145], v[144:145]
v_pk_mul_f32 v[70:71], v[146:147], v[146:147]
v_pk_fma_f32 v[68:69], v[68:69], v[66:67], v[66:67] op_sel:[0,1,0] op_sel_hi:[1,1,0]
v_pk_fma_f32 v[70:71], v[70:71], v[66:67], v[66:67] op_sel:[0,1,0] op_sel_hi:[1,1,0]
v_pk_mul_f32 v[68:69], v[68:69], v[144:145]
v_pk_mul_f32 v[70:71], v[70:71], v[146:147]
v_exp_f32 v68, v68
v_exp_f32 v70, v70
v_exp_f32 v69, v69
v_exp_f32 v71, v71
v_pk_fma_f32 v[68:69], v[68:69], v[64:65], v[64:65] op_sel:[0,1,1] op_sel_hi:[1,1,1]
v_pk_fma_f32 v[70:71], v[70:71], v[64:65], v[64:65] op_sel:[0,1,1] op_sel_hi:[1,1,1]
v_rcp_f32 v68, v68
v_rcp_f32 v70, v70
v_rcp_f32 v69, v69
v_rcp_f32 v71, v71
v_pk_mul_f32 v[144:145], v[144:145], v[68:69]
v_pk_mul_f32 v[146:147], v[146:147], v[70:71]
v_pk_add_f32 v[176:177], v[116:117], v[118:119]
v_pk_mul_f32 v[184:185], v[116:117], v[116:117]
v_pk_fma_f32 v[184:185], v[118:119], v[118:119], v[184:185]
v_pk_add_f32 v[176:177], v[176:177], v[132:133]
v_pk_add_f32 v[176:177], v[176:177], v[134:135]
v_pk_fma_f32 v[184:185], v[132:133], v[132:133], v[184:185]
v_pk_fma_f32 v[184:185], v[134:135], v[134:135], v[184:185]
v_pk_add_f32 v[178:179], v[120:121], v[122:123]
v_pk_mul_f32 v[186:187], v[120:121], v[120:121]
v_pk_fma_f32 v[186:187], v[122:123], v[122:123], v[186:187]
v_pk_add_f32 v[178:179], v[178:179], v[136:137]
v_pk_add_f32 v[178:179], v[178:179], v[138:139]
v_pk_fma_f32 v[186:187], v[136:137], v[136:137], v[186:187]
v_pk_fma_f32 v[186:187], v[138:139], v[138:139], v[186:187]
v_pk_add_f32 v[180:181], v[124:125], v[126:127]
v_pk_mul_f32 v[188:189], v[124:125], v[124:125]
v_pk_fma_f32 v[188:189], v[126:127], v[126:127], v[188:189]
v_pk_add_f32 v[180:181], v[180:181], v[140:141]
v_pk_add_f32 v[180:181], v[180:181], v[142:143]
v_pk_fma_f32 v[188:189], v[140:141], v[140:141], v[188:189]
v_pk_fma_f32 v[188:189], v[142:143], v[142:143], v[188:189]
v_pk_add_f32 v[182:183], v[128:129], v[130:131]
v_pk_mul_f32 v[190:191], v[128:129], v[128:129]
v_pk_fma_f32 v[190:191], v[130:131], v[130:131], v[190:191]
v_pk_add_f32 v[182:183], v[182:183], v[144:145]
v_pk_add_f32 v[182:183], v[182:183], v[146:147]
v_pk_fma_f32 v[190:191], v[144:145], v[144:145], v[190:191]
v_pk_fma_f32 v[190:191], v[146:147], v[146:147], v[190:191]
v_add_f32 v176, v176, v177
v_add_f32 v178, v178, v179
v_add_f32 v180, v180, v181
v_add_f32 v182, v182, v183
v_add_f32 v184, v184, v185
v_add_f32 v186, v186, v187
v_add_f32 v188, v188, v189
v_add_f32 v190, v190, v191
v_permlane32_swap_b32 v176, v180
v_permlane32_swap_b32 v178, v182
v_permlane32_swap_b32 v184, v188
v_permlane32_swap_b32 v186, v190
v_add_f32 v176, v176, v180
v_add_f32 v178, v178, v182
v_add_f32 v184, v184, v188
v_add_f32 v186, v186, v190
v_permlane16_swap_b32 v176, v178
s_nop 0
v_permlane16_swap_b32 v184, v186
v_add_f32 v68, v176, v178
v_add_f32 v69, v184, v186
ds_write_b64 v27, v[68:69]
s_waitcnt lgkmcnt(0)
s_barrier
s_cmp_lg_u32 s16, 0
s_cbranch_scc1 Lks_npub34
v_lshlrev_b32 v9, 3, v1
v_add_u32 v2, 160768, v9
ds_read_b64 v[176:177], v2 offset:0
ds_read_b64 v[178:179], v2 offset:512
ds_read_b64 v[180:181], v2 offset:1024
ds_read_b64 v[182:183], v2 offset:1536
s_lshl_b32 s36, s18, 9
s_add_u32 s36, s36, s29
s_waitcnt lgkmcnt(0)
s_nop 0
v_pk_add_f32 v[176:177], v[176:177], v[178:179]
v_pk_add_f32 v[180:181], v[180:181], v[182:183]
v_pk_add_f32 v[176:177], v[176:177], v[180:181]
buffer_store_dwordx2 v[176:177], v9, s[8:11], s36 offen sc1
Lks_npub34:
s_add_u32 m0, s26, 8192
s_add_u32 s55, s4, 256
buffer_load_dwordx4 v11, s[12:15], s55 offen lds
s_add_u32 m0, s26, 9216
s_nop 0
buffer_load_dwordx4 v12, s[12:15], s55 offen lds
s_add_u32 m0, s26, 10240
s_nop 0
buffer_load_dwordx4 v13, s[12:15], s55 offen lds
s_add_u32 m0, s26, 11264
s_nop 0
s_nop 0
buffer_load_dwordx4 v14, s[12:15], s55 offen lds
s_add_u32 m0, s26, 12288
s_add_u32 s55, s55, 65536
buffer_load_dwordx4 v11, s[12:15], s55 offen lds
s_add_u32 m0, s26, 13312
s_nop 0
buffer_load_dwordx4 v12, s[12:15], s55 offen lds
s_add_u32 m0, s26, 14336
s_nop 0
buffer_load_dwordx4 v13, s[12:15], s55 offen lds
s_add_u32 m0, s26, 15360
s_nop 0
buffer_load_dwordx4 v14, s[12:15], s55 offen lds
s_waitcnt vmcnt(16)
s_mul_i32 s21, s18, 393216
s_add_u32 s21, s21, 0xd00000
s_lshl_b32 s36, s16, 15
s_add_u32 s21, s21, s36
s_add_u32 s54, s21, 262144
s_add_u32 s21, s21, s36
s_lshl_b32 s36, s20, 12
s_add_u32 s36, s36, 0
v_add_u32 v9, s36, v5
s_lshl_b32 s36, s20, 10
s_add_u32 s36, s36, 8192
v_add_u32 v6, s36, v5
ds_read_b64_tr_b16 v[68:69], v16 offset:0
ds_read_b64_tr_b16 v[70:71], v16 offset:2048
ds_read_b64_tr_b16 v[72:73], v17 offset:0
ds_read_b64_tr_b16 v[74:75], v17 offset:2048
ds_read_b64_tr_b16 v[76:77], v18 offset:0
ds_read_b64_tr_b16 v[78:79], v18 offset:2048
ds_read_b64_tr_b16 v[80:81], v19 offset:0
ds_read_b64_tr_b16 v[82:83], v19 offset:2048
ds_read_b64_tr_b16 v[84:85], v16 offset:4096
ds_read_b64_tr_b16 v[86:87], v16 offset:6144
ds_read_b64_tr_b16 v[88:89], v17 offset:4096
ds_read_b64_tr_b16 v[90:91], v17 offset:6144
ds_read_b64_tr_b16 v[92:93], v18 offset:4096
ds_read_b64_tr_b16 v[94:95], v18 offset:6144
ds_read_b64_tr_b16 v[96:97], v19 offset:4096
ds_read_b64_tr_b16 v[98:99], v19 offset:6144
s_waitcnt lgkmcnt(8)
v_mfma_f32_16x16x32_bf16 v[148:151], a[160:163], v[68:71], 0
ds_read_b64_tr_b16 v[100:101], v16 offset:8192
ds_read_b64_tr_b16 v[102:103], v16 offset:10240
v_mfma_f32_16x16x32_bf16 v[152:155], a[160:163], v[72:75], 0
ds_read_b64_tr_b16 v[104:105], v17 offset:8192
ds_read_b64_tr_b16 v[106:107], v17 offset:10240
v_mfma_f32_16x16x32_bf16 v[156:159], a[160:163], v[76:79], 0
s_nop 0
ds_read_b64_tr_b16 v[108:109], v18 offset:8192
ds_read_b64_tr_b16 v[110:111], v18 offset:10240
v_mfma_f32_16x16x32_bf16 v[160:163], a[160:163], v[80:83], 0
ds_read_b64_tr_b16 v[112:113], v19 offset:8192
ds_read_b64_tr_b16 v[114:115], v19 offset:10240
s_waitcnt lgkmcnt(8)
v_mfma_f32_16x16x32_bf16 v[148:151], a[164:167], v[84:87], v[148:151]
ds_read_b64_tr_b16 v[68:69], v16 offset:12288
ds_read_b64_tr_b16 v[70:71], v16 offset:14336
v_mfma_f32_16x16x32_bf16 v[152:155], a[164:167], v[88:91], v[152:155]
ds_read_b64_tr_b16 v[72:73], v17 offset:12288
ds_read_b64_tr_b16 v[74:75], v17 offset:14336
v_mfma_f32_16x16x32_bf16 v[156:159], a[164:167], v[92:95], v[156:159]
s_nop 0
ds_read_b64_tr_b16 v[76:77], v18 offset:12288
ds_read_b64_tr_b16 v[78:79], v18 offset:14336
v_mfma_f32_16x16x32_bf16 v[160:163], a[164:167], v[96:99], v[160:163]
ds_read_b64_tr_b16 v[80:81], v19 offset:12288
ds_read_b64_tr_b16 v[82:83], v19 offset:14336
s_waitcnt lgkmcnt(8)
v_mfma_f32_16x16x32_bf16 v[148:151], a[168:171], v[100:103], v[148:151]
ds_read_b64_tr_b16 v[84:85], v16 offset:16384
ds_read_b64_tr_b16 v[86:87], v16 offset:18432
v_mfma_f32_16x16x32_bf16 v[152:155], a[168:171], v[104:107], v[152:155]
ds_read_b64_tr_b16 v[88:89], v17 offset:16384
ds_read_b64_tr_b16 v[90:91], v17 offset:18432
v_mfma_f32_16x16x32_bf16 v[156:159], a[168:171], v[108:111], v[156:159]
s_nop 0
ds_read_b64_tr_b16 v[92:93], v18 offset:16384
ds_read_b64_tr_b16 v[94:95], v18 offset:18432
v_mfma_f32_16x16x32_bf16 v[160:163], a[168:171], v[112:115], v[160:163]
ds_read_b64_tr_b16 v[96:97], v19 offset:16384
ds_read_b64_tr_b16 v[98:99], v19 offset:18432
s_waitcnt lgkmcnt(8)
v_mfma_f32_16x16x32_bf16 v[148:151], a[172:175], v[68:71], v[148:151]
ds_read_b64_tr_b16 v[100:101], v16 offset:20480
ds_read_b64_tr_b16 v[102:103], v16 offset:22528
v_mfma_f32_16x16x32_bf16 v[152:155], a[172:175], v[72:75], v[152:155]
ds_read_b64_tr_b16 v[104:105], v17 offset:20480
ds_read_b64_tr_b16 v[106:107], v17 offset:22528
v_mfma_f32_16x16x32_bf16 v[156:159], a[172:175], v[76:79], v[156:159]
s_nop 0
ds_read_b64_tr_b16 v[108:109], v18 offset:20480
ds_read_b64_tr_b16 v[110:111], v18 offset:22528
v_mfma_f32_16x16x32_bf16 v[160:163], a[172:175], v[80:83], v[160:163]
ds_read_b64_tr_b16 v[112:113], v19 offset:20480
ds_read_b64_tr_b16 v[114:115], v19 offset:22528
s_waitcnt lgkmcnt(8)
v_mfma_f32_16x16x32_bf16 v[148:151], a[176:179], v[84:87], v[148:151]
ds_read_b64_tr_b16 v[68:69], v16 offset:24576
ds_read_b64_tr_b16 v[70:71], v16 offset:26624
v_mfma_f32_16x16x32_bf16 v[152:155], a[176:179], v[88:91], v[152:155]
ds_read_b64_tr_b16 v[72:73], v17 offset:24576
ds_read_b64_tr_b16 v[74:75], v17 offset:26624
v_mfma_f32_16x16x32_bf16 v[156:159], a[176:179], v[92:95], v[156:159]
s_nop 0
ds_read_b64_tr_b16 v[76:77], v18 offset:24576
ds_read_b64_tr_b16 v[78:79], v18 offset:26624
v_mfma_f32_16x16x32_bf16 v[160:163], a[176:179], v[96:99], v[160:163]
ds_read_b64_tr_b16 v[80:81], v19 offset:24576
ds_read_b64_tr_b16 v[82:83], v19 offset:26624
s_waitcnt lgkmcnt(8)
s_nop 0
v_mfma_f32_16x16x32_bf16 v[148:151], a[180:183], v[100:103], v[148:151]
ds_read_b64_tr_b16 v[84:85], v16 offset:28672
ds_read_b64_tr_b16 v[86:87], v16 offset:30720
v_mfma_f32_16x16x32_bf16 v[152:155], a[180:183], v[104:107], v[152:155]
ds_read_b64_tr_b16 v[88:89], v17 offset:28672
ds_read_b64_tr_b16 v[90:91], v17 offset:30720
v_mfma_f32_16x16x32_bf16 v[156:159], a[180:183], v[108:111], v[156:159]
ds_read_b64_tr_b16 v[92:93], v18 offset:28672
ds_read_b64_tr_b16 v[94:95], v18 offset:30720
v_mfma_f32_16x16x32_bf16 v[160:163], a[180:183], v[112:115], v[160:163]
ds_read_b64_tr_b16 v[96:97], v19 offset:28672
ds_read_b64_tr_b16 v[98:99], v19 offset:30720
buffer_load_dwordx2 v[176:177], v25, s[8:11], s29 offen offset:0 sc1
buffer_load_dwordx2 v[178:179], v25, s[8:11], s29 offen offset:512 sc1
buffer_load_dwordx2 v[180:181], v25, s[8:11], s29 offen offset:1024 sc1
buffer_load_dwordx2 v[182:183], v25, s[8:11], s29 offen offset:1536 sc1
buffer_load_dwordx2 v[184:185], v25, s[8:11], s29 offen offset:2048 sc1
buffer_load_dwordx2 v[186:187], v25, s[8:11], s29 offen offset:2560 sc1
buffer_load_dwordx2 v[188:189], v25, s[8:11], s29 offen offset:3072 sc1
buffer_load_dwordx2 v[190:191], v25, s[8:11], s29 offen offset:3584 sc1
s_waitcnt lgkmcnt(8)
v_mfma_f32_16x16x32_bf16 v[148:151], a[184:187], v[68:71], v[148:151]
ds_read_b64_tr_b16 v[100:101], v16 offset:32768
ds_read_b64_tr_b16 v[102:103], v16 offset:34816
v_mfma_f32_16x16x32_bf16 v[152:155], a[184:187], v[72:75], v[152:155]
ds_read_b64_tr_b16 v[104:105], v17 offset:32768
ds_read_b64_tr_b16 v[106:107], v17 offset:34816
v_mfma_f32_16x16x32_bf16 v[156:159], a[184:187], v[76:79], v[156:159]
s_nop 0
ds_read_b64_tr_b16 v[108:109], v18 offset:32768
ds_read_b64_tr_b16 v[110:111], v18 offset:34816
v_mfma_f32_16x16x32_bf16 v[160:163], a[184:187], v[80:83], v[160:163]
ds_read_b64_tr_b16 v[112:113], v19 offset:32768
ds_read_b64_tr_b16 v[114:115], v19 offset:34816
s_waitcnt lgkmcnt(8)
v_mfma_f32_16x16x32_bf16 v[148:151], a[188:191], v[84:87], v[148:151]
ds_read_b64_tr_b16 v[68:69], v16 offset:36864
ds_read_b64_tr_b16 v[70:71], v16 offset:38912
v_mfma_f32_16x16x32_bf16 v[152:155], a[188:191], v[88:91], v[152:155]
ds_read_b64_tr_b16 v[72:73], v17 offset:36864
ds_read_b64_tr_b16 v[74:75], v17 offset:38912
v_mfma_f32_16x16x32_bf16 v[156:159], a[188:191], v[92:95], v[156:159]
s_nop 0
ds_read_b64_tr_b16 v[76:77], v18 offset:36864
ds_read_b64_tr_b16 v[78:79], v18 offset:38912
v_mfma_f32_16x16x32_bf16 v[160:163], a[188:191], v[96:99], v[160:163]
ds_read_b64_tr_b16 v[80:81], v19 offset:36864
ds_read_b64_tr_b16 v[82:83], v19 offset:38912
s_waitcnt vmcnt(16)
s_nop 0
ds_read_b128 a[0:3], v168 offset:0
ds_read_b128 a[4:7], v169 offset:0
ds_read_b128 a[8:11], v170 offset:0
ds_read_b128 a[12:15], v171 offset:0
ds_read_b128 a[16:19], v172 offset:0
ds_read_b128 a[20:23], v173 offset:0
ds_read_b128 a[24:27], v174 offset:0
ds_read_b128 a[28:31], v175 offset:0
s_waitcnt vmcnt(8)
s_nop 0
ds_read_b128 a[32:35], v168 offset:8192
ds_read_b128 a[36:39], v169 offset:8192
ds_read_b128 a[40:43], v170 offset:8192
ds_read_b128 a[44:47], v171 offset:8192
ds_read_b128 a[48:51], v172 offset:8192
ds_read_b128 a[52:55], v173 offset:8192
ds_read_b128 a[56:59], v174 offset:8192
ds_read_b128 a[60:63], v175 offset:8192
s_waitcnt lgkmcnt(15)
v_mfma_f32_16x16x32_bf16 v[148:151], a[192:195], v[100:103], v[148:151]
ds_read_b64_tr_b16 v[84:85], v20 offset:0
ds_read_b64_tr_b16 v[86:87], v20 offset:2048
v_mfma_f32_16x16x32_bf16 v[152:155], a[192:195], v[104:107], v[152:155]
ds_read_b64_tr_b16 v[88:89], v21 offset:0
ds_read_b64_tr_b16 v[90:91], v21 offset:2048
v_mfma_f32_16x16x32_bf16 v[156:159], a[192:195], v[108:111], v[156:159]
ds_read_b64_tr_b16 v[92:93], v22 offset:0
ds_read_b64_tr_b16 v[94:95], v22 offset:2048
v_mfma_f32_16x16x32_bf16 v[160:163], a[192:195], v[112:115], v[160:163]
ds_read_b64_tr_b16 v[96:97], v23 offset:0
ds_read_b64_tr_b16 v[98:99], v23 offset:2048
v_mfma_f32_16x16x32_bf16 v[148:151], a[196:199], v[68:71], v[148:151]
ds_read_b64_tr_b16 v[100:101], v20 offset:4096
ds_read_b64_tr_b16 v[102:103], v20 offset:6144
v_mfma_f32_16x16x32_bf16 v[152:155], a[196:199], v[72:75], v[152:155]
ds_read_b64_tr_b16 v[104:105], v21 offset:4096
ds_read_b64_tr_b16 v[106:107], v21 offset:6144
v_mfma_f32_16x16x32_bf16 v[156:159], a[196:199], v[76:79], v[156:159]
s_nop 0
ds_read_b64_tr_b16 v[108:109], v22 offset:4096
ds_read_b64_tr_b16 v[110:111], v22 offset:6144
v_mfma_f32_16x16x32_bf16 v[160:163], a[196:199], v[80:83], v[160:163]
ds_read_b64_tr_b16 v[112:113], v23 offset:4096
ds_read_b64_tr_b16 v[114:115], v23 offset:6144
s_waitcnt lgkmcnt(8)
v_mfma_f32_16x16x32_bf16 v[148:151], a[200:203], v[84:87], v[148:151]
s_nop 0
ds_read_b64_tr_b16 v[68:69], v20 offset:8192
ds_read_b64_tr_b16 v[70:71], v20 offset:10240
v_mfma_f32_16x16x32_bf16 v[152:155], a[200:203], v[88:91], v[152:155]
ds_read_b64_tr_b16 v[72:73], v21 offset:8192
ds_read_b64_tr_b16 v[74:75], v21 offset:10240
v_mfma_f32_16x16x32_bf16 v[156:159], a[200:203], v[92:95], v[156:159]
ds_read_b64_tr_b16 v[76:77], v22 offset:8192
ds_read_b64_tr_b16 v[78:79], v22 offset:10240
v_mfma_f32_16x16x32_bf16 v[160:163], a[200:203], v[96:99], v[160:163]
ds_read_b64_tr_b16 v[80:81], v23 offset:8192
ds_read_b64_tr_b16 v[82:83], v23 offset:10240
s_mul_i32 s30, s18, 393216
s_add_u32 s30, s30, 0xd00000
s_lshl_b32 s31, s17, 13
s_add_u32 s30, s30, s31
s_lshl_b32 s31, s20, 11
s_add_u32 s30, s30, s31
s_lshl_b32 s31, s20, 12
s_add_u32 s32, s30, s31
s_xor_b32 s31, s31, 4096
s_add_u32 s33, s30, s31
s_waitcnt vmcnt(0)
s_mov_b32 s37, 0
Lks_spoll35:
v_min_f32 v2, v177, v179
v_min3_f32 v2, v2, v181, v183
v_min3_f32 v2, v2, v185, v187
v_min3_f32 v2, v2, v189, v191
v_cmp_gt_f32 vcc, 0, v2
s_cbranch_vccz Lks_sok36
s_add_u32 s37, s37, 1
s_cmp_gt_u32 s37, 131072
s_cbranch_scc1 Lks_sok36
buffer_load_dwordx2 v[176:177], v25, s[8:11], s29 offen offset:0 sc1
buffer_load_dwordx2 v[178:179], v25, s[8:11], s29 offen offset:512 sc1
buffer_load_dwordx2 v[180:181], v25, s[8:11], s29 offen offset:1024 sc1
buffer_load_dwordx2 v[182:183], v25, s[8:11], s29 offen offset:1536 sc1
buffer_load_dwordx2 v[184:185], v25, s[8:11], s29 offen offset:2048 sc1
buffer_load_dwordx2 v[186:187], v25, s[8:11], s29 offen offset:2560 sc1
buffer_load_dwordx2 v[188:189], v25, s[8:11], s29 offen offset:3072 sc1
buffer_load_dwordx2 v[190:191], v25, s[8:11], s29 offen offset:3584 sc1
s_waitcnt vmcnt(0)
s_branch Lks_spoll35
Lks_sok36:
v_pk_add_f32 v[176:177], v[176:177], v[184:185]
v_pk_add_f32 v[178:179], v[178:179], v[186:187]
v_pk_add_f32 v[180:181], v[180:181], v[188:189]
v_pk_add_f32 v[182:183], v[182:183], v[190:191]
v_pk_add_f32 v[176:177], v[176:177], v[180:181]
v_pk_add_f32 v[178:179], v[178:179], v[182:183]
v_pk_add_f32 v[176:177], v[176:177], v[178:179]
v_mov_b32 v4, 0x3aaaaaab
v_mul_f32 v176, v4, v176
v_mul_f32 v178, v176, v176
v_fma_f32 v177, v177, v4, -v178
v_max_f32 v177, 0, v177
v_cvt_pk_bf16_f32 v178, v176, v177
v_lshlrev_b32 v176, 16, v178
v_and_b32 v177, 0xffff0000, v178
v_add_f32 v177, 0x3727c5ac, v177
v_cvt_pk_bf16_f32 v177, v177, v177
v_and_b32 v177, 0xffff0000, v177
v_sqrt_f32 v177, v177
s_nop 0
v_cvt_pk_bf16_f32 v177, v177, v177
v_and_b32 v177, 0xffff0000, v177
v_rcp_f32 v177, v177
s_nop 0
v_mul_f32 v176, v176, -v177
v_mov_b32 v184, v176
v_mov_b32 v188, v176
v_mov_b32 v185, v177
v_mov_b32 v189, v177
v_permlane32_swap_b32 v184, v188
s_nop 0
v_permlane32_swap_b32 v185, v189
v_mov_b32 v186, v184
v_mov_b32 v190, v188
v_mov_b32 v187, v185
v_mov_b32_e64 v191, v189
v_permlane16_swap_b32 v184, v186
v_permlane16_swap_b32 v188, v190
v_permlane16_swap_b32 v185, v187
v_permlane16_swap_b32 v189, v191
v_pk_fma_f32 v[116:117], v[116:117], v[184:185], v[184:185] op_sel:[0,1,0] op_sel_hi:[1,1,0]
v_pk_fma_f32 v[118:119], v[118:119], v[184:185], v[184:185] op_sel:[0,1,0] op_sel_hi:[1,1,0]
v_cvt_pk_bf16_f32 v116, v116, v117
v_cvt_pk_bf16_f32 v117, v118, v119
v_pk_fma_f32 v[120:121], v[120:121], v[186:187], v[186:187] op_sel:[0,1,0] op_sel_hi:[1,1,0]
v_pk_fma_f32 v[122:123], v[122:123], v[186:187], v[186:187] op_sel:[0,1,0] op_sel_hi:[1,1,0]
v_cvt_pk_bf16_f32 v120, v120, v121
v_cvt_pk_bf16_f32 v121, v122, v123
v_pk_fma_f32 v[124:125], v[124:125], v[188:189], v[188:189] op_sel:[0,1,0] op_sel_hi:[1,1,0]
v_pk_fma_f32 v[126:127], v[126:127], v[188:189], v[188:189] op_sel:[0,1,0] op_sel_hi:[1,1,0]
v_cvt_pk_bf16_f32 v124, v124, v125
v_cvt_pk_bf16_f32 v125, v126, v127
v_pk_fma_f32 v[128:129], v[128:129], v[190:191], v[190:191] op_sel:[0,1,0] op_sel_hi:[1,1,0]
v_pk_fma_f32 v[130:131], v[130:131], v[190:191], v[190:191] op_sel:[0,1,0] op_sel_hi:[1,1,0]
v_cvt_pk_bf16_f32 v128, v128, v129
v_cvt_pk_bf16_f32 v129, v130, v131
ds_write_b64 v26, v[116:117] offset:0
ds_write_b64 v26, v[120:121] offset:512
ds_write_b64 v26, v[124:125] offset:1024
ds_write_b64 v26, v[128:129] offset:1536
ds_read_b64_tr_b16 v[116:117], v15 offset:0
ds_read_b64_tr_b16 v[118:119], v15 offset:256
ds_read_b64_tr_b16 v[120:121], v15 offset:1024
ds_read_b64_tr_b16 v[122:123], v15 offset:1280
v_pk_fma_f32 v[132:133], v[132:133], v[184:185], v[184:185] op_sel:[0,1,0] op_sel_hi:[1,1,0]
v_pk_fma_f32 v[134:135], v[134:135], v[184:185], v[184:185] op_sel:[0,1,0] op_sel_hi:[1,1,0]
v_cvt_pk_bf16_f32 v132, v132, v133
v_cvt_pk_bf16_f32 v133, v134, v135
v_pk_fma_f32 v[136:137], v[136:137], v[186:187], v[186:187] op_sel:[0,1,0] op_sel_hi:[1,1,0]
v_pk_fma_f32 v[138:139], v[138:139], v[186:187], v[186:187] op_sel:[0,1,0] op_sel_hi:[1,1,0]
v_cvt_pk_bf16_f32 v136, v136, v137
v_cvt_pk_bf16_f32 v137, v138, v139
v_pk_fma_f32 v[140:141], v[140:141], v[188:189], v[188:189] op_sel:[0,1,0] op_sel_hi:[1,1,0]
v_pk_fma_f32 v[142:143], v[142:143], v[188:189], v[188:189] op_sel:[0,1,0] op_sel_hi:[1,1,0]
v_cvt_pk_bf16_f32 v140, v140, v141
v_cvt_pk_bf16_f32 v141, v142, v143
v_pk_fma_f32 v[144:145], v[144:145], v[190:191], v[190:191] op_sel:[0,1,0] op_sel_hi:[1,1,0]
v_pk_fma_f32 v[146:147], v[146:147], v[190:191], v[190:191] op_sel:[0,1,0] op_sel_hi:[1,1,0]
v_cvt_pk_bf16_f32 v144, v144, v145
v_cvt_pk_bf16_f32 v145, v146, v147
ds_write_b64 v26, v[132:133] offset:2048
ds_write_b64 v26, v[136:137] offset:2560
ds_write_b64 v26, v[140:141] offset:3072
ds_write_b64 v26, v[144:145] offset:3584
ds_read_b64_tr_b16 v[132:133], v15 offset:2048
ds_read_b64_tr_b16 v[134:135], v15 offset:2304
ds_read_b64_tr_b16 v[136:137], v15 offset:3072
ds_read_b64_tr_b16 v[138:139], v15 offset:3328
s_waitcnt lgkmcnt(10)
buffer_store_dwordx4 v[116:119], v5, s[8:11], s32 offen offset:0 sc1
s_waitcnt lgkmcnt(8)
buffer_store_dwordx4 v[120:123], v5, s[8:11], s33 offen offset:0 sc1
s_waitcnt lgkmcnt(2)
buffer_store_dwordx4 v[132:135], v5, s[8:11], s32 offen offset:1024 sc1
s_waitcnt lgkmcnt(0)
buffer_store_dwordx4 v[136:139], v5, s[8:11], s33 offen offset:1024 sc1
s_lshl_b32 s30, s18, 5
s_add_u32 s31, s30, s17
s_lshl_b32 s31, s31, 7
s_add_u32 s31, s31, 0x9b8000
s_lshl_b32 s5, s16, 3
s_add_u32 s5, s5, s30
s_lshl_b32 s5, s5, 7
s_add_u32 s5, s5, 0x9b8000
v_and_b32 v2, 7, v1
v_lshlrev_b32 v51, 7, v2
v_min_u32 v2, 4, v2
v_lshlrev_b32 v50, 7, v2
v_mfma_f32_16x16x32_bf16 v[148:151], a[204:207], v[100:103], v[148:151]
ds_read_b64_tr_b16 v[84:85], v20 offset:12288
ds_read_b64_tr_b16 v[86:87], v20 offset:14336
v_mfma_f32_16x16x32_bf16 v[152:155], a[204:207], v[104:107], v[152:155]
ds_read_b64_tr_b16 v[88:89], v21 offset:12288
ds_read_b64_tr_b16 v[90:91], v21 offset:14336
v_mfma_f32_16x16x32_bf16 v[156:159], a[204:207], v[108:111], v[156:159]
ds_read_b64_tr_b16 v[92:93], v22 offset:12288
ds_read_b64_tr_b16 v[94:95], v22 offset:14336
v_mfma_f32_16x16x32_bf16 v[160:163], a[204:207], v[112:115], v[160:163]
ds_read_b64_tr_b16 v[96:97], v23 offset:12288
ds_read_b64_tr_b16 v[98:99], v23 offset:14336
v_mfma_f32_16x16x32_bf16 v[148:151], a[208:211], v[68:71], v[148:151]
ds_read_b64_tr_b16 v[100:101], v20 offset:16384
ds_read_b64_tr_b16 v[102:103], v20 offset:18432
v_mfma_f32_16x16x32_bf16 v[152:155], a[208:211], v[72:75], v[152:155]
ds_read_b64_tr_b16 v[104:105], v21 offset:16384
ds_read_b64_tr_b16 v[106:107], v21 offset:18432
v_mfma_f32_16x16x32_bf16 v[156:159], a[208:211], v[76:79], v[156:159]
ds_read_b64_tr_b16 v[108:109], v22 offset:16384
ds_read_b64_tr_b16 v[110:111], v22 offset:18432
v_mfma_f32_16x16x32_bf16 v[160:163], a[208:211], v[80:83], v[160:163]
ds_read_b64_tr_b16 v[112:113], v23 offset:16384
ds_read_b64_tr_b16 v[114:115], v23 offset:18432
s_waitcnt lgkmcnt(0)
s_add_u32 m0, s26, 0
s_add_u32 s55, s28, 512
v_mfma_f32_16x16x32_bf16 v[148:151], a[212:215], v[84:87], v[148:151]
buffer_load_dwordx4 v11, s[12:15], s55 offen lds
ds_read_b64_tr_b16 v[68:69], v20 offset:20480
ds_read_b64_tr_b16 v[70:71], v20 offset:22528
s_add_u32 m0, s26, 1024
v_mfma_f32_16x16x32_bf16 v[152:155], a[212:215], v[88:91], v[152:155]
buffer_load_dwordx4 v12, s[12:15], s55 offen lds
ds_read_b64_tr_b16 v[72:73], v21 offset:20480
ds_read_b64_tr_b16 v[74:75], v21 offset:22528
v_mfma_f32_16x16x32_bf16 v[156:159], a[212:215], v[92:95], v[156:159]
ds_read_b64_tr_b16 v[76:77], v22 offset:20480
ds_read_b64_tr_b16 v[78:79], v22 offset:22528
s_add_u32 m0, s26, 2048
v_mfma_f32_16x16x32_bf16 v[160:163], a[212:215], v[96:99], v[160:163]
buffer_load_dwordx4 v13, s[12:15], s55 offen lds
ds_read_b64_tr_b16 v[80:81], v23 offset:20480
ds_read_b64_tr_b16 v[82:83], v23 offset:22528
s_add_u32 m0, s26, 3072
v_mfma_f32_16x16x32_bf16 v[148:151], a[216:219], v[100:103], v[148:151]
buffer_load_dwordx4 v14, s[12:15], s55 offen lds
ds_read_b64_tr_b16 v[84:85], v20 offset:24576
ds_read_b64_tr_b16 v[86:87], v20 offset:26624
v_mfma_f32_16x16x32_bf16 v[152:155], a[216:219], v[104:107], v[152:155]
ds_read_b64_tr_b16 v[88:89], v21 offset:24576
ds_read_b64_tr_b16 v[90:91], v21 offset:26624
s_add_u32 m0, s26, 4096
s_add_u32 s55, s55, 65536
v_mfma_f32_16x16x32_bf16 v[156:159], a[216:219], v[108:111], v[156:159]
buffer_load_dwordx4 v11, s[12:15], s55 offen lds
ds_read_b64_tr_b16 v[92:93], v22 offset:24576
ds_read_b64_tr_b16 v[94:95], v22 offset:26624
s_add_u32 m0, s26, 5120
v_mfma_f32_16x16x32_bf16 v[160:163], a[216:219], v[112:115], v[160:163]
buffer_load_dwordx4 v12, s[12:15], s55 offen lds
ds_read_b64_tr_b16 v[96:97], v23 offset:24576
ds_read_b64_tr_b16 v[98:99], v23 offset:26624
s_waitcnt lgkmcnt(8)
v_mfma_f32_16x16x32_bf16 v[148:151], a[220:223], v[68:71], v[148:151]
s_nop 0
ds_read_b64_tr_b16 v[100:101], v20 offset:28672
ds_read_b64_tr_b16 v[102:103], v20 offset:30720
s_add_u32 m0, s26, 6144
v_mfma_f32_16x16x32_bf16 v[152:155], a[220:223], v[72:75], v[152:155]
buffer_load_dwordx4 v13, s[12:15], s55 offen lds
ds_read_b64_tr_b16 v[104:105], v21 offset:28672
ds_read_b64_tr_b16 v[106:107], v21 offset:30720
s_add_u32 m0, s26, 7168
v_mfma_f32_16x16x32_bf16 v[156:159], a[220:223], v[76:79], v[156:159]
buffer_load_dwordx4 v14, s[12:15], s55 offen lds
ds_read_b64_tr_b16 v[108:109], v22 offset:28672
ds_read_b64_tr_b16 v[110:111], v22 offset:30720
v_mfma_f32_16x16x32_bf16 v[160:163], a[220:223], v[80:83], v[160:163]
ds_read_b64_tr_b16 v[112:113], v23 offset:28672
ds_read_b64_tr_b16 v[114:115], v23 offset:30720
s_waitcnt lgkmcnt(8)
s_nop 0
s_add_u32 m0, s26, 8192
s_add_u32 s55, s4, 512
v_mfma_f32_16x16x32_bf16 v[148:151], a[224:227], v[84:87], v[148:151]
buffer_load_dwordx4 v11, s[12:15], s55 offen lds
ds_read_b64_tr_b16 v[68:69], v20 offset:32768
ds_read_b64_tr_b16 v[70:71], v20 offset:34816
s_add_u32 m0, s26, 9216
v_mfma_f32_16x16x32_bf16 v[152:155], a[224:227], v[88:91], v[152:155]
buffer_load_dwordx4 v12, s[12:15], s55 offen lds
ds_read_b64_tr_b16 v[72:73], v21 offset:32768
ds_read_b64_tr_b16 v[74:75], v21 offset:34816
v_mfma_f32_16x16x32_bf16 v[156:159], a[224:227], v[92:95], v[156:159]
ds_read_b64_tr_b16 v[76:77], v22 offset:32768
ds_read_b64_tr_b16 v[78:79], v22 offset:34816
s_add_u32 m0, s26, 10240
v_mfma_f32_16x16x32_bf16 v[160:163], a[224:227], v[96:99], v[160:163]
buffer_load_dwordx4 v13, s[12:15], s55 offen lds
ds_read_b64_tr_b16 v[80:81], v23 offset:32768
ds_read_b64_tr_b16 v[82:83], v23 offset:34816
s_waitcnt vmcnt(11)
s_barrier
s_cmp_lg_u32 s16, 0
s_cbranch_scc1 Lks_sig37
v_mov_b32 v2, 0
v_mov_b32_e64 v3, s6
s_mov_b64 exec, 1
buffer_store_dword v3, v2, s[8:11], s31 offen sc1
s_mov_b64 exec, -1
Lks_sig37:
s_waitcnt lgkmcnt(8)
s_add_u32 m0, s26, 11264
v_mfma_f32_16x16x32_bf16 v[148:151], a[228:231], v[100:103], v[148:151]
buffer_load_dwordx4 v14, s[12:15], s55 offen lds
ds_read_b64_tr_b16 v[84:85], v20 offset:36864
ds_read_b64_tr_b16 v[86:87], v20 offset:38912
v_mfma_f32_16x16x32_bf16 v[152:155], a[228:231], v[104:107], v[152:155]
ds_read_b64_tr_b16 v[88:89], v21 offset:36864
ds_read_b64_tr_b16 v[90:91], v21 offset:38912
s_add_u32 m0, s26, 12288
s_add_u32 s55, s55, 65536
v_mfma_f32_16x16x32_bf16 v[156:159], a[228:231], v[108:111], v[156:159]
buffer_load_dwordx4 v11, s[12:15], s55 offen lds
ds_read_b64_tr_b16 v[92:93], v22 offset:36864
ds_read_b64_tr_b16 v[94:95], v22 offset:38912
s_add_u32 m0, s26, 13312
v_mfma_f32_16x16x32_bf16 v[160:163], a[228:231], v[112:115], v[160:163]
buffer_load_dwordx4 v12, s[12:15], s55 offen lds
ds_read_b64_tr_b16 v[96:97], v23 offset:36864
ds_read_b64_tr_b16 v[98:99], v23 offset:38912
s_waitcnt lgkmcnt(8)
v_mfma_f32_16x16x32_bf16 v[148:151], a[232:235], v[68:71], v[148:151]
s_add_u32 m0, s26, 14336
v_mfma_f32_16x16x32_bf16 v[152:155], a[232:235], v[72:75], v[152:155]
buffer_load_dwordx4 v13, s[12:15], s55 offen lds
s_add_u32 m0, s26, 15360
v_mfma_f32_16x16x32_bf16 v[156:159], a[232:235], v[76:79], v[156:159]
buffer_load_dwordx4 v14, s[12:15], s55 offen lds
v_mfma_f32_16x16x32_bf16 v[160:163], a[232:235], v[80:83], v[160:163]
s_waitcnt lgkmcnt(0)
v_mfma_f32_16x16x32_bf16 v[148:151], a[236:239], v[84:87], v[148:151]
v_mfma_f32_16x16x32_bf16 v[152:155], a[236:239], v[88:91], v[152:155]
v_mfma_f32_16x16x32_bf16 v[156:159], a[236:239], v[92:95], v[156:159]
v_mfma_f32_16x16x32_bf16 v[160:163], a[236:239], v[96:99], v[160:163]
s_sub_u32 m0, s26, 69632
s_add_u32 s55, s28, 768
s_nop 2
s_nop 0
v_pk_fma_f32 v[148:149], v[36:37], v[52:53], v[148:149] op_sel_hi:[1,0,1] neg_lo:[0,1,0] neg_hi:[0,1,0]
buffer_load_dwordx4 v11, s[12:15], s55 offen lds
v_pk_fma_f32 v[150:151], v[38:39], v[52:53], v[150:151] op_sel_hi:[1,0,1] neg_lo:[0,1,0] neg_hi:[0,1,0]
v_pk_mul_f32 v[68:69], v[148:149], v[148:149]
v_pk_mul_f32 v[70:71], v[150:151], v[150:151]
s_sub_u32 m0, s26, 68608
v_pk_fma_f32 v[68:69], v[68:69], v[54:55], v[54:55] op_sel:[0,1,0] op_sel_hi:[1,1,0]
buffer_load_dwordx4 v12, s[12:15], s55 offen lds
v_pk_fma_f32 v[70:71], v[70:71], v[54:55], v[54:55] op_sel:[0,1,0] op_sel_hi:[1,1,0]
v_pk_mul_f32 v[68:69], v[68:69], v[148:149]
v_pk_mul_f32 v[70:71], v[70:71], v[150:151]
s_sub_u32 m0, s26, 67584
v_exp_f32 v68, v68
buffer_load_dwordx4 v13, s[12:15], s55 offen lds
v_exp_f32 v70, v70
v_exp_f32 v69, v69
v_exp_f32 v71, v71
s_sub_u32 m0, s26, 66560
v_pk_fma_f32 v[68:69], v[68:69], v[52:53], v[52:53] op_sel:[0,1,1] op_sel_hi:[1,1,1]
buffer_load_dwordx4 v14, s[12:15], s55 offen lds
v_pk_fma_f32 v[70:71], v[70:71], v[52:53], v[52:53] op_sel:[0,1,1] op_sel_hi:[1,1,1]
v_rcp_f32 v68, v68
v_rcp_f32 v70, v70
s_sub_u32 m0, s26, 65536
s_add_u32 s55, s55, 65536
v_rcp_f32 v69, v69
buffer_load_dwordx4 v11, s[12:15], s55 offen lds
v_rcp_f32 v71, v71
v_pk_mul_f32 v[148:149], v[148:149], v[68:69]
v_pk_mul_f32 v[150:151], v[150:151], v[70:71]
s_sub_u32 m0, s26, 64512
v_pk_fma_f32 v[152:153], v[36:37], v[56:57], v[152:153] op_sel_hi:[1,0,1] neg_lo:[0,1,0] neg_hi:[0,1,0]
buffer_load_dwordx4 v12, s[12:15], s55 offen lds
v_pk_fma_f32 v[154:155], v[38:39], v[56:57], v[154:155] op_sel_hi:[1,0,1] neg_lo:[0,1,0] neg_hi:[0,1,0]
v_pk_mul_f32 v[68:69], v[152:153], v[152:153]
v_pk_mul_f32 v[70:71], v[154:155], v[154:155]
s_sub_u32 m0, s26, 63488
v_pk_fma_f32 v[68:69], v[68:69], v[58:59], v[58:59] op_sel:[0,1,0] op_sel_hi:[1,1,0]
buffer_load_dwordx4 v13, s[12:15], s55 offen lds
v_pk_fma_f32 v[70:71], v[70:71], v[58:59], v[58:59] op_sel:[0,1,0] op_sel_hi:[1,1,0]
v_pk_mul_f32 v[68:69], v[68:69], v[152:153]
v_pk_mul_f32 v[70:71], v[70:71], v[154:155]
s_sub_u32 m0, s26, 62464
v_exp_f32 v68, v68
buffer_load_dwordx4 v14, s[12:15], s55 offen lds
v_exp_f32 v70, v70
v_exp_f32 v69, v69
v_exp_f32 v71, v71
s_sub_u32 m0, s26, 61440
s_add_u32 s55, s4, 768
v_pk_fma_f32 v[68:69], v[68:69], v[56:57], v[56:57] op_sel:[0,1,1] op_sel_hi:[1,1,1]
buffer_load_dwordx4 v11, s[12:15], s55 offen lds
v_pk_fma_f32 v[70:71], v[70:71], v[56:57], v[56:57] op_sel:[0,1,1] op_sel_hi:[1,1,1]
v_rcp_f32 v68, v68
v_rcp_f32 v70, v70
s_sub_u32 m0, s26, 60416
v_rcp_f32 v69, v69
buffer_load_dwordx4 v12, s[12:15], s55 offen lds
v_rcp_f32 v71, v71
v_pk_mul_f32 v[152:153], v[152:153], v[68:69]
v_pk_mul_f32 v[154:155], v[154:155], v[70:71]
s_sub_u32 m0, s26, 59392
v_pk_fma_f32 v[156:157], v[36:37], v[60:61], v[156:157] op_sel_hi:[1,0,1] neg_lo:[0,1,0] neg_hi:[0,1,0]
buffer_load_dwordx4 v13, s[12:15], s55 offen lds
v_pk_fma_f32 v[158:159], v[38:39], v[60:61], v[158:159] op_sel_hi:[1,0,1] neg_lo:[0,1,0] neg_hi:[0,1,0]
v_pk_mul_f32 v[68:69], v[156:157], v[156:157]
v_pk_mul_f32 v[70:71], v[158:159], v[158:159]
s_sub_u32 m0, s26, 58368
v_pk_fma_f32 v[68:69], v[68:69], v[62:63], v[62:63] op_sel:[0,1,0] op_sel_hi:[1,1,0]
buffer_load_dwordx4 v14, s[12:15], s55 offen lds
v_pk_fma_f32 v[70:71], v[70:71], v[62:63], v[62:63] op_sel:[0,1,0] op_sel_hi:[1,1,0]
v_pk_mul_f32 v[68:69], v[68:69], v[156:157]
v_pk_mul_f32 v[70:71], v[70:71], v[158:159]
s_sub_u32 m0, s26, 57344
s_add_u32 s55, s55, 65536
v_exp_f32 v68, v68
buffer_load_dwordx4 v11, s[12:15], s55 offen lds
v_exp_f32 v70, v70
v_exp_f32 v69, v69
v_exp_f32 v71, v71
s_sub_u32 m0, s26, 56320
v_pk_fma_f32 v[68:69], v[68:69], v[60:61], v[60:61] op_sel:[0,1,1] op_sel_hi:[1,1,1]
buffer_load_dwordx4 v12, s[12:15], s55 offen lds
v_pk_fma_f32 v[70:71], v[70:71], v[60:61], v[60:61] op_sel:[0,1,1] op_sel_hi:[1,1,1]
v_rcp_f32 v68, v68
v_rcp_f32 v70, v70
s_sub_u32 m0, s26, 55296
v_rcp_f32 v69, v69
buffer_load_dwordx4 v13, s[12:15], s55 offen lds
v_rcp_f32 v71, v71
v_pk_mul_f32 v[156:157], v[156:157], v[68:69]
v_pk_mul_f32 v[158:159], v[158:159], v[70:71]
s_sub_u32 m0, s26, 54272
v_pk_fma_f32 v[160:161], v[36:37], v[64:65], v[160:161] op_sel_hi:[1,0,1] neg_lo:[0,1,0] neg_hi:[0,1,0]
buffer_load_dwordx4 v14, s[12:15], s55 offen lds
v_pk_fma_f32 v[162:163], v[38:39], v[64:65], v[162:163] op_sel_hi:[1,0,1] neg_lo:[0,1,0] neg_hi:[0,1,0]
v_pk_mul_f32 v[68:69], v[160:161], v[160:161]
v_pk_mul_f32 v[70:71], v[162:163], v[162:163]
v_pk_fma_f32 v[68:69], v[68:69], v[66:67], v[66:67] op_sel:[0,1,0] op_sel_hi:[1,1,0]
v_pk_fma_f32 v[70:71], v[70:71], v[66:67], v[66:67] op_sel:[0,1,0] op_sel_hi:[1,1,0]
v_pk_mul_f32 v[68:69], v[68:69], v[160:161]
v_pk_mul_f32 v[70:71], v[70:71], v[162:163]
v_exp_f32 v68, v68
v_exp_f32 v70, v70
v_exp_f32 v69, v69
v_exp_f32 v71, v71
v_pk_fma_f32 v[68:69], v[68:69], v[64:65], v[64:65] op_sel:[0,1,1] op_sel_hi:[1,1,1]
v_pk_fma_f32 v[70:71], v[70:71], v[64:65], v[64:65] op_sel:[0,1,1] op_sel_hi:[1,1,1]
v_rcp_f32 v68, v68
v_rcp_f32 v70, v70
v_rcp_f32 v69, v69
v_rcp_f32 v71, v71
v_pk_mul_f32 v[160:161], v[160:161], v[68:69]
v_pk_mul_f32 v[162:163], v[162:163], v[70:71]
s_lshl_b32 s34, s20, 3
s_add_u32 s34, s34, 147456
s_mul_i32 s36, s20, 6144
s_add_u32 s36, s36, s34
s_mul_i32 s35, s20, 12288
s_sub_u32 s35, s36, s35
v_add_u32 v2, s36, v5
v_add_u32_e64 v3, s35, v5
v_cvt_pk_bf16_f32 v148, v148, v149
v_cvt_pk_bf16_f32 v149, v150, v151
ds_write_b64 v2, v[148:149] offset:0
v_cvt_pk_bf16_f32 v152, v152, v153
v_cvt_pk_bf16_f32 v153, v154, v155
ds_write_b64 v2, v[152:153] offset:3072
v_cvt_pk_bf16_f32 v156, v156, v157
v_cvt_pk_bf16_f32 v157, v158, v159
ds_write_b64 v3, v[156:157] offset:6144
v_cvt_pk_bf16_f32 v160, v160, v161
v_cvt_pk_bf16_f32 v161, v162, v163
ds_write_b64 v3, v[160:161] offset:9216
s_waitcnt lgkmcnt(0)
buffer_load_dword v4, v50, s[8:11], s5 offen sc1
s_barrier
ds_read_b128 v[132:135], v9 offset:0
ds_read_b128 v[136:139], v9 offset:1024
ds_read_b128 v[140:143], v9 offset:2048
ds_read_b128 v[144:147], v9 offset:3072
ds_read_b128 v[32:35], v6
s_waitcnt lgkmcnt(0)
s_nop 0
v_pk_fma_f32 v[132:133], v[32:33], v[52:53], v[132:133] op_sel_hi:[1,0,1] neg_lo:[0,1,0] neg_hi:[0,1,0]
v_pk_fma_f32 v[134:135], v[34:35], v[52:53], v[134:135] op_sel_hi:[1,0,1] neg_lo:[0,1,0] neg_hi:[0,1,0]
v_pk_mul_f32 v[68:69], v[132:133], v[132:133]
v_pk_mul_f32 v[70:71], v[134:135], v[134:135]
v_pk_fma_f32 v[68:69], v[68:69], v[54:55], v[54:55] op_sel:[0,1,0] op_sel_hi:[1,1,0]
v_pk_fma_f32 v[70:71], v[70:71], v[54:55], v[54:55] op_sel:[0,1,0] op_sel_hi:[1,1,0]
v_pk_mul_f32 v[68:69], v[68:69], v[132:133]
v_pk_mul_f32 v[70:71], v[70:71], v[134:135]
v_exp_f32 v68, v68
v_exp_f32 v70, v70
v_exp_f32 v69, v69
v_exp_f32 v71, v71
v_pk_fma_f32 v[68:69], v[68:69], v[52:53], v[52:53] op_sel:[0,1,1] op_sel_hi:[1,1,1]
v_pk_fma_f32 v[70:71], v[70:71], v[52:53], v[52:53] op_sel:[0,1,1] op_sel_hi:[1,1,1]
v_rcp_f32 v68, v68
v_rcp_f32 v70, v70
v_rcp_f32 v69, v69
v_rcp_f32 v71, v71
v_pk_mul_f32 v[132:133], v[132:133], v[68:69]
v_pk_mul_f32 v[134:135], v[134:135], v[70:71]
v_pk_fma_f32 v[136:137], v[32:33], v[56:57], v[136:137] op_sel_hi:[1,0,1] neg_lo:[0,1,0] neg_hi:[0,1,0]
v_pk_fma_f32 v[138:139], v[34:35], v[56:57], v[138:139] op_sel_hi:[1,0,1] neg_lo:[0,1,0] neg_hi:[0,1,0]
v_pk_mul_f32 v[68:69], v[136:137], v[136:137]
v_pk_mul_f32 v[70:71], v[138:139], v[138:139]
v_pk_fma_f32 v[68:69], v[68:69], v[58:59], v[58:59] op_sel:[0,1,0] op_sel_hi:[1,1,0]
v_pk_fma_f32 v[70:71], v[70:71], v[58:59], v[58:59] op_sel:[0,1,0] op_sel_hi:[1,1,0]
v_pk_mul_f32 v[68:69], v[68:69], v[136:137]
v_pk_mul_f32 v[70:71], v[70:71], v[138:139]
v_exp_f32 v68, v68
v_exp_f32 v70, v70
v_exp_f32 v69, v69
v_exp_f32 v71, v71
v_pk_fma_f32 v[68:69], v[68:69], v[56:57], v[56:57] op_sel:[0,1,1] op_sel_hi:[1,1,1]
v_pk_fma_f32 v[70:71], v[70:71], v[56:57], v[56:57] op_sel:[0,1,1] op_sel_hi:[1,1,1]
v_rcp_f32 v68, v68
v_rcp_f32 v70, v70
v_rcp_f32 v69, v69
v_rcp_f32 v71, v71
v_pk_mul_f32 v[136:137], v[136:137], v[68:69]
v_pk_mul_f32 v[138:139], v[138:139], v[70:71]
s_waitcnt vmcnt(0)
v_cmp_ne_u32 vcc, s6, v4
s_cbranch_vccz Lks_pqo38
s_mov_b32 s37, 0
Lks_poll39:
buffer_load_dword v3, v50, s[8:11], s5 offen sc1
s_add_u32 s37, s37, 1
s_cmp_gt_u32 s37, 131072
s_cbranch_scc1 Lks_pok40
s_waitcnt vmcnt(0)
v_cmp_ne_u32_e64 vcc, s6, v3
s_cbranch_vccnz Lks_poll39
Lks_pok40:
s_waitcnt vmcnt(0)
Lks_pqo38:
s_add_u32 s56, s21, 0
buffer_load_dwordx4 v[116:119], v5, s[8:11], s56 offen offset:0 sc1
buffer_load_dwordx4 v[120:123], v5, s[8:11], s56 offen offset:1024 sc1
buffer_load_dwordx4 v[124:127], v5, s[8:11], s56 offen offset:2048 sc1
buffer_load_dwordx4 v[128:131], v5, s[8:11], s56 offen offset:3072 sc1
s_add_u32 s56, s21, 4096
v_pk_fma_f32 v[140:141], v[32:33], v[60:61], v[140:141] op_sel_hi:[1,0,1] neg_lo:[0,1,0] neg_hi:[0,1,0]
buffer_load_dwordx4 v[148:151], v5, s[8:11], s56 offen offset:0 sc1
v_pk_fma_f32 v[142:143], v[34:35], v[60:61], v[142:143] op_sel_hi:[1,0,1] neg_lo:[0,1,0] neg_hi:[0,1,0]
v_pk_mul_f32 v[68:69], v[140:141], v[140:141]
v_pk_mul_f32 v[70:71], v[142:143], v[142:143]
v_pk_fma_f32 v[68:69], v[68:69], v[62:63], v[62:63] op_sel:[0,1,0] op_sel_hi:[1,1,0]
buffer_load_dwordx4 v[152:155], v5, s[8:11], s56 offen offset:1024 sc1
v_pk_fma_f32 v[70:71], v[70:71], v[62:63], v[62:63] op_sel:[0,1,0] op_sel_hi:[1,1,0]
v_pk_mul_f32 v[68:69], v[68:69], v[140:141]
v_pk_mul_f32 v[70:71], v[70:71], v[142:143]
v_exp_f32 v68, v68
buffer_load_dwordx4 v[156:159], v5, s[8:11], s56 offen offset:2048 sc1
v_exp_f32 v70, v70
v_exp_f32 v69, v69
v_exp_f32 v71, v71
v_pk_fma_f32 v[68:69], v[68:69], v[60:61], v[60:61] op_sel:[0,1,1] op_sel_hi:[1,1,1]
buffer_load_dwordx4 v[160:163], v5, s[8:11], s56 offen offset:3072 sc1
v_pk_fma_f32 v[70:71], v[70:71], v[60:61], v[60:61] op_sel:[0,1,1] op_sel_hi:[1,1,1]
v_rcp_f32 v68, v68
v_rcp_f32 v70, v70
s_add_u32 s56, s21, 8192
v_rcp_f32 v69, v69
buffer_load_dwordx4 v[164:167], v5, s[8:11], s56 offen offset:0 sc1
v_rcp_f32 v71, v71
v_pk_mul_f32 v[140:141], v[140:141], v[68:69]
v_pk_mul_f32 v[142:143], v[142:143], v[70:71]
v_pk_fma_f32 v[144:145], v[32:33], v[64:65], v[144:145] op_sel_hi:[1,0,1] neg_lo:[0,1,0] neg_hi:[0,1,0]
buffer_load_dwordx4 v[176:179], v5, s[8:11], s56 offen offset:1024 sc1
v_pk_fma_f32 v[146:147], v[34:35], v[64:65], v[146:147] op_sel_hi:[1,0,1] neg_lo:[0,1,0] neg_hi:[0,1,0]
v_pk_mul_f32 v[68:69], v[144:145], v[144:145]
v_pk_mul_f32 v[70:71], v[146:147], v[146:147]
v_pk_fma_f32 v[68:69], v[68:69], v[66:67], v[66:67] op_sel:[0,1,0] op_sel_hi:[1,1,0]
buffer_load_dwordx4 v[180:183], v5, s[8:11], s56 offen offset:2048 sc1
v_pk_fma_f32 v[70:71], v[70:71], v[66:67], v[66:67] op_sel:[0,1,0] op_sel_hi:[1,1,0]
v_pk_mul_f32 v[68:69], v[68:69], v[144:145]
v_pk_mul_f32 v[70:71], v[70:71], v[146:147]
v_exp_f32 v68, v68
buffer_load_dwordx4 v[184:187], v5, s[8:11], s56 offen offset:3072 sc1
v_exp_f32 v70, v70
v_exp_f32 v69, v69
v_exp_f32 v71, v71
v_pk_fma_f32 v[68:69], v[68:69], v[64:65], v[64:65] op_sel:[0,1,1] op_sel_hi:[1,1,1]
v_pk_fma_f32 v[70:71], v[70:71], v[64:65], v[64:65] op_sel:[0,1,1] op_sel_hi:[1,1,1]
v_rcp_f32 v68, v68
v_rcp_f32 v70, v70
v_rcp_f32 v69, v69
v_rcp_f32 v71, v71
v_pk_mul_f32 v[144:145], v[144:145], v[68:69]
v_pk_mul_f32 v[146:147], v[146:147], v[70:71]
s_lshl_b32 s34, s20, 10
s_add_u32 s34, s34, 148488
s_mul_i32 s36, s20, 6144
s_add_u32 s36, s36, s34
s_mul_i32 s35, s20, 12288
s_sub_u32 s35, s36, s35
v_add_u32 v2, s36, v5
v_add_u32_e64 v3, s35, v5
v_cvt_pk_bf16_f32 v132, v132, v133
v_cvt_pk_bf16_f32 v133, v134, v135
ds_write_b64 v2, v[132:133] offset:0
v_cvt_pk_bf16_f32 v136, v136, v137
v_cvt_pk_bf16_f32 v137, v138, v139
ds_write_b64 v2, v[136:137] offset:3072
v_cvt_pk_bf16_f32 v140, v140, v141
v_cvt_pk_bf16_f32 v141, v142, v143
ds_write_b64 v3, v[140:141] offset:6144
v_cvt_pk_bf16_f32 v144, v144, v145
v_cvt_pk_bf16_f32 v145, v146, v147
ds_write_b64 v3, v[144:145] offset:9216
s_waitcnt lgkmcnt(0)
s_branch Lks_C
Lks_Bhi:
s_add_u32 m0, s25, 0
s_add_u32 s27, s21, 0
buffer_load_dwordx4 v10, s[8:11], s27 offen sc1 lds
s_add_u32 m0, s25, 1024
s_add_u32 s27, s21, 32768
buffer_load_dwordx4 v10, s[8:11], s27 offen sc1 lds
s_add_u32 m0, s25, 8192
s_add_u32 s27, s21, 262144
buffer_load_dwordx4 v10, s[8:11], s27 offen sc1 lds
s_add_u32 m0, s25, 9216
s_add_u32 s27, s21, 294912
buffer_load_dwordx4 v10, s[8:11], s27 offen sc1 lds
s_add_u32 m0, s25, 16384
s_add_u32 s27, s21, 524288
buffer_load_dwordx4 v10, s[8:11], s27 offen sc1 lds
s_add_u32 m0, s25, 17408
s_add_u32 s27, s21, 557056
buffer_load_dwordx4 v10, s[8:11], s27 offen sc1 lds
s_add_u32 m0, s25, 24576
s_add_u32 s27, s21, 786432
buffer_load_dwordx4 v10, s[8:11], s27 offen sc1 lds
s_add_u32 m0, s25, 25600
s_add_u32 s27, s21, 819200
buffer_load_dwordx4 v10, s[8:11], s27 offen sc1 lds
s_add_u32 m0, s25, 32768
s_add_u32 s27, s21, 1048576
buffer_load_dwordx4 v10, s[8:11], s27 offen sc1 lds
s_add_u32 m0, s25, 33792
s_add_u32 s27, s21, 1081344
buffer_load_dwordx4 v10, s[8:11], s27 offen sc1 lds
s_add_u32 m0, s25, 40960
s_add_u32 s27, s21, 1310720
buffer_load_dwordx4 v10, s[8:11], s27 offen sc1 lds
s_add_u32 m0, s25, 41984
s_add_u32 s27, s21, 1343488
buffer_load_dwordx4 v10, s[8:11], s27 offen sc1 lds
v_pk_add_f32 v[28:29], v[28:29], v[116:117]
v_pk_add_f32 v[30:31], v[30:31], v[118:119]
v_pk_add_f32 v[28:29], v[28:29], v[120:121]
v_pk_add_f32 v[30:31], v[30:31], v[122:123]
v_pk_add_f32 v[28:29], v[28:29], v[124:125]
v_pk_add_f32 v[30:31], v[30:31], v[126:127]
v_pk_add_f32 v[32:33], v[32:33], v[128:129]
v_pk_add_f32 v[34:35], v[34:35], v[130:131]
v_pk_add_f32 v[32:33], v[32:33], v[132:133]
v_pk_add_f32 v[34:35], v[34:35], v[134:135]
v_pk_add_f32 v[32:33], v[32:33], v[136:137]
v_pk_add_f32 v[34:35], v[34:35], v[138:139]
v_pk_add_f32 v[36:37], v[36:37], v[140:141]
v_pk_add_f32 v[38:39], v[38:39], v[142:143]
v_pk_add_f32 v[36:37], v[36:37], v[144:145]
v_pk_add_f32 v[38:39], v[38:39], v[146:147]
v_pk_add_f32 v[36:37], v[36:37], v[148:149]
v_pk_add_f32 v[38:39], v[38:39], v[150:151]
s_waitcnt vmcnt(10)
s_barrier
s_lshl_b32 s36, s20, 9
v_lshlrev_b32 v3, 4, v7
v_add_u32_e64 v3, s36, v3
v_xor_b32 v4, 512, v3
v_add_u32 v50, 159744, v3
v_add_u32 v51, 159744, v4
ds_read_b64_tr_b16 v[68:69], v16 offset:0
ds_read_b64_tr_b16 v[70:71], v16 offset:2048
ds_read_b64_tr_b16 v[72:73], v17 offset:0
ds_read_b64_tr_b16 v[74:75], v17 offset:2048
ds_read_b64_tr_b16 v[76:77], v18 offset:0
ds_read_b64_tr_b16 v[78:79], v18 offset:2048
ds_read_b64_tr_b16 v[80:81], v19 offset:0
ds_read_b64_tr_b16 v[82:83], v19 offset:2048
ds_read_b64_tr_b16 v[84:85], v16 offset:4096
ds_read_b64_tr_b16 v[86:87], v16 offset:6144
ds_read_b64_tr_b16 v[88:89], v17 offset:4096
ds_read_b64_tr_b16 v[90:91], v17 offset:6144
ds_read_b64_tr_b16 v[92:93], v18 offset:4096
ds_read_b64_tr_b16 v[94:95], v18 offset:6144
ds_read_b64_tr_b16 v[96:97], v19 offset:4096
ds_read_b64_tr_b16 v[98:99], v19 offset:6144
s_waitcnt lgkmcnt(8)
s_waitcnt vmcnt(6)
s_barrier
v_mfma_f32_16x16x32_bf16 v[148:151], v[164:167], v[68:71], 0
ds_read_b64_tr_b16 v[100:101], v16 offset:8192
s_add_u32 m0, s25, 49152
s_add_u32 s27, s21, 1572864
v_mfma_f32_16x16x32_bf16 v[152:155], v[68:71], v[68:71], 0
buffer_load_dwordx4 v10, s[8:11], s27 offen sc1 lds
ds_read_b64_tr_b16 v[102:103], v16 offset:10240
v_mfma_f32_16x16x32_bf16 v[156:159], v[164:167], v[72:75], 0
ds_read_b64_tr_b16 v[104:105], v17 offset:8192
s_add_u32 m0, s25, 50176
s_add_u32 s27, s21, 1605632
v_mfma_f32_16x16x32_bf16 v[160:163], v[72:75], v[72:75], 0
buffer_load_dwordx4 v10, s[8:11], s27 offen sc1 lds
ds_read_b64_tr_b16 v[106:107], v17 offset:10240
v_mfma_f32_16x16x32_bf16 v[116:119], a[0:3], v[68:71], 0
s_nop 0
ds_read_b64_tr_b16 v[108:109], v18 offset:8192
s_add_u32 m0, s25, 57344
s_add_u32 s27, s21, 1835008
v_mfma_f32_16x16x32_bf16 v[120:123], a[0:3], v[72:75], 0
buffer_load_dwordx4 v10, s[8:11], s27 offen sc1 lds
ds_read_b64_tr_b16 v[110:111], v18 offset:10240
v_mfma_f32_16x16x32_bf16 v[124:127], a[0:3], v[76:79], 0
ds_read_b64_tr_b16 v[112:113], v19 offset:8192
s_add_u32 m0, s25, 58368
s_add_u32 s27, s21, 1867776
v_mfma_f32_16x16x32_bf16 v[128:131], a[0:3], v[80:83], 0
buffer_load_dwordx4 v10, s[8:11], s27 offen sc1 lds
ds_read_b64_tr_b16 v[114:115], v19 offset:10240
s_waitcnt lgkmcnt(8)
v_mfma_f32_16x16x32_bf16 v[148:151], v[164:167], v[84:87], v[148:151]
ds_read_b64_tr_b16 v[68:69], v16 offset:12288
s_add_u32 m0, s25, 65536
s_add_u32 s27, s21, 2097152
v_mfma_f32_16x16x32_bf16 v[152:155], v[84:87], v[84:87], v[152:155]
buffer_load_dwordx4 v10, s[8:11], s27 offen sc1 lds
ds_read_b64_tr_b16 v[70:71], v16 offset:14336
v_mfma_f32_16x16x32_bf16 v[156:159], v[164:167], v[88:91], v[156:159]
ds_read_b64_tr_b16 v[72:73], v17 offset:12288
s_add_u32 m0, s25, 66560
s_add_u32 s27, s21, 2129920
v_mfma_f32_16x16x32_bf16 v[160:163], v[88:91], v[88:91], v[160:163]
buffer_load_dwordx4 v10, s[8:11], s27 offen sc1 lds
ds_read_b64_tr_b16 v[74:75], v17 offset:14336
v_mfma_f32_16x16x32_bf16 v[116:119], a[4:7], v[84:87], v[116:119]
s_nop 0
ds_read_b64_tr_b16 v[76:77], v18 offset:12288
s_add_u32 m0, s25, 73728
s_add_u32 s27, s21, 2359296
v_mfma_f32_16x16x32_bf16 v[120:123], a[4:7], v[88:91], v[120:123]
buffer_load_dwordx4 v10, s[8:11], s27 offen sc1 lds
ds_read_b64_tr_b16 v[78:79], v18 offset:14336
v_mfma_f32_16x16x32_bf16 v[124:127], a[4:7], v[92:95], v[124:127]
ds_read_b64_tr_b16 v[80:81], v19 offset:12288
s_add_u32 m0, s25, 74752
s_add_u32 s27, s21, 2392064
v_mfma_f32_16x16x32_bf16 v[128:131], a[4:7], v[96:99], v[128:131]
buffer_load_dwordx4 v10, s[8:11], s27 offen sc1 lds
ds_read_b64_tr_b16 v[82:83], v19 offset:14336
s_waitcnt lgkmcnt(8)
v_mfma_f32_16x16x32_bf16 v[148:151], v[164:167], v[100:103], v[148:151]
ds_read_b64_tr_b16 v[84:85], v16 offset:16384
s_add_u32 m0, s26, 0
s_add_u32 s55, s28, 0
v_mfma_f32_16x16x32_bf16 v[152:155], v[100:103], v[100:103], v[152:155]
buffer_load_dwordx4 v11, s[12:15], s55 offen lds
ds_read_b64_tr_b16 v[86:87], v16 offset:18432
v_mfma_f32_16x16x32_bf16 v[156:159], v[164:167], v[104:107], v[156:159]
ds_read_b64_tr_b16 v[88:89], v17 offset:16384
s_add_u32 m0, s26, 1024
v_mfma_f32_16x16x32_bf16 v[160:163], v[104:107], v[104:107], v[160:163]
buffer_load_dwordx4 v12, s[12:15], s55 offen lds
ds_read_b64_tr_b16 v[90:91], v17 offset:18432
v_mfma_f32_16x16x32_bf16 v[116:119], a[8:11], v[100:103], v[116:119]
ds_read_b64_tr_b16 v[92:93], v18 offset:16384
s_add_u32 m0, s26, 2048
v_mfma_f32_16x16x32_bf16 v[120:123], a[8:11], v[104:107], v[120:123]
buffer_load_dwordx4 v13, s[12:15], s55 offen lds
ds_read_b64_tr_b16 v[94:95], v18 offset:18432
v_mfma_f32_16x16x32_bf16 v[124:127], a[8:11], v[108:111], v[124:127]
s_nop 0
ds_read_b64_tr_b16 v[96:97], v19 offset:16384
s_add_u32 m0, s26, 3072
v_mfma_f32_16x16x32_bf16 v[128:131], a[8:11], v[112:115], v[128:131]
buffer_load_dwordx4 v14, s[12:15], s55 offen lds
ds_read_b64_tr_b16 v[98:99], v19 offset:18432
s_waitcnt lgkmcnt(8)
v_mfma_f32_16x16x32_bf16 v[148:151], v[164:167], v[68:71], v[148:151]
ds_read_b64_tr_b16 v[100:101], v16 offset:20480
s_add_u32 m0, s26, 4096
s_add_u32 s55, s55, 65536
v_mfma_f32_16x16x32_bf16 v[152:155], v[68:71], v[68:71], v[152:155]
buffer_load_dwordx4 v11, s[12:15], s55 offen lds
ds_read_b64_tr_b16 v[102:103], v16 offset:22528
v_mfma_f32_16x16x32_bf16 v[156:159], v[164:167], v[72:75], v[156:159]
ds_read_b64_tr_b16 v[104:105], v17 offset:20480
s_add_u32 m0, s26, 5120
v_mfma_f32_16x16x32_bf16 v[160:163], v[72:75], v[72:75], v[160:163]
buffer_load_dwordx4 v12, s[12:15], s55 offen lds
ds_read_b64_tr_b16 v[106:107], v17 offset:22528
v_mfma_f32_16x16x32_bf16 v[116:119], a[12:15], v[68:71], v[116:119]
ds_read_b64_tr_b16 v[108:109], v18 offset:20480
s_add_u32 m0, s26, 6144
v_mfma_f32_16x16x32_bf16 v[120:123], a[12:15], v[72:75], v[120:123]
buffer_load_dwordx4 v13, s[12:15], s55 offen lds
ds_read_b64_tr_b16 v[110:111], v18 offset:22528
v_mfma_f32_16x16x32_bf16 v[124:127], a[12:15], v[76:79], v[124:127]
s_nop 0
ds_read_b64_tr_b16 v[112:113], v19 offset:20480
s_add_u32 m0, s26, 7168
v_mfma_f32_16x16x32_bf16 v[128:131], a[12:15], v[80:83], v[128:131]
buffer_load_dwordx4 v14, s[12:15], s55 offen lds
ds_read_b64_tr_b16 v[114:115], v19 offset:22528
s_waitcnt lgkmcnt(8)
s_waitcnt vmcnt(16)
s_barrier
v_mfma_f32_16x16x32_bf16 v[148:151], v[164:167], v[84:87], v[148:151]
ds_read_b64_tr_b16 v[68:69], v16 offset:24576
v_mfma_f32_16x16x32_bf16 v[152:155], v[84:87], v[84:87], v[152:155]
ds_read_b64_tr_b16 v[70:71], v16 offset:26624
v_mfma_f32_16x16x32_bf16 v[156:159], v[164:167], v[88:91], v[156:159]
ds_read_b64_tr_b16 v[72:73], v17 offset:24576
s_add_u32 m0, s26, 8192
s_add_u32 s55, s4, 0
v_mfma_f32_16x16x32_bf16 v[160:163], v[88:91], v[88:91], v[160:163]
buffer_load_dwordx4 v11, s[12:15], s55 offen lds
ds_read_b64_tr_b16 v[74:75], v17 offset:26624
v_mfma_f32_16x16x32_bf16 v[116:119], a[16:19], v[84:87], v[116:119]
ds_read_b64_tr_b16 v[76:77], v18 offset:24576
v_mfma_f32_16x16x32_bf16 v[120:123], a[16:19], v[88:91], v[120:123]
ds_read_b64_tr_b16 v[78:79], v18 offset:26624
v_mfma_f32_16x16x32_bf16 v[124:127], a[16:19], v[92:95], v[124:127]
ds_read_b64_tr_b16 v[80:81], v19 offset:24576
s_add_u32 m0, s26, 9216
v_mfma_f32_16x16x32_bf16 v[128:131], a[16:19], v[96:99], v[128:131]
buffer_load_dwordx4 v12, s[12:15], s55 offen lds
ds_read_b64_tr_b16 v[82:83], v19 offset:26624
s_waitcnt lgkmcnt(8)
v_mfma_f32_16x16x32_bf16 v[148:151], v[164:167], v[100:103], v[148:151]
ds_read_b64_tr_b16 v[84:85], v16 offset:28672
v_mfma_f32_16x16x32_bf16 v[152:155], v[100:103], v[100:103], v[152:155]
ds_read_b64_tr_b16 v[86:87], v16 offset:30720
v_mfma_f32_16x16x32_bf16 v[156:159], v[164:167], v[104:107], v[156:159]
ds_read_b64_tr_b16 v[88:89], v17 offset:28672
s_add_u32 m0, s26, 10240
v_mfma_f32_16x16x32_bf16 v[160:163], v[104:107], v[104:107], v[160:163]
buffer_load_dwordx4 v13, s[12:15], s55 offen lds
ds_read_b64_tr_b16 v[90:91], v17 offset:30720
v_mfma_f32_16x16x32_bf16 v[116:119], a[20:23], v[100:103], v[116:119]
ds_read_b64_tr_b16 v[92:93], v18 offset:28672
v_mfma_f32_16x16x32_bf16 v[120:123], a[20:23], v[104:107], v[120:123]
ds_read_b64_tr_b16 v[94:95], v18 offset:30720
v_mfma_f32_16x16x32_bf16 v[124:127], a[20:23], v[108:111], v[124:127]
s_nop 0
ds_read_b64_tr_b16 v[96:97], v19 offset:28672
s_add_u32 m0, s26, 11264
v_mfma_f32_16x16x32_bf16 v[128:131], a[20:23], v[112:115], v[128:131]
buffer_load_dwordx4 v14, s[12:15], s55 offen lds
ds_read_b64_tr_b16 v[98:99], v19 offset:30720
s_waitcnt lgkmcnt(8)
v_mfma_f32_16x16x32_bf16 v[148:151], v[164:167], v[68:71], v[148:151]
ds_read_b64_tr_b16 v[100:101], v16 offset:32768
v_mfma_f32_16x16x32_bf16 v[152:155], v[68:71], v[68:71], v[152:155]
ds_read_b64_tr_b16 v[102:103], v16 offset:34816
v_mfma_f32_16x16x32_bf16 v[156:159], v[164:167], v[72:75], v[156:159]
ds_read_b64_tr_b16 v[104:105], v17 offset:32768
s_add_u32 m0, s26, 12288
s_add_u32 s55, s55, 65536
v_mfma_f32_16x16x32_bf16 v[160:163], v[72:75], v[72:75], v[160:163]
buffer_load_dwordx4 v11, s[12:15], s55 offen lds
ds_read_b64_tr_b16 v[106:107], v17 offset:34816
v_mfma_f32_16x16x32_bf16 v[116:119], a[24:27], v[68:71], v[116:119]
ds_read_b64_tr_b16 v[108:109], v18 offset:32768
v_mfma_f32_16x16x32_bf16 v[120:123], a[24:27], v[72:75], v[120:123]
ds_read_b64_tr_b16 v[110:111], v18 offset:34816
v_mfma_f32_16x16x32_bf16 v[124:127], a[24:27], v[76:79], v[124:127]
s_nop 0
ds_read_b64_tr_b16 v[112:113], v19 offset:32768
s_add_u32 m0, s26, 13312
v_mfma_f32_16x16x32_bf16 v[128:131], a[24:27], v[80:83], v[128:131]
buffer_load_dwordx4 v12, s[12:15], s55 offen lds
ds_read_b64_tr_b16 v[114:115], v19 offset:34816
s_waitcnt lgkmcnt(8)
v_mfma_f32_16x16x32_bf16 v[148:151], v[164:167], v[84:87], v[148:151]
ds_read_b64_tr_b16 v[68:69], v16 offset:36864
v_mfma_f32_16x16x32_bf16 v[152:155], v[84:87], v[84:87], v[152:155]
ds_read_b64_tr_b16 v[70:71], v16 offset:38912
v_mfma_f32_16x16x32_bf16 v[156:159], v[164:167], v[88:91], v[156:159]
ds_read_b64_tr_b16 v[72:73], v17 offset:36864
s_add_u32 m0, s26, 14336
v_mfma_f32_16x16x32_bf16 v[160:163], v[88:91], v[88:91], v[160:163]
buffer_load_dwordx4 v13, s[12:15], s55 offen lds
ds_read_b64_tr_b16 v[74:75], v17 offset:38912
v_mfma_f32_16x16x32_bf16 v[116:119], a[28:31], v[84:87], v[116:119]
ds_read_b64_tr_b16 v[76:77], v18 offset:36864
v_mfma_f32_16x16x32_bf16 v[120:123], a[28:31], v[88:91], v[120:123]
ds_read_b64_tr_b16 v[78:79], v18 offset:38912
v_mfma_f32_16x16x32_bf16 v[124:127], a[28:31], v[92:95], v[124:127]
s_nop 0
ds_read_b64_tr_b16 v[80:81], v19 offset:36864
s_add_u32 m0, s26, 15360
v_mfma_f32_16x16x32_bf16 v[128:131], a[28:31], v[96:99], v[128:131]
buffer_load_dwordx4 v14, s[12:15], s55 offen lds
ds_read_b64_tr_b16 v[82:83], v19 offset:38912
s_waitcnt lgkmcnt(8)
v_mfma_f32_16x16x32_bf16 v[148:151], v[164:167], v[100:103], v[148:151]
ds_read_b64_tr_b16 v[84:85], v20 offset:0
v_mfma_f32_16x16x32_bf16 v[152:155], v[100:103], v[100:103], v[152:155]
ds_read_b64_tr_b16 v[86:87], v20 offset:2048
v_mfma_f32_16x16x32_bf16 v[156:159], v[164:167], v[104:107], v[156:159]
ds_read_b64_tr_b16 v[88:89], v21 offset:0
s_add_u32 s27, s24, 0
v_mfma_f32_16x16x32_bf16 v[160:163], v[104:107], v[104:107], v[160:163]
buffer_load_dwordx4 a[160:163], v5, s[8:11], s27 offen offset:0 sc1
ds_read_b64_tr_b16 v[90:91], v21 offset:2048
v_mfma_f32_16x16x32_bf16 v[116:119], a[32:35], v[100:103], v[116:119]
ds_read_b64_tr_b16 v[92:93], v22 offset:0
v_mfma_f32_16x16x32_bf16 v[120:123], a[32:35], v[104:107], v[120:123]
ds_read_b64_tr_b16 v[94:95], v22 offset:2048
v_mfma_f32_16x16x32_bf16 v[124:127], a[32:35], v[108:111], v[124:127]
ds_read_b64_tr_b16 v[96:97], v23 offset:0
v_mfma_f32_16x16x32_bf16 v[128:131], a[32:35], v[112:115], v[128:131]
buffer_load_dwordx4 a[164:167], v5, s[8:11], s27 offen offset:1024 sc1
ds_read_b64_tr_b16 v[98:99], v23 offset:2048
s_waitcnt lgkmcnt(8)
v_mfma_f32_16x16x32_bf16 v[148:151], v[164:167], v[68:71], v[148:151]
ds_read_b64_tr_b16 v[100:101], v20 offset:4096
v_mfma_f32_16x16x32_bf16 v[152:155], v[68:71], v[68:71], v[152:155]
ds_read_b64_tr_b16 v[102:103], v20 offset:6144
v_mfma_f32_16x16x32_bf16 v[156:159], v[164:167], v[72:75], v[156:159]
ds_read_b64_tr_b16 v[104:105], v21 offset:4096
v_mfma_f32_16x16x32_bf16 v[160:163], v[72:75], v[72:75], v[160:163]
buffer_load_dwordx4 a[168:171], v5, s[8:11], s27 offen offset:2048 sc1
ds_read_b64_tr_b16 v[106:107], v21 offset:6144
v_mfma_f32_16x16x32_bf16 v[116:119], a[36:39], v[68:71], v[116:119]
ds_read_b64_tr_b16 v[108:109], v22 offset:4096
v_mfma_f32_16x16x32_bf16 v[120:123], a[36:39], v[72:75], v[120:123]
ds_read_b64_tr_b16 v[110:111], v22 offset:6144
v_mfma_f32_16x16x32_bf16 v[124:127], a[36:39], v[76:79], v[124:127]
ds_read_b64_tr_b16 v[112:113], v23 offset:4096
v_mfma_f32_16x16x32_bf16 v[128:131], a[36:39], v[80:83], v[128:131]
buffer_load_dwordx4 a[172:175], v5, s[8:11], s27 offen offset:3072 sc1
ds_read_b64_tr_b16 v[114:115], v23 offset:6144
s_waitcnt lgkmcnt(8)
s_waitcnt vmcnt(20)
s_barrier
v_mfma_f32_16x16x32_bf16 v[148:151], v[164:167], v[84:87], v[148:151]
ds_read_b64_tr_b16 v[68:69], v20 offset:8192
v_mfma_f32_16x16x32_bf16 v[152:155], v[84:87], v[84:87], v[152:155]
ds_read_b64_tr_b16 v[70:71], v20 offset:10240
v_mfma_f32_16x16x32_bf16 v[156:159], v[164:167], v[88:91], v[156:159]
ds_read_b64_tr_b16 v[72:73], v21 offset:8192
s_add_u32 s27, s24, 4096
v_mfma_f32_16x16x32_bf16 v[160:163], v[88:91], v[88:91], v[160:163]
buffer_load_dwordx4 a[176:179], v5, s[8:11], s27 offen offset:0 sc1
ds_read_b64_tr_b16 v[74:75], v21 offset:10240
v_mfma_f32_16x16x32_bf16 v[116:119], a[40:43], v[84:87], v[116:119]
ds_read_b64_tr_b16 v[76:77], v20 offset:12288
v_mfma_f32_16x16x32_bf16 v[120:123], a[40:43], v[88:91], v[120:123]
ds_read_b64_tr_b16 v[78:79], v20 offset:14336
v_mfma_f32_16x16x32_bf16 v[124:127], a[40:43], v[92:95], v[124:127]
ds_read_b64_tr_b16 v[80:81], v21 offset:12288
v_mfma_f32_16x16x32_bf16 v[128:131], a[40:43], v[96:99], v[128:131]
buffer_load_dwordx4 a[180:183], v5, s[8:11], s27 offen offset:1024 sc1
ds_read_b64_tr_b16 v[82:83], v21 offset:14336
s_waitcnt lgkmcnt(8)
v_mfma_f32_16x16x32_bf16 v[148:151], v[164:167], v[100:103], v[148:151]
ds_read_b64_tr_b16 v[84:85], v20 offset:16384
v_mfma_f32_16x16x32_bf16 v[152:155], v[100:103], v[100:103], v[152:155]
ds_read_b64_tr_b16 v[86:87], v20 offset:18432
v_mfma_f32_16x16x32_bf16 v[156:159], v[164:167], v[104:107], v[156:159]
ds_read_b64_tr_b16 v[88:89], v21 offset:16384
v_mfma_f32_16x16x32_bf16 v[160:163], v[104:107], v[104:107], v[160:163]
buffer_load_dwordx4 a[184:187], v5, s[8:11], s27 offen offset:2048 sc1
ds_read_b64_tr_b16 v[90:91], v21 offset:18432
v_mfma_f32_16x16x32_bf16 v[116:119], a[44:47], v[100:103], v[116:119]
ds_read_b64_tr_b16 v[92:93], v20 offset:20480
v_mfma_f32_16x16x32_bf16 v[120:123], a[44:47], v[104:107], v[120:123]
ds_read_b64_tr_b16 v[94:95], v20 offset:22528
v_mfma_f32_16x16x32_bf16 v[124:127], a[44:47], v[108:111], v[124:127]
ds_read_b64_tr_b16 v[96:97], v21 offset:20480
v_mfma_f32_16x16x32_bf16 v[128:131], a[44:47], v[112:115], v[128:131]
buffer_load_dwordx4 a[188:191], v5, s[8:11], s27 offen offset:3072 sc1
ds_read_b64_tr_b16 v[98:99], v21 offset:22528
s_waitcnt lgkmcnt(8)
v_mfma_f32_16x16x32_bf16 v[148:151], v[164:167], v[68:71], v[148:151]
ds_read_b64_tr_b16 v[100:101], v20 offset:24576
v_mfma_f32_16x16x32_bf16 v[152:155], v[68:71], v[68:71], v[152:155]
ds_read_b64_tr_b16 v[102:103], v20 offset:26624
v_mfma_f32_16x16x32_bf16 v[156:159], v[164:167], v[72:75], v[156:159]
ds_read_b64_tr_b16 v[104:105], v21 offset:24576
s_add_u32 s27, s24, 8192
v_mfma_f32_16x16x32_bf16 v[160:163], v[72:75], v[72:75], v[160:163]
buffer_load_dwordx4 a[192:195], v5, s[8:11], s27 offen offset:0 sc1
ds_read_b64_tr_b16 v[106:107], v21 offset:26624
v_mfma_f32_16x16x32_bf16 v[148:151], v[164:167], v[76:79], v[148:151]
ds_read_b64_tr_b16 v[108:109], v20 offset:28672
v_mfma_f32_16x16x32_bf16 v[152:155], v[76:79], v[76:79], v[152:155]
ds_read_b64_tr_b16 v[110:111], v20 offset:30720
v_mfma_f32_16x16x32_bf16 v[156:159], v[164:167], v[80:83], v[156:159]
ds_read_b64_tr_b16 v[112:113], v21 offset:28672
v_mfma_f32_16x16x32_bf16 v[160:163], v[80:83], v[80:83], v[160:163]
buffer_load_dwordx4 a[196:199], v5, s[8:11], s27 offen offset:1024 sc1
ds_read_b64_tr_b16 v[114:115], v21 offset:30720
s_waitcnt lgkmcnt(8)
v_mfma_f32_16x16x32_bf16 v[148:151], v[164:167], v[84:87], v[148:151]
ds_read_b64_tr_b16 v[68:69], v20 offset:32768
v_mfma_f32_16x16x32_bf16 v[152:155], v[84:87], v[84:87], v[152:155]
ds_read_b64_tr_b16 v[70:71], v20 offset:34816
v_mfma_f32_16x16x32_bf16 v[156:159], v[164:167], v[88:91], v[156:159]
ds_read_b64_tr_b16 v[72:73], v21 offset:32768
v_mfma_f32_16x16x32_bf16 v[160:163], v[88:91], v[88:91], v[160:163]
buffer_load_dwordx4 a[200:203], v5, s[8:11], s27 offen offset:2048 sc1
ds_read_b64_tr_b16 v[74:75], v21 offset:34816
v_mfma_f32_16x16x32_bf16 v[148:151], v[164:167], v[92:95], v[148:151]
ds_read_b64_tr_b16 v[76:77], v20 offset:36864
v_mfma_f32_16x16x32_bf16 v[152:155], v[92:95], v[92:95], v[152:155]
ds_read_b64_tr_b16 v[78:79], v20 offset:38912
v_mfma_f32_16x16x32_bf16 v[156:159], v[164:167], v[96:99], v[156:159]
ds_read_b64_tr_b16 v[80:81], v21 offset:36864
v_mfma_f32_16x16x32_bf16 v[160:163], v[96:99], v[96:99], v[160:163]
buffer_load_dwordx4 a[204:207], v5, s[8:11], s27 offen offset:3072 sc1
ds_read_b64_tr_b16 v[82:83], v21 offset:38912
s_waitcnt lgkmcnt(8)
v_mfma_f32_16x16x32_bf16 v[148:151], v[164:167], v[100:103], v[148:151]
ds_read_b64_tr_b16 v[84:85], v20 offset:8192
v_mfma_f32_16x16x32_bf16 v[152:155], v[100:103], v[100:103], v[152:155]
ds_read_b64_tr_b16 v[86:87], v20 offset:10240
v_mfma_f32_16x16x32_bf16 v[156:159], v[164:167], v[104:107], v[156:159]
ds_read_b64_tr_b16 v[88:89], v21 offset:8192
s_add_u32 s27, s24, 12288
v_mfma_f32_16x16x32_bf16 v[160:163], v[104:107], v[104:107], v[160:163]
buffer_load_dwordx4 a[208:211], v5, s[8:11], s27 offen offset:0 sc1
ds_read_b64_tr_b16 v[90:91], v21 offset:10240
v_mfma_f32_16x16x32_bf16 v[148:151], v[164:167], v[108:111], v[148:151]
ds_read_b64_tr_b16 v[92:93], v22 offset:8192
v_mfma_f32_16x16x32_bf16 v[152:155], v[108:111], v[108:111], v[152:155]
ds_read_b64_tr_b16 v[94:95], v22 offset:10240
v_mfma_f32_16x16x32_bf16 v[156:159], v[164:167], v[112:115], v[156:159]
ds_read_b64_tr_b16 v[96:97], v23 offset:8192
v_mfma_f32_16x16x32_bf16 v[160:163], v[112:115], v[112:115], v[160:163]
buffer_load_dwordx4 a[212:215], v5, s[8:11], s27 offen offset:1024 sc1
ds_read_b64_tr_b16 v[98:99], v23 offset:10240
s_waitcnt lgkmcnt(8)
v_mfma_f32_16x16x32_bf16 v[148:151], v[164:167], v[68:71], v[148:151]
ds_read_b64_tr_b16 v[100:101], v20 offset:12288
v_mfma_f32_16x16x32_bf16 v[152:155], v[68:71], v[68:71], v[152:155]
ds_read_b64_tr_b16 v[102:103], v20 offset:14336
v_mfma_f32_16x16x32_bf16 v[156:159], v[164:167], v[72:75], v[156:159]
ds_read_b64_tr_b16 v[104:105], v21 offset:12288
v_mfma_f32_16x16x32_bf16 v[160:163], v[72:75], v[72:75], v[160:163]
buffer_load_dwordx4 a[216:219], v5, s[8:11], s27 offen offset:2048 sc1
ds_read_b64_tr_b16 v[106:107], v21 offset:14336
v_mfma_f32_16x16x32_bf16 v[148:151], v[164:167], v[76:79], v[148:151]
ds_read_b64_tr_b16 v[108:109], v22 offset:12288
v_mfma_f32_16x16x32_bf16 v[152:155], v[76:79], v[76:79], v[152:155]
ds_read_b64_tr_b16 v[110:111], v22 offset:14336
v_mfma_f32_16x16x32_bf16 v[156:159], v[164:167], v[80:83], v[156:159]
ds_read_b64_tr_b16 v[112:113], v23 offset:12288
v_mfma_f32_16x16x32_bf16 v[160:163], v[80:83], v[80:83], v[160:163]
buffer_load_dwordx4 a[220:223], v5, s[8:11], s27 offen offset:3072 sc1
ds_read_b64_tr_b16 v[114:115], v23 offset:14336
v_and_b32 v2, 3, v1
v_cmp_eq_u32_e64 vcc, 1, v2
v_cmp_eq_u32 s[30:31], 2, v2
v_cmp_eq_u32 s[32:33], 3, v2
v_mov_b32 v6, 0x3acccccd
v_cndmask_b32 v152, v152, v153, vcc
v_cndmask_b32 v160, v160, v161, vcc
v_cndmask_b32 v152, v152, v154, s[30:31]
v_cndmask_b32 v160, v160, v162, s[30:31]
v_cndmask_b32 v152, v152, v155, s[32:33]
v_cndmask_b32 v160, v160, v163, s[32:33]
v_mul_f32 v148, v6, v148
v_mul_f32 v156, v6, v156
v_mul_f32 v149, v148, v148
v_mul_f32 v157, v156, v156
v_fma_f32 v149, v152, v6, -v149
v_fma_f32 v157, v160, v6, -v157
v_max_f32 v149, 0, v149
v_max_f32 v157, 0, v157
v_cvt_pk_bf16_f32 v150, v148, v149
v_cvt_pk_bf16_f32 v158, v156, v157
v_lshlrev_b32 v148, 16, v150
v_lshlrev_b32 v156, 16, v158
v_and_b32 v149, 0xffff0000, v150
v_and_b32 v157, 0xffff0000, v158
v_add_f32 v149, 0x3727c5ac, v149
v_add_f32 v157, 0x3727c5ac, v157
v_cvt_pk_bf16_f32 v149, v149, v149
v_cvt_pk_bf16_f32 v157, v157, v157
v_and_b32 v149, 0xffff0000, v149
v_and_b32 v157, 0xffff0000, v157
v_sqrt_f32 v149, v149
v_sqrt_f32 v157, v157
v_cvt_pk_bf16_f32 v149, v149, v149
v_cvt_pk_bf16_f32 v157, v157, v157
v_and_b32 v149, 0xffff0000, v149
v_and_b32 v157, 0xffff0000, v157
v_rcp_f32 v152, v149
v_rcp_f32 v160, v157
v_mul_f32 v150, 0xc0135761, v152
v_mul_f32 v158, 0xc0135761, v160
v_mul_f32 v151, v152, v152
v_mul_f32 v159, v160, v160
v_mul_f32 v151, v151, v152
v_mul_f32 v159, v159, v160
v_mul_f32 v151, 0xbdd2d3e8, v151
v_mul_f32 v159, 0xbdd2d3e8, v159
s_mov_b32 exec_lo, 0x00f0000f
s_mov_b32 exec_hi, 0xf0000f00
ds_write_b128 v50, v[148:151] offset:0
ds_write_b128 v50, v[156:159] offset:256
s_mov_b64 exec, -1
s_waitcnt lgkmcnt(10)
v_mfma_f32_16x16x32_bf16 v[116:119], a[48:51], v[84:87], v[116:119]
ds_read_b64_tr_b16 v[68:69], v20 offset:16384
ds_read_b64_tr_b16 v[70:71], v20 offset:18432
v_mfma_f32_16x16x32_bf16 v[120:123], a[48:51], v[88:91], v[120:123]
ds_read_b64_tr_b16 v[72:73], v21 offset:16384
ds_read_b64_tr_b16 v[74:75], v21 offset:18432
v_mfma_f32_16x16x32_bf16 v[124:127], a[48:51], v[92:95], v[124:127]
ds_read_b64_tr_b16 v[76:77], v22 offset:16384
ds_read_b64_tr_b16 v[78:79], v22 offset:18432
s_add_u32 s27, s24, 16384
v_mfma_f32_16x16x32_bf16 v[128:131], a[48:51], v[96:99], v[128:131]
buffer_load_dwordx4 a[224:227], v5, s[8:11], s27 offen offset:0 sc1
ds_read_b64_tr_b16 v[80:81], v23 offset:16384
ds_read_b64_tr_b16 v[82:83], v23 offset:18432
s_waitcnt lgkmcnt(10)
v_mfma_f32_16x16x32_bf16 v[116:119], a[52:55], v[100:103], v[116:119]
ds_read_b64_tr_b16 v[84:85], v20 offset:20480
ds_read_b64_tr_b16 v[86:87], v20 offset:22528
v_mfma_f32_16x16x32_bf16 v[120:123], a[52:55], v[104:107], v[120:123]
s_nop 0
ds_read_b64_tr_b16 v[88:89], v21 offset:20480
ds_read_b64_tr_b16 v[90:91], v21 offset:22528
v_mfma_f32_16x16x32_bf16 v[124:127], a[52:55], v[108:111], v[124:127]
ds_read_b64_tr_b16 v[92:93], v22 offset:20480
ds_read_b64_tr_b16 v[94:95], v22 offset:22528
v_mfma_f32_16x16x32_bf16 v[128:131], a[52:55], v[112:115], v[128:131]
buffer_load_dwordx4 a[228:231], v5, s[8:11], s27 offen offset:1024 sc1
ds_read_b64_tr_b16 v[96:97], v23 offset:20480
ds_read_b64_tr_b16 v[98:99], v23 offset:22528
s_waitcnt lgkmcnt(15)
s_barrier
ds_read_b128 v[52:55], v50 offset:0
ds_read_b128 v[56:59], v50 offset:256
ds_read_b128 v[60:63], v51 offset:0
ds_read_b128 v[64:67], v51 offset:256
s_waitcnt lgkmcnt(12)
v_mfma_f32_16x16x32_bf16 v[116:119], a[56:59], v[68:71], v[116:119]
ds_read_b64_tr_b16 v[100:101], v20 offset:24576
ds_read_b64_tr_b16 v[102:103], v20 offset:26624
v_mfma_f32_16x16x32_bf16 v[120:123], a[56:59], v[72:75], v[120:123]
s_nop 0
ds_read_b64_tr_b16 v[104:105], v21 offset:24576
ds_read_b64_tr_b16 v[106:107], v21 offset:26624
v_mfma_f32_16x16x32_bf16 v[124:127], a[56:59], v[76:79], v[124:127]
ds_read_b64_tr_b16 v[108:109], v22 offset:24576
ds_read_b64_tr_b16 v[110:111], v22 offset:26624
v_mfma_f32_16x16x32_bf16 v[128:131], a[56:59], v[80:83], v[128:131]
buffer_load_dwordx4 a[232:235], v5, s[8:11], s27 offen offset:2048 sc1
ds_read_b64_tr_b16 v[112:113], v23 offset:24576
ds_read_b64_tr_b16 v[114:115], v23 offset:26624
s_waitcnt lgkmcnt(12)
v_mfma_f32_16x16x32_bf16 v[116:119], a[60:63], v[84:87], v[116:119]
ds_read_b64_tr_b16 v[68:69], v20 offset:28672
ds_read_b64_tr_b16 v[70:71], v20 offset:30720
v_mfma_f32_16x16x32_bf16 v[120:123], a[60:63], v[88:91], v[120:123]
s_nop 0
ds_read_b64_tr_b16 v[72:73], v21 offset:28672
ds_read_b64_tr_b16 v[74:75], v21 offset:30720
v_mfma_f32_16x16x32_bf16 v[124:127], a[60:63], v[92:95], v[124:127]
ds_read_b64_tr_b16 v[76:77], v22 offset:28672
ds_read_b64_tr_b16 v[78:79], v22 offset:30720
v_mfma_f32_16x16x32_bf16 v[128:131], a[60:63], v[96:99], v[128:131]
buffer_load_dwordx4 a[236:239], v5, s[8:11], s27 offen offset:3072 sc1
ds_read_b64_tr_b16 v[80:81], v23 offset:28672
ds_read_b64_tr_b16 v[82:83], v23 offset:30720
s_waitcnt lgkmcnt(8)
v_mfma_f32_16x16x32_bf16 v[116:119], a[64:67], v[100:103], v[116:119]
ds_read_b64_tr_b16 v[84:85], v20 offset:32768
ds_read_b64_tr_b16 v[86:87], v20 offset:34816
v_mfma_f32_16x16x32_bf16 v[120:123], a[64:67], v[104:107], v[120:123]
ds_read_b64_tr_b16 v[88:89], v21 offset:32768
ds_read_b64_tr_b16 v[90:91], v21 offset:34816
v_mfma_f32_16x16x32_bf16 v[124:127], a[64:67], v[108:111], v[124:127]
s_nop 0
ds_read_b64_tr_b16 v[92:93], v22 offset:32768
ds_read_b64_tr_b16 v[94:95], v22 offset:34816
v_mfma_f32_16x16x32_bf16 v[128:131], a[64:67], v[112:115], v[128:131]
ds_read_b64_tr_b16 v[96:97], v23 offset:32768
ds_read_b64_tr_b16 v[98:99], v23 offset:34816
s_waitcnt lgkmcnt(8)
v_mfma_f32_16x16x32_bf16 v[116:119], a[68:71], v[68:71], v[116:119]
ds_read_b64_tr_b16 v[100:101], v20 offset:36864
ds_read_b64_tr_b16 v[102:103], v20 offset:38912
v_mfma_f32_16x16x32_bf16 v[120:123], a[68:71], v[72:75], v[120:123]
ds_read_b64_tr_b16 v[104:105], v21 offset:36864
ds_read_b64_tr_b16 v[106:107], v21 offset:38912
v_mfma_f32_16x16x32_bf16 v[124:127], a[68:71], v[76:79], v[124:127]
s_nop 0
ds_read_b64_tr_b16 v[108:109], v22 offset:36864
ds_read_b64_tr_b16 v[110:111], v22 offset:38912
v_mfma_f32_16x16x32_bf16 v[128:131], a[68:71], v[80:83], v[128:131]
ds_read_b64_tr_b16 v[112:113], v23 offset:36864
ds_read_b64_tr_b16 v[114:115], v23 offset:38912
s_waitcnt lgkmcnt(8)
v_mfma_f32_16x16x32_bf16 v[116:119], a[72:75], v[84:87], v[116:119]
ds_read_b64_tr_b16 v[40:41], v24 offset:0
ds_read_b64_tr_b16 v[42:43], v24 offset:2048
v_mfma_f32_16x16x32_bf16 v[120:123], a[72:75], v[88:91], v[120:123]
ds_read_b64_tr_b16 v[44:45], v24 offset:4096
v_mfma_f32_16x16x32_bf16 v[124:127], a[72:75], v[92:95], v[124:127]
ds_read_b64_tr_b16 v[46:47], v24 offset:6144
v_mfma_f32_16x16x32_bf16 v[128:131], a[72:75], v[96:99], v[128:131]
ds_read_b64_tr_b16 v[48:49], v24 offset:8192
s_waitcnt lgkmcnt(5)
v_mfma_f32_16x16x32_bf16 v[116:119], a[76:79], v[100:103], v[116:119]
v_mfma_f32_16x16x32_bf16 v[120:123], a[76:79], v[104:107], v[120:123]
v_mfma_f32_16x16x32_bf16 v[124:127], a[76:79], v[108:111], v[124:127]
v_mfma_f32_16x16x32_bf16 v[128:131], a[76:79], v[112:115], v[128:131]
s_waitcnt vmcnt(28)
s_nop 0
ds_read_b128 v[192:195], v168 offset:0
ds_read_b128 v[196:199], v169 offset:0
ds_read_b128 v[200:203], v170 offset:0
ds_read_b128 v[204:207], v171 offset:0
ds_read_b128 v[208:211], v172 offset:0
ds_read_b128 v[212:215], v173 offset:0
ds_read_b128 v[216:219], v174 offset:0
ds_read_b128 v[220:223], v175 offset:0
s_waitcnt vmcnt(20)
s_nop 0
ds_read_b128 v[224:227], v168 offset:8192
ds_read_b128 v[228:231], v169 offset:8192
ds_read_b128 v[232:235], v170 offset:8192
ds_read_b128 v[236:239], v171 offset:8192
ds_read_b128 v[240:243], v172 offset:8192
ds_read_b128 v[244:247], v173 offset:8192
ds_read_b128 v[248:251], v174 offset:8192
ds_read_b128 v[252:255], v175 offset:8192
s_waitcnt lgkmcnt(0)
s_add_u32 m0, s26, 0
s_add_u32 s55, s28, 256
v_pk_fma_f32 v[116:117], v[28:29], v[52:53], v[116:117] op_sel_hi:[1,0,1] neg_lo:[0,1,0] neg_hi:[0,1,0]
buffer_load_dwordx4 v11, s[12:15], s55 offen lds
v_pk_fma_f32 v[118:119], v[30:31], v[52:53], v[118:119] op_sel_hi:[1,0,1] neg_lo:[0,1,0] neg_hi:[0,1,0]
v_pk_mul_f32 v[68:69], v[116:117], v[116:117]
v_pk_mul_f32 v[70:71], v[118:119], v[118:119]
s_add_u32 m0, s26, 1024
v_pk_fma_f32 v[68:69], v[68:69], v[54:55], v[54:55] op_sel:[0,1,0] op_sel_hi:[1,1,0]
buffer_load_dwordx4 v12, s[12:15], s55 offen lds
v_pk_fma_f32 v[70:71], v[70:71], v[54:55], v[54:55] op_sel:[0,1,0] op_sel_hi:[1,1,0]
v_pk_mul_f32 v[68:69], v[68:69], v[116:117]
v_pk_mul_f32 v[70:71], v[70:71], v[118:119]
s_add_u32 m0, s26, 2048
v_exp_f32 v68, v68
buffer_load_dwordx4 v13, s[12:15], s55 offen lds
v_exp_f32 v70, v70
v_exp_f32 v69, v69
v_exp_f32 v71, v71
s_add_u32 m0, s26, 3072
v_pk_fma_f32 v[68:69], v[68:69], v[52:53], v[52:53] op_sel:[0,1,1] op_sel_hi:[1,1,1]
buffer_load_dwordx4 v14, s[12:15], s55 offen lds
v_pk_fma_f32 v[70:71], v[70:71], v[52:53], v[52:53] op_sel:[0,1,1] op_sel_hi:[1,1,1]
v_rcp_f32 v68, v68
v_rcp_f32 v70, v70
s_add_u32 m0, s26, 4096
s_add_u32 s55, s55, 65536
v_rcp_f32 v69, v69
buffer_load_dwordx4 v11, s[12:15], s55 offen lds
v_rcp_f32 v71, v71
v_pk_mul_f32 v[116:117], v[116:117], v[68:69]
v_pk_mul_f32 v[118:119], v[118:119], v[70:71]
s_add_u32 m0, s26, 5120
v_pk_fma_f32 v[120:121], v[28:29], v[56:57], v[120:121] op_sel_hi:[1,0,1] neg_lo:[0,1,0] neg_hi:[0,1,0]
buffer_load_dwordx4 v12, s[12:15], s55 offen lds
v_pk_fma_f32 v[122:123], v[30:31], v[56:57], v[122:123] op_sel_hi:[1,0,1] neg_lo:[0,1,0] neg_hi:[0,1,0]
v_pk_mul_f32 v[68:69], v[120:121], v[120:121]
v_pk_mul_f32 v[70:71], v[122:123], v[122:123]
s_add_u32 m0, s26, 6144
v_pk_fma_f32 v[68:69], v[68:69], v[58:59], v[58:59] op_sel:[0,1,0] op_sel_hi:[1,1,0]
buffer_load_dwordx4 v13, s[12:15], s55 offen lds
v_pk_fma_f32 v[70:71], v[70:71], v[58:59], v[58:59] op_sel:[0,1,0] op_sel_hi:[1,1,0]
v_pk_mul_f32 v[68:69], v[68:69], v[120:121]
v_pk_mul_f32 v[70:71], v[70:71], v[122:123]
s_add_u32 m0, s26, 7168
v_exp_f32 v68, v68
buffer_load_dwordx4 v14, s[12:15], s55 offen lds
v_exp_f32 v70, v70
v_exp_f32 v69, v69
v_exp_f32 v71, v71
s_add_u32 m0, s26, 8192
s_add_u32 s55, s4, 256
v_pk_fma_f32 v[68:69], v[68:69], v[56:57], v[56:57] op_sel:[0,1,1] op_sel_hi:[1,1,1]
buffer_load_dwordx4 v11, s[12:15], s55 offen lds
v_pk_fma_f32 v[70:71], v[70:71], v[56:57], v[56:57] op_sel:[0,1,1] op_sel_hi:[1,1,1]
v_rcp_f32 v68, v68
v_rcp_f32 v70, v70
s_add_u32 m0, s26, 9216
v_rcp_f32 v69, v69
buffer_load_dwordx4 v12, s[12:15], s55 offen lds
v_rcp_f32 v71, v71
v_pk_mul_f32 v[120:121], v[120:121], v[68:69]
v_pk_mul_f32 v[122:123], v[122:123], v[70:71]
s_add_u32 m0, s26, 10240
v_pk_fma_f32 v[124:125], v[28:29], v[60:61], v[124:125] op_sel_hi:[1,0,1] neg_lo:[0,1,0] neg_hi:[0,1,0]
buffer_load_dwordx4 v13, s[12:15], s55 offen lds
v_pk_fma_f32 v[126:127], v[30:31], v[60:61], v[126:127] op_sel_hi:[1,0,1] neg_lo:[0,1,0] neg_hi:[0,1,0]
v_pk_mul_f32 v[68:69], v[124:125], v[124:125]
v_pk_mul_f32 v[70:71], v[126:127], v[126:127]
s_add_u32 m0, s26, 11264
v_pk_fma_f32 v[68:69], v[68:69], v[62:63], v[62:63] op_sel:[0,1,0] op_sel_hi:[1,1,0]
buffer_load_dwordx4 v14, s[12:15], s55 offen lds
v_pk_fma_f32 v[70:71], v[70:71], v[62:63], v[62:63] op_sel:[0,1,0] op_sel_hi:[1,1,0]
v_pk_mul_f32 v[68:69], v[68:69], v[124:125]
v_pk_mul_f32 v[70:71], v[70:71], v[126:127]
s_add_u32 m0, s26, 12288
s_add_u32 s55, s55, 65536
v_exp_f32 v68, v68
buffer_load_dwordx4 v11, s[12:15], s55 offen lds
v_exp_f32 v70, v70
v_exp_f32 v69, v69
v_exp_f32 v71, v71
s_add_u32 m0, s26, 13312
v_pk_fma_f32 v[68:69], v[68:69], v[60:61], v[60:61] op_sel:[0,1,1] op_sel_hi:[1,1,1]
buffer_load_dwordx4 v12, s[12:15], s55 offen lds
v_pk_fma_f32 v[70:71], v[70:71], v[60:61], v[60:61] op_sel:[0,1,1] op_sel_hi:[1,1,1]
v_rcp_f32 v68, v68
v_rcp_f32 v70, v70
s_add_u32 m0, s26, 14336
v_rcp_f32 v69, v69
buffer_load_dwordx4 v13, s[12:15], s55 offen lds
v_rcp_f32 v71, v71
v_pk_mul_f32 v[124:125], v[124:125], v[68:69]
v_pk_mul_f32 v[126:127], v[126:127], v[70:71]
s_add_u32 m0, s26, 15360
v_pk_fma_f32 v[128:129], v[28:29], v[64:65], v[128:129] op_sel_hi:[1,0,1] neg_lo:[0,1,0] neg_hi:[0,1,0]
buffer_load_dwordx4 v14, s[12:15], s55 offen lds
v_pk_fma_f32 v[130:131], v[30:31], v[64:65], v[130:131] op_sel_hi:[1,0,1] neg_lo:[0,1,0] neg_hi:[0,1,0]
v_pk_mul_f32 v[68:69], v[128:129], v[128:129]
v_pk_mul_f32 v[70:71], v[130:131], v[130:131]
v_pk_fma_f32 v[68:69], v[68:69], v[66:67], v[66:67] op_sel:[0,1,0] op_sel_hi:[1,1,0]
v_pk_fma_f32 v[70:71], v[70:71], v[66:67], v[66:67] op_sel:[0,1,0] op_sel_hi:[1,1,0]
v_pk_mul_f32 v[68:69], v[68:69], v[128:129]
v_pk_mul_f32 v[70:71], v[70:71], v[130:131]
v_exp_f32 v68, v68
v_exp_f32 v70, v70
v_exp_f32 v69, v69
v_exp_f32 v71, v71
v_pk_fma_f32 v[68:69], v[68:69], v[64:65], v[64:65] op_sel:[0,1,1] op_sel_hi:[1,1,1]
v_pk_fma_f32 v[70:71], v[70:71], v[64:65], v[64:65] op_sel:[0,1,1] op_sel_hi:[1,1,1]
v_rcp_f32 v68, v68
v_rcp_f32 v70, v70
v_rcp_f32 v69, v69
v_rcp_f32 v71, v71
v_pk_mul_f32 v[128:129], v[128:129], v[68:69]
v_pk_mul_f32 v[130:131], v[130:131], v[70:71]
v_pk_add_f32 v[176:177], v[116:117], v[118:119]
v_pk_mul_f32 v[184:185], v[116:117], v[116:117]
v_pk_fma_f32 v[184:185], v[118:119], v[118:119], v[184:185]
v_pk_add_f32 v[178:179], v[120:121], v[122:123]
v_pk_mul_f32 v[186:187], v[120:121], v[120:121]
v_pk_fma_f32 v[186:187], v[122:123], v[122:123], v[186:187]
v_pk_add_f32 v[180:181], v[124:125], v[126:127]
v_pk_mul_f32 v[188:189], v[124:125], v[124:125]
v_pk_fma_f32 v[188:189], v[126:127], v[126:127], v[188:189]
v_pk_add_f32 v[182:183], v[128:129], v[130:131]
v_pk_mul_f32 v[190:191], v[128:129], v[128:129]
v_pk_fma_f32 v[190:191], v[130:131], v[130:131], v[190:191]
v_add_f32 v176, v176, v177
v_add_f32 v178, v178, v179
v_add_f32 v180, v180, v181
v_add_f32 v182, v182, v183
v_add_f32 v184, v184, v185
v_add_f32 v186, v186, v187
v_add_f32 v188, v188, v189
v_add_f32 v190, v190, v191
v_permlane32_swap_b32 v176, v180
v_permlane32_swap_b32 v178, v182
v_permlane32_swap_b32 v184, v188
v_permlane32_swap_b32 v186, v190
v_add_f32 v176, v176, v180
v_add_f32 v178, v178, v182
v_add_f32 v184, v184, v188
v_add_f32 v186, v186, v190
v_permlane16_swap_b32 v176, v178
s_nop 0
v_permlane16_swap_b32 v184, v186
v_add_f32 v68, v176, v178
v_add_f32_e64 v69, v184, v186
ds_write_b64 v27, v[68:69]
s_waitcnt lgkmcnt(0)
s_waitcnt vmcnt(16)
s_mul_i32 s21, s18, 393216
s_add_u32 s21, s21, 0xd00000
s_lshl_b32 s36, s16, 15
s_add_u32 s21, s21, s36
s_add_u32 s54, s21, 262144
s_add_u32 s21, s21, s36
s_lshl_b32 s36, s20, 12
s_add_u32 s36, s36, 0
v_add_u32 v9, s36, v5
s_lshl_b32 s36, s20, 10
s_add_u32 s36, s36, 8192
v_add_u32 v6, s36, v5
ds_read_b64_tr_b16 v[68:69], v16 offset:0
ds_read_b64_tr_b16 v[70:71], v16 offset:2048
ds_read_b64_tr_b16 v[72:73], v17 offset:0
ds_read_b64_tr_b16 v[74:75], v17 offset:2048
ds_read_b64_tr_b16 v[76:77], v18 offset:0
ds_read_b64_tr_b16 v[78:79], v18 offset:2048
ds_read_b64_tr_b16 v[80:81], v19 offset:0
ds_read_b64_tr_b16 v[82:83], v19 offset:2048
ds_read_b64_tr_b16 v[84:85], v16 offset:4096
ds_read_b64_tr_b16 v[86:87], v16 offset:6144
ds_read_b64_tr_b16 v[88:89], v17 offset:4096
ds_read_b64_tr_b16 v[90:91], v17 offset:6144
ds_read_b64_tr_b16 v[92:93], v18 offset:4096
ds_read_b64_tr_b16 v[94:95], v18 offset:6144
ds_read_b64_tr_b16 v[96:97], v19 offset:4096
ds_read_b64_tr_b16 v[98:99], v19 offset:6144
s_barrier
s_waitcnt lgkmcnt(8)
v_mfma_f32_16x16x32_bf16 v[132:135], a[80:83], v[68:71], 0
ds_read_b64_tr_b16 v[100:101], v16 offset:8192
v_mfma_f32_16x16x32_bf16 v[148:151], a[160:163], v[68:71], 0
ds_read_b64_tr_b16 v[102:103], v16 offset:10240
v_mfma_f32_16x16x32_bf16 v[136:139], a[80:83], v[72:75], 0
ds_read_b64_tr_b16 v[104:105], v17 offset:8192
v_mfma_f32_16x16x32_bf16 v[152:155], a[160:163], v[72:75], 0
ds_read_b64_tr_b16 v[106:107], v17 offset:10240
v_mfma_f32_16x16x32_bf16 v[140:143], a[80:83], v[76:79], 0
ds_read_b64_tr_b16 v[108:109], v18 offset:8192
v_mfma_f32_16x16x32_bf16 v[156:159], a[160:163], v[76:79], 0
ds_read_b64_tr_b16 v[110:111], v18 offset:10240
v_mfma_f32_16x16x32_bf16 v[144:147], a[80:83], v[80:83], 0
ds_read_b64_tr_b16 v[112:113], v19 offset:8192
v_mfma_f32_16x16x32_bf16 v[160:163], a[160:163], v[80:83], 0
ds_read_b64_tr_b16 v[114:115], v19 offset:10240
s_waitcnt lgkmcnt(8)
v_mfma_f32_16x16x32_bf16 v[132:135], a[84:87], v[84:87], v[132:135]
ds_read_b64_tr_b16 v[68:69], v16 offset:12288
v_mfma_f32_16x16x32_bf16 v[148:151], a[164:167], v[84:87], v[148:151]
ds_read_b64_tr_b16 v[70:71], v16 offset:14336
v_mfma_f32_16x16x32_bf16 v[136:139], a[84:87], v[88:91], v[136:139]
ds_read_b64_tr_b16 v[72:73], v17 offset:12288
v_mfma_f32_16x16x32_bf16 v[152:155], a[164:167], v[88:91], v[152:155]
ds_read_b64_tr_b16 v[74:75], v17 offset:14336
v_mfma_f32_16x16x32_bf16 v[140:143], a[84:87], v[92:95], v[140:143]
ds_read_b64_tr_b16 v[76:77], v18 offset:12288
v_mfma_f32_16x16x32_bf16 v[156:159], a[164:167], v[92:95], v[156:159]
ds_read_b64_tr_b16 v[78:79], v18 offset:14336
v_mfma_f32_16x16x32_bf16 v[144:147], a[84:87], v[96:99], v[144:147]
ds_read_b64_tr_b16 v[80:81], v19 offset:12288
v_mfma_f32_16x16x32_bf16 v[160:163], a[164:167], v[96:99], v[160:163]
ds_read_b64_tr_b16 v[82:83], v19 offset:14336
s_waitcnt lgkmcnt(8)
v_mfma_f32_16x16x32_bf16 v[132:135], a[88:91], v[100:103], v[132:135]
ds_read_b64_tr_b16 v[84:85], v16 offset:16384
v_mfma_f32_16x16x32_bf16 v[148:151], a[168:171], v[100:103], v[148:151]
ds_read_b64_tr_b16 v[86:87], v16 offset:18432
v_mfma_f32_16x16x32_bf16 v[136:139], a[88:91], v[104:107], v[136:139]
ds_read_b64_tr_b16 v[88:89], v17 offset:16384
v_mfma_f32_16x16x32_bf16 v[152:155], a[168:171], v[104:107], v[152:155]
ds_read_b64_tr_b16 v[90:91], v17 offset:18432
v_mfma_f32_16x16x32_bf16 v[140:143], a[88:91], v[108:111], v[140:143]
ds_read_b64_tr_b16 v[92:93], v18 offset:16384
v_mfma_f32_16x16x32_bf16 v[156:159], a[168:171], v[108:111], v[156:159]
ds_read_b64_tr_b16 v[94:95], v18 offset:18432
v_mfma_f32_16x16x32_bf16 v[144:147], a[88:91], v[112:115], v[144:147]
ds_read_b64_tr_b16 v[96:97], v19 offset:16384
v_mfma_f32_16x16x32_bf16 v[160:163], a[168:171], v[112:115], v[160:163]
ds_read_b64_tr_b16 v[98:99], v19 offset:18432
s_waitcnt lgkmcnt(8)
v_mfma_f32_16x16x32_bf16 v[132:135], a[92:95], v[68:71], v[132:135]
ds_read_b64_tr_b16 v[100:101], v16 offset:20480
v_mfma_f32_16x16x32_bf16 v[148:151], a[172:175], v[68:71], v[148:151]
ds_read_b64_tr_b16 v[102:103], v16 offset:22528
v_mfma_f32_16x16x32_bf16 v[136:139], a[92:95], v[72:75], v[136:139]
ds_read_b64_tr_b16 v[104:105], v17 offset:20480
v_mfma_f32_16x16x32_bf16 v[152:155], a[172:175], v[72:75], v[152:155]
ds_read_b64_tr_b16 v[106:107], v17 offset:22528
v_mfma_f32_16x16x32_bf16 v[140:143], a[92:95], v[76:79], v[140:143]
ds_read_b64_tr_b16 v[108:109], v18 offset:20480
v_mfma_f32_16x16x32_bf16 v[156:159], a[172:175], v[76:79], v[156:159]
ds_read_b64_tr_b16 v[110:111], v18 offset:22528
v_mfma_f32_16x16x32_bf16 v[144:147], a[92:95], v[80:83], v[144:147]
ds_read_b64_tr_b16 v[112:113], v19 offset:20480
v_mfma_f32_16x16x32_bf16 v[160:163], a[172:175], v[80:83], v[160:163]
ds_read_b64_tr_b16 v[114:115], v19 offset:22528
s_waitcnt lgkmcnt(8)
v_mfma_f32_16x16x32_bf16 v[132:135], a[96:99], v[84:87], v[132:135]
ds_read_b64_tr_b16 v[68:69], v16 offset:24576
v_mfma_f32_16x16x32_bf16 v[148:151], a[176:179], v[84:87], v[148:151]
ds_read_b64_tr_b16 v[70:71], v16 offset:26624
v_mfma_f32_16x16x32_bf16 v[136:139], a[96:99], v[88:91], v[136:139]
ds_read_b64_tr_b16 v[72:73], v17 offset:24576
v_mfma_f32_16x16x32_bf16 v[152:155], a[176:179], v[88:91], v[152:155]
ds_read_b64_tr_b16 v[74:75], v17 offset:26624
v_mfma_f32_16x16x32_bf16 v[140:143], a[96:99], v[92:95], v[140:143]
ds_read_b64_tr_b16 v[76:77], v18 offset:24576
v_mfma_f32_16x16x32_bf16 v[156:159], a[176:179], v[92:95], v[156:159]
ds_read_b64_tr_b16 v[78:79], v18 offset:26624
v_mfma_f32_16x16x32_bf16 v[144:147], a[96:99], v[96:99], v[144:147]
ds_read_b64_tr_b16 v[80:81], v19 offset:24576
v_mfma_f32_16x16x32_bf16 v[160:163], a[176:179], v[96:99], v[160:163]
ds_read_b64_tr_b16 v[82:83], v19 offset:26624
buffer_load_dwordx2 v[176:177], v25, s[8:11], s29 offen offset:0 sc1
buffer_load_dwordx2 v[178:179], v25, s[8:11], s29 offen offset:512 sc1
buffer_load_dwordx2 v[180:181], v25, s[8:11], s29 offen offset:1024 sc1
buffer_load_dwordx2 v[182:183], v25, s[8:11], s29 offen offset:1536 sc1
buffer_load_dwordx2 v[184:185], v25, s[8:11], s29 offen offset:2048 sc1
buffer_load_dwordx2 v[186:187], v25, s[8:11], s29 offen offset:2560 sc1
buffer_load_dwordx2 v[188:189], v25, s[8:11], s29 offen offset:3072 sc1
buffer_load_dwordx2 v[190:191], v25, s[8:11], s29 offen offset:3584 sc1
s_waitcnt lgkmcnt(8)
v_mfma_f32_16x16x32_bf16 v[132:135], a[100:103], v[100:103], v[132:135]
ds_read_b64_tr_b16 v[84:85], v16 offset:28672
v_mfma_f32_16x16x32_bf16 v[148:151], a[180:183], v[100:103], v[148:151]
ds_read_b64_tr_b16 v[86:87], v16 offset:30720
v_mfma_f32_16x16x32_bf16 v[136:139], a[100:103], v[104:107], v[136:139]
ds_read_b64_tr_b16 v[88:89], v17 offset:28672
v_mfma_f32_16x16x32_bf16 v[152:155], a[180:183], v[104:107], v[152:155]
ds_read_b64_tr_b16 v[90:91], v17 offset:30720
v_mfma_f32_16x16x32_bf16 v[140:143], a[100:103], v[108:111], v[140:143]
ds_read_b64_tr_b16 v[92:93], v18 offset:28672
v_mfma_f32_16x16x32_bf16 v[156:159], a[180:183], v[108:111], v[156:159]
ds_read_b64_tr_b16 v[94:95], v18 offset:30720
v_mfma_f32_16x16x32_bf16 v[144:147], a[100:103], v[112:115], v[144:147]
ds_read_b64_tr_b16 v[96:97], v19 offset:28672
v_mfma_f32_16x16x32_bf16 v[160:163], a[180:183], v[112:115], v[160:163]
ds_read_b64_tr_b16 v[98:99], v19 offset:30720
s_waitcnt lgkmcnt(8)
v_mfma_f32_16x16x32_bf16 v[132:135], a[104:107], v[68:71], v[132:135]
ds_read_b64_tr_b16 v[100:101], v16 offset:32768
v_mfma_f32_16x16x32_bf16 v[148:151], a[184:187], v[68:71], v[148:151]
ds_read_b64_tr_b16 v[102:103], v16 offset:34816
v_mfma_f32_16x16x32_bf16 v[136:139], a[104:107], v[72:75], v[136:139]
ds_read_b64_tr_b16 v[104:105], v17 offset:32768
v_mfma_f32_16x16x32_bf16 v[152:155], a[184:187], v[72:75], v[152:155]
ds_read_b64_tr_b16 v[106:107], v17 offset:34816
v_mfma_f32_16x16x32_bf16 v[140:143], a[104:107], v[76:79], v[140:143]
ds_read_b64_tr_b16 v[108:109], v18 offset:32768
v_mfma_f32_16x16x32_bf16 v[156:159], a[184:187], v[76:79], v[156:159]
ds_read_b64_tr_b16 v[110:111], v18 offset:34816
v_mfma_f32_16x16x32_bf16 v[144:147], a[104:107], v[80:83], v[144:147]
ds_read_b64_tr_b16 v[112:113], v19 offset:32768
v_mfma_f32_16x16x32_bf16 v[160:163], a[184:187], v[80:83], v[160:163]
ds_read_b64_tr_b16 v[114:115], v19 offset:34816
s_waitcnt lgkmcnt(8)
v_mfma_f32_16x16x32_bf16 v[132:135], a[108:111], v[84:87], v[132:135]
ds_read_b64_tr_b16 v[68:69], v16 offset:36864
v_mfma_f32_16x16x32_bf16 v[148:151], a[188:191], v[84:87], v[148:151]
ds_read_b64_tr_b16 v[70:71], v16 offset:38912
v_mfma_f32_16x16x32_bf16 v[136:139], a[108:111], v[88:91], v[136:139]
ds_read_b64_tr_b16 v[72:73], v17 offset:36864
v_mfma_f32_16x16x32_bf16 v[152:155], a[188:191], v[88:91], v[152:155]
ds_read_b64_tr_b16 v[74:75], v17 offset:38912
v_mfma_f32_16x16x32_bf16 v[140:143], a[108:111], v[92:95], v[140:143]
ds_read_b64_tr_b16 v[76:77], v18 offset:36864
v_mfma_f32_16x16x32_bf16 v[156:159], a[188:191], v[92:95], v[156:159]
ds_read_b64_tr_b16 v[78:79], v18 offset:38912
v_mfma_f32_16x16x32_bf16 v[144:147], a[108:111], v[96:99], v[144:147]
ds_read_b64_tr_b16 v[80:81], v19 offset:36864
v_mfma_f32_16x16x32_bf16 v[160:163], a[188:191], v[96:99], v[160:163]
ds_read_b64_tr_b16 v[82:83], v19 offset:38912
s_waitcnt vmcnt(16)
ds_read_b128 a[0:3], v168 offset:0
ds_read_b128 a[4:7], v169 offset:0
ds_read_b128 a[8:11], v170 offset:0
ds_read_b128 a[12:15], v171 offset:0
ds_read_b128 a[16:19], v172 offset:0
ds_read_b128 a[20:23], v173 offset:0
ds_read_b128 a[24:27], v174 offset:0
ds_read_b128 a[28:31], v175 offset:0
s_waitcnt vmcnt(8)
s_nop 0
ds_read_b128 a[32:35], v168 offset:8192
ds_read_b128 a[36:39], v169 offset:8192
ds_read_b128 a[40:43], v170 offset:8192
ds_read_b128 a[44:47], v171 offset:8192
ds_read_b128 a[48:51], v172 offset:8192
ds_read_b128 a[52:55], v173 offset:8192
ds_read_b128 a[56:59], v174 offset:8192
ds_read_b128 a[60:63], v175 offset:8192
s_waitcnt lgkmcnt(15)
v_mfma_f32_16x16x32_bf16 v[132:135], a[112:115], v[100:103], v[132:135]
ds_read_b64_tr_b16 v[84:85], v20 offset:0
v_mfma_f32_16x16x32_bf16 v[148:151], a[192:195], v[100:103], v[148:151]
ds_read_b64_tr_b16 v[86:87], v20 offset:2048
v_mfma_f32_16x16x32_bf16 v[136:139], a[112:115], v[104:107], v[136:139]
ds_read_b64_tr_b16 v[88:89], v21 offset:0
v_mfma_f32_16x16x32_bf16 v[152:155], a[192:195], v[104:107], v[152:155]
ds_read_b64_tr_b16 v[90:91], v21 offset:2048
v_mfma_f32_16x16x32_bf16 v[140:143], a[112:115], v[108:111], v[140:143]
ds_read_b64_tr_b16 v[92:93], v22 offset:0
v_mfma_f32_16x16x32_bf16 v[156:159], a[192:195], v[108:111], v[156:159]
ds_read_b64_tr_b16 v[94:95], v22 offset:2048
v_mfma_f32_16x16x32_bf16 v[144:147], a[112:115], v[112:115], v[144:147]
s_nop 0
ds_read_b64_tr_b16 v[96:97], v23 offset:0
v_mfma_f32_16x16x32_bf16 v[160:163], a[192:195], v[112:115], v[160:163]
ds_read_b64_tr_b16 v[98:99], v23 offset:2048
s_mul_i32 s30, s18, 393216
s_add_u32 s30, s30, 0xd40000
s_lshl_b32 s31, s17, 12
s_add_u32 s30, s30, s31
s_lshl_b32 s31, s20, 10
s_add_u32 s30, s30, s31
s_lshl_b32 s31, s20, 11
s_add_u32 s32, s30, s31
s_xor_b32 s31, s31, 2048
s_add_u32 s33, s30, s31
s_waitcnt vmcnt(0)
s_mov_b32 s37, 0
Lks_spoll41:
v_min_f32 v2, v177, v179
v_min3_f32 v2, v2, v181, v183
v_min3_f32 v2, v2, v185, v187
v_min3_f32 v2, v2, v189, v191
v_cmp_gt_f32 vcc, 0, v2
s_cbranch_vccz Lks_sok42
s_add_u32 s37, s37, 1
s_cmp_gt_u32 s37, 131072
s_cbranch_scc1 Lks_sok42
buffer_load_dwordx2 v[176:177], v25, s[8:11], s29 offen offset:0 sc1
buffer_load_dwordx2 v[178:179], v25, s[8:11], s29 offen offset:512 sc1
buffer_load_dwordx2 v[180:181], v25, s[8:11], s29 offen offset:1024 sc1
buffer_load_dwordx2 v[182:183], v25, s[8:11], s29 offen offset:1536 sc1
buffer_load_dwordx2 v[184:185], v25, s[8:11], s29 offen offset:2048 sc1
buffer_load_dwordx2 v[186:187], v25, s[8:11], s29 offen offset:2560 sc1
buffer_load_dwordx2 v[188:189], v25, s[8:11], s29 offen offset:3072 sc1
buffer_load_dwordx2 v[190:191], v25, s[8:11], s29 offen offset:3584 sc1
s_waitcnt vmcnt(0)
s_branch Lks_spoll41
Lks_sok42:
v_pk_add_f32 v[176:177], v[176:177], v[184:185]
v_pk_add_f32 v[178:179], v[178:179], v[186:187]
v_pk_add_f32 v[180:181], v[180:181], v[188:189]
v_pk_add_f32 v[182:183], v[182:183], v[190:191]
v_pk_add_f32 v[176:177], v[176:177], v[180:181]
v_pk_add_f32 v[178:179], v[178:179], v[182:183]
v_pk_add_f32 v[176:177], v[176:177], v[178:179]
v_mov_b32 v4, 0x3aaaaaab
v_mul_f32 v176, v4, v176
v_mul_f32 v178, v176, v176
v_fma_f32 v177, v177, v4, -v178
v_max_f32 v177, 0, v177
v_cvt_pk_bf16_f32 v178, v176, v177
v_lshlrev_b32 v176, 16, v178
v_and_b32 v177, 0xffff0000, v178
v_add_f32 v177, 0x3727c5ac, v177
v_cvt_pk_bf16_f32 v177, v177, v177
v_and_b32 v177, 0xffff0000, v177
v_sqrt_f32 v177, v177
s_nop 0
v_cvt_pk_bf16_f32 v177, v177, v177
v_and_b32 v177, 0xffff0000, v177
v_rcp_f32 v177, v177
s_nop 0
v_mul_f32 v176, v176, -v177
v_mov_b32 v184, v176
v_mov_b32 v188, v176
v_mov_b32 v185, v177
v_mov_b32 v189, v177
v_permlane32_swap_b32 v184, v188
s_nop 0
v_permlane32_swap_b32 v185, v189
v_mov_b32 v186, v184
v_mov_b32 v190, v188
v_mov_b32 v187, v185
v_mov_b32_e64 v191, v189
v_permlane16_swap_b32 v184, v186
v_permlane16_swap_b32 v188, v190
v_permlane16_swap_b32 v185, v187
v_permlane16_swap_b32 v189, v191
v_pk_fma_f32 v[116:117], v[116:117], v[184:185], v[184:185] op_sel:[0,1,0] op_sel_hi:[1,1,0]
v_pk_fma_f32 v[118:119], v[118:119], v[184:185], v[184:185] op_sel:[0,1,0] op_sel_hi:[1,1,0]
v_cvt_pk_bf16_f32 v116, v116, v117
v_cvt_pk_bf16_f32 v117, v118, v119
v_pk_fma_f32 v[120:121], v[120:121], v[186:187], v[186:187] op_sel:[0,1,0] op_sel_hi:[1,1,0]
v_pk_fma_f32 v[122:123], v[122:123], v[186:187], v[186:187] op_sel:[0,1,0] op_sel_hi:[1,1,0]
v_cvt_pk_bf16_f32 v120, v120, v121
v_cvt_pk_bf16_f32 v121, v122, v123
v_pk_fma_f32 v[124:125], v[124:125], v[188:189], v[188:189] op_sel:[0,1,0] op_sel_hi:[1,1,0]
v_pk_fma_f32 v[126:127], v[126:127], v[188:189], v[188:189] op_sel:[0,1,0] op_sel_hi:[1,1,0]
v_cvt_pk_bf16_f32 v124, v124, v125
v_cvt_pk_bf16_f32 v125, v126, v127
v_pk_fma_f32 v[128:129], v[128:129], v[190:191], v[190:191] op_sel:[0,1,0] op_sel_hi:[1,1,0]
v_pk_fma_f32 v[130:131], v[130:131], v[190:191], v[190:191] op_sel:[0,1,0] op_sel_hi:[1,1,0]
v_cvt_pk_bf16_f32 v128, v128, v129
v_cvt_pk_bf16_f32 v129, v130, v131
ds_write_b64 v26, v[116:117] offset:0
ds_write_b64 v26, v[120:121] offset:512
ds_write_b64 v26, v[124:125] offset:1024
ds_write_b64 v26, v[128:129] offset:1536
ds_read_b64_tr_b16 v[116:117], v15 offset:0
ds_read_b64_tr_b16 v[118:119], v15 offset:256
ds_read_b64_tr_b16 v[120:121], v15 offset:1024
ds_read_b64_tr_b16 v[122:123], v15 offset:1280
s_waitcnt lgkmcnt(2)
buffer_store_dwordx4 v[116:119], v5, s[8:11], s32 offen offset:0 sc1
s_waitcnt lgkmcnt(0)
buffer_store_dwordx4 v[120:123], v5, s[8:11], s33 offen offset:0 sc1
s_lshl_b32 s30, s18, 5
s_add_u32 s31, s30, s17
s_lshl_b32 s31, s31, 7
s_add_u32 s31, s31, 0x9b8000
s_lshl_b32 s5, s16, 3
s_add_u32 s5, s5, s30
s_lshl_b32 s5, s5, 7
s_add_u32 s5, s5, 0x9b8000
v_and_b32 v2, 7, v1
v_lshlrev_b32 v51, 7, v2
v_min_u32 v2, 4, v2
v_lshlrev_b32 v50, 7, v2
v_mfma_f32_16x16x32_bf16 v[132:135], a[116:119], v[68:71], v[132:135]
ds_read_b64_tr_b16 v[100:101], v20 offset:4096
v_mfma_f32_16x16x32_bf16 v[148:151], a[196:199], v[68:71], v[148:151]
ds_read_b64_tr_b16 v[102:103], v20 offset:6144
v_mfma_f32_16x16x32_bf16 v[136:139], a[116:119], v[72:75], v[136:139]
ds_read_b64_tr_b16 v[104:105], v21 offset:4096
v_mfma_f32_16x16x32_bf16 v[152:155], a[196:199], v[72:75], v[152:155]
ds_read_b64_tr_b16 v[106:107], v21 offset:6144
v_mfma_f32_16x16x32_bf16 v[140:143], a[116:119], v[76:79], v[140:143]
ds_read_b64_tr_b16 v[108:109], v22 offset:4096
v_mfma_f32_16x16x32_bf16 v[156:159], a[196:199], v[76:79], v[156:159]
ds_read_b64_tr_b16 v[110:111], v22 offset:6144
v_mfma_f32_16x16x32_bf16 v[144:147], a[116:119], v[80:83], v[144:147]
ds_read_b64_tr_b16 v[112:113], v23 offset:4096
v_mfma_f32_16x16x32_bf16 v[160:163], a[196:199], v[80:83], v[160:163]
ds_read_b64_tr_b16 v[114:115], v23 offset:6144
s_waitcnt lgkmcnt(0)
s_add_u32 m0, s26, 0
s_add_u32 s55, s28, 512
v_mfma_f32_16x16x32_bf16 v[132:135], a[120:123], v[84:87], v[132:135]
buffer_load_dwordx4 v11, s[12:15], s55 offen lds
ds_read_b64_tr_b16 v[68:69], v20 offset:8192
v_mfma_f32_16x16x32_bf16 v[148:151], a[200:203], v[84:87], v[148:151]
ds_read_b64_tr_b16 v[70:71], v20 offset:10240
v_mfma_f32_16x16x32_bf16 v[136:139], a[120:123], v[88:91], v[136:139]
ds_read_b64_tr_b16 v[72:73], v21 offset:8192
s_add_u32 m0, s26, 1024
v_mfma_f32_16x16x32_bf16 v[152:155], a[200:203], v[88:91], v[152:155]
buffer_load_dwordx4 v12, s[12:15], s55 offen lds
ds_read_b64_tr_b16 v[74:75], v21 offset:10240
v_mfma_f32_16x16x32_bf16 v[140:143], a[120:123], v[92:95], v[140:143]
ds_read_b64_tr_b16 v[76:77], v22 offset:8192
v_mfma_f32_16x16x32_bf16 v[156:159], a[200:203], v[92:95], v[156:159]
ds_read_b64_tr_b16 v[78:79], v22 offset:10240
s_add_u32 m0, s26, 2048
v_mfma_f32_16x16x32_bf16 v[144:147], a[120:123], v[96:99], v[144:147]
buffer_load_dwordx4 v13, s[12:15], s55 offen lds
ds_read_b64_tr_b16 v[80:81], v23 offset:8192
v_mfma_f32_16x16x32_bf16 v[160:163], a[200:203], v[96:99], v[160:163]
ds_read_b64_tr_b16 v[82:83], v23 offset:10240
v_mfma_f32_16x16x32_bf16 v[132:135], a[124:127], v[100:103], v[132:135]
ds_read_b64_tr_b16 v[84:85], v20 offset:12288
s_add_u32 m0, s26, 3072
v_mfma_f32_16x16x32_bf16 v[148:151], a[204:207], v[100:103], v[148:151]
buffer_load_dwordx4 v14, s[12:15], s55 offen lds
ds_read_b64_tr_b16 v[86:87], v20 offset:14336
v_mfma_f32_16x16x32_bf16 v[136:139], a[124:127], v[104:107], v[136:139]
ds_read_b64_tr_b16 v[88:89], v21 offset:12288
v_mfma_f32_16x16x32_bf16 v[152:155], a[204:207], v[104:107], v[152:155]
ds_read_b64_tr_b16 v[90:91], v21 offset:14336
s_add_u32 m0, s26, 4096
s_add_u32 s55, s55, 65536
v_mfma_f32_16x16x32_bf16 v[140:143], a[124:127], v[108:111], v[140:143]
buffer_load_dwordx4 v11, s[12:15], s55 offen lds
ds_read_b64_tr_b16 v[92:93], v22 offset:12288
v_mfma_f32_16x16x32_bf16 v[156:159], a[204:207], v[108:111], v[156:159]
ds_read_b64_tr_b16 v[94:95], v22 offset:14336
v_mfma_f32_16x16x32_bf16 v[144:147], a[124:127], v[112:115], v[144:147]
ds_read_b64_tr_b16 v[96:97], v23 offset:12288
s_add_u32 m0, s26, 5120
v_mfma_f32_16x16x32_bf16 v[160:163], a[204:207], v[112:115], v[160:163]
buffer_load_dwordx4 v12, s[12:15], s55 offen lds
ds_read_b64_tr_b16 v[98:99], v23 offset:14336
s_waitcnt lgkmcnt(8)
v_mfma_f32_16x16x32_bf16 v[132:135], a[128:131], v[68:71], v[132:135]
ds_read_b64_tr_b16 v[100:101], v20 offset:16384
v_mfma_f32_16x16x32_bf16 v[148:151], a[208:211], v[68:71], v[148:151]
ds_read_b64_tr_b16 v[102:103], v20 offset:18432
s_add_u32 m0, s26, 6144
v_mfma_f32_16x16x32_bf16 v[136:139], a[128:131], v[72:75], v[136:139]
buffer_load_dwordx4 v13, s[12:15], s55 offen lds
ds_read_b64_tr_b16 v[104:105], v21 offset:16384
v_mfma_f32_16x16x32_bf16 v[152:155], a[208:211], v[72:75], v[152:155]
ds_read_b64_tr_b16 v[106:107], v21 offset:18432
v_mfma_f32_16x16x32_bf16 v[140:143], a[128:131], v[76:79], v[140:143]
ds_read_b64_tr_b16 v[108:109], v22 offset:16384
s_add_u32 m0, s26, 7168
v_mfma_f32_16x16x32_bf16 v[156:159], a[208:211], v[76:79], v[156:159]
buffer_load_dwordx4 v14, s[12:15], s55 offen lds
ds_read_b64_tr_b16 v[110:111], v22 offset:18432
v_mfma_f32_16x16x32_bf16 v[144:147], a[128:131], v[80:83], v[144:147]
ds_read_b64_tr_b16 v[112:113], v23 offset:16384
v_mfma_f32_16x16x32_bf16 v[160:163], a[208:211], v[80:83], v[160:163]
ds_read_b64_tr_b16 v[114:115], v23 offset:18432
s_waitcnt lgkmcnt(8)
s_add_u32 m0, s26, 8192
s_add_u32 s55, s4, 512
v_mfma_f32_16x16x32_bf16 v[132:135], a[132:135], v[84:87], v[132:135]
buffer_load_dwordx4 v11, s[12:15], s55 offen lds
ds_read_b64_tr_b16 v[68:69], v20 offset:20480
v_mfma_f32_16x16x32_bf16 v[148:151], a[212:215], v[84:87], v[148:151]
ds_read_b64_tr_b16 v[70:71], v20 offset:22528
v_mfma_f32_16x16x32_bf16 v[136:139], a[132:135], v[88:91], v[136:139]
ds_read_b64_tr_b16 v[72:73], v21 offset:20480
s_add_u32 m0, s26, 9216
v_mfma_f32_16x16x32_bf16 v[152:155], a[212:215], v[88:91], v[152:155]
buffer_load_dwordx4 v12, s[12:15], s55 offen lds
ds_read_b64_tr_b16 v[74:75], v21 offset:22528
v_mfma_f32_16x16x32_bf16 v[140:143], a[132:135], v[92:95], v[140:143]
ds_read_b64_tr_b16 v[76:77], v22 offset:20480
v_mfma_f32_16x16x32_bf16 v[156:159], a[212:215], v[92:95], v[156:159]
ds_read_b64_tr_b16 v[78:79], v22 offset:22528
s_add_u32 m0, s26, 10240
v_mfma_f32_16x16x32_bf16 v[144:147], a[132:135], v[96:99], v[144:147]
buffer_load_dwordx4 v13, s[12:15], s55 offen lds
ds_read_b64_tr_b16 v[80:81], v23 offset:20480
v_mfma_f32_16x16x32_bf16 v[160:163], a[212:215], v[96:99], v[160:163]
ds_read_b64_tr_b16 v[82:83], v23 offset:22528
s_waitcnt lgkmcnt(8)
v_mfma_f32_16x16x32_bf16 v[132:135], a[136:139], v[100:103], v[132:135]
ds_read_b64_tr_b16 v[84:85], v20 offset:24576
s_add_u32 m0, s26, 11264
v_mfma_f32_16x16x32_bf16 v[148:151], a[216:219], v[100:103], v[148:151]
buffer_load_dwordx4 v14, s[12:15], s55 offen lds
ds_read_b64_tr_b16 v[86:87], v20 offset:26624
v_mfma_f32_16x16x32_bf16 v[136:139], a[136:139], v[104:107], v[136:139]
ds_read_b64_tr_b16 v[88:89], v21 offset:24576
v_mfma_f32_16x16x32_bf16 v[152:155], a[216:219], v[104:107], v[152:155]
ds_read_b64_tr_b16 v[90:91], v21 offset:26624
s_add_u32 m0, s26, 12288
s_add_u32 s55, s55, 65536
v_mfma_f32_16x16x32_bf16 v[140:143], a[136:139], v[108:111], v[140:143]
buffer_load_dwordx4 v11, s[12:15], s55 offen lds
ds_read_b64_tr_b16 v[92:93], v22 offset:24576
v_mfma_f32_16x16x32_bf16 v[156:159], a[216:219], v[108:111], v[156:159]
ds_read_b64_tr_b16 v[94:95], v22 offset:26624
v_mfma_f32_16x16x32_bf16 v[144:147], a[136:139], v[112:115], v[144:147]
s_nop 0
ds_read_b64_tr_b16 v[96:97], v23 offset:24576
s_add_u32 m0, s26, 13312
v_mfma_f32_16x16x32_bf16 v[160:163], a[216:219], v[112:115], v[160:163]
buffer_load_dwordx4 v12, s[12:15], s55 offen lds
ds_read_b64_tr_b16 v[98:99], v23 offset:26624
s_waitcnt vmcnt(14)
s_barrier
s_cmp_lg_u32 s16, 0
s_cbranch_scc1 Lks_sig43
v_mov_b32 v2, 0
v_mov_b32_e64 v3, s6
s_mov_b64 exec, 1
buffer_store_dword v3, v2, s[8:11], s31 offen sc1
s_mov_b64 exec, -1
Lks_sig43:
s_waitcnt lgkmcnt(8)
v_mfma_f32_16x16x32_bf16 v[132:135], a[140:143], v[68:71], v[132:135]
ds_read_b64_tr_b16 v[100:101], v20 offset:28672
v_mfma_f32_16x16x32_bf16 v[148:151], a[220:223], v[68:71], v[148:151]
ds_read_b64_tr_b16 v[102:103], v20 offset:30720
s_add_u32 m0, s26, 14336
v_mfma_f32_16x16x32_bf16 v[136:139], a[140:143], v[72:75], v[136:139]
buffer_load_dwordx4 v13, s[12:15], s55 offen lds
ds_read_b64_tr_b16 v[104:105], v21 offset:28672
v_mfma_f32_16x16x32_bf16 v[152:155], a[220:223], v[72:75], v[152:155]
ds_read_b64_tr_b16 v[106:107], v21 offset:30720
v_mfma_f32_16x16x32_bf16 v[140:143], a[140:143], v[76:79], v[140:143]
ds_read_b64_tr_b16 v[108:109], v22 offset:28672
s_add_u32 m0, s26, 15360
v_mfma_f32_16x16x32_bf16 v[156:159], a[220:223], v[76:79], v[156:159]
buffer_load_dwordx4 v14, s[12:15], s55 offen lds
ds_read_b64_tr_b16 v[110:111], v22 offset:30720
v_mfma_f32_16x16x32_bf16 v[144:147], a[140:143], v[80:83], v[144:147]
ds_read_b64_tr_b16 v[112:113], v23 offset:28672
v_mfma_f32_16x16x32_bf16 v[160:163], a[220:223], v[80:83], v[160:163]
ds_read_b64_tr_b16 v[114:115], v23 offset:30720
s_waitcnt lgkmcnt(8)
v_mfma_f32_16x16x32_bf16 v[132:135], a[144:147], v[84:87], v[132:135]
ds_read_b64_tr_b16 v[68:69], v20 offset:32768
v_mfma_f32_16x16x32_bf16 v[148:151], a[224:227], v[84:87], v[148:151]
ds_read_b64_tr_b16 v[70:71], v20 offset:34816
v_mfma_f32_16x16x32_bf16 v[136:139], a[144:147], v[88:91], v[136:139]
ds_read_b64_tr_b16 v[72:73], v21 offset:32768
v_mfma_f32_16x16x32_bf16 v[152:155], a[224:227], v[88:91], v[152:155]
ds_read_b64_tr_b16 v[74:75], v21 offset:34816
v_mfma_f32_16x16x32_bf16 v[140:143], a[144:147], v[92:95], v[140:143]
ds_read_b64_tr_b16 v[76:77], v22 offset:32768
v_mfma_f32_16x16x32_bf16 v[156:159], a[224:227], v[92:95], v[156:159]
ds_read_b64_tr_b16 v[78:79], v22 offset:34816
v_mfma_f32_16x16x32_bf16 v[144:147], a[144:147], v[96:99], v[144:147]
ds_read_b64_tr_b16 v[80:81], v23 offset:32768
v_mfma_f32_16x16x32_bf16 v[160:163], a[224:227], v[96:99], v[160:163]
ds_read_b64_tr_b16 v[82:83], v23 offset:34816
s_waitcnt lgkmcnt(8)
v_mfma_f32_16x16x32_bf16 v[132:135], a[148:151], v[100:103], v[132:135]
ds_read_b64_tr_b16 v[84:85], v20 offset:36864
v_mfma_f32_16x16x32_bf16 v[148:151], a[228:231], v[100:103], v[148:151]
ds_read_b64_tr_b16 v[86:87], v20 offset:38912
v_mfma_f32_16x16x32_bf16 v[136:139], a[148:151], v[104:107], v[136:139]
ds_read_b64_tr_b16 v[88:89], v21 offset:36864
v_mfma_f32_16x16x32_bf16 v[152:155], a[228:231], v[104:107], v[152:155]
ds_read_b64_tr_b16 v[90:91], v21 offset:38912
v_mfma_f32_16x16x32_bf16 v[140:143], a[148:151], v[108:111], v[140:143]
ds_read_b64_tr_b16 v[92:93], v22 offset:36864
v_mfma_f32_16x16x32_bf16 v[156:159], a[228:231], v[108:111], v[156:159]
ds_read_b64_tr_b16 v[94:95], v22 offset:38912
v_mfma_f32_16x16x32_bf16 v[144:147], a[148:151], v[112:115], v[144:147]
ds_read_b64_tr_b16 v[96:97], v23 offset:36864
v_mfma_f32_16x16x32_bf16 v[160:163], a[228:231], v[112:115], v[160:163]
ds_read_b64_tr_b16 v[98:99], v23 offset:38912
s_waitcnt lgkmcnt(8)
v_mfma_f32_16x16x32_bf16 v[132:135], a[152:155], v[68:71], v[132:135]
v_mfma_f32_16x16x32_bf16 v[148:151], a[232:235], v[68:71], v[148:151]
v_mfma_f32_16x16x32_bf16 v[136:139], a[152:155], v[72:75], v[136:139]
v_mfma_f32_16x16x32_bf16 v[152:155], a[232:235], v[72:75], v[152:155]
v_mfma_f32_16x16x32_bf16 v[140:143], a[152:155], v[76:79], v[140:143]
v_mfma_f32_16x16x32_bf16 v[156:159], a[232:235], v[76:79], v[156:159]
v_mfma_f32_16x16x32_bf16 v[144:147], a[152:155], v[80:83], v[144:147]
v_mfma_f32_16x16x32_bf16 v[160:163], a[232:235], v[80:83], v[160:163]
s_waitcnt lgkmcnt(0)
v_mfma_f32_16x16x32_bf16 v[132:135], a[156:159], v[84:87], v[132:135]
v_mfma_f32_16x16x32_bf16 v[148:151], a[236:239], v[84:87], v[148:151]
v_mfma_f32_16x16x32_bf16 v[136:139], a[156:159], v[88:91], v[136:139]
v_mfma_f32_16x16x32_bf16 v[152:155], a[236:239], v[88:91], v[152:155]
v_mfma_f32_16x16x32_bf16 v[140:143], a[156:159], v[92:95], v[140:143]
v_mfma_f32_16x16x32_bf16 v[156:159], a[236:239], v[92:95], v[156:159]
v_mfma_f32_16x16x32_bf16 v[144:147], a[156:159], v[96:99], v[144:147]
v_mfma_f32_16x16x32_bf16 v[160:163], a[236:239], v[96:99], v[160:163]
s_nop 1
ds_write_b128 v9, v[148:151] offset:0
s_nop 0
ds_write_b128 v9, v[152:155] offset:1024
s_nop 0
ds_write_b128 v9, v[156:159] offset:2048
s_nop 0
ds_write_b128 v9, v[160:163] offset:3072
ds_write_b128 v6, v[36:39]
s_waitcnt lgkmcnt(0)
s_barrier
buffer_load_dword v4, v50, s[8:11], s5 offen sc1
s_sub_u32 m0, s26, 69632
s_add_u32 s55, s28, 768
v_pk_fma_f32 v[132:133], v[32:33], v[52:53], v[132:133] op_sel_hi:[1,0,1] neg_lo:[0,1,0] neg_hi:[0,1,0]
buffer_load_dwordx4 v11, s[12:15], s55 offen lds
v_pk_fma_f32 v[134:135], v[34:35], v[52:53], v[134:135] op_sel_hi:[1,0,1] neg_lo:[0,1,0] neg_hi:[0,1,0]
s_sub_u32 m0, s26, 68608
v_pk_mul_f32 v[68:69], v[132:133], v[132:133]
buffer_load_dwordx4 v12, s[12:15], s55 offen lds
v_pk_mul_f32 v[70:71], v[134:135], v[134:135]
s_sub_u32 m0, s26, 67584
v_pk_fma_f32 v[68:69], v[68:69], v[54:55], v[54:55] op_sel:[0,1,0] op_sel_hi:[1,1,0]
buffer_load_dwordx4 v13, s[12:15], s55 offen lds
v_pk_fma_f32 v[70:71], v[70:71], v[54:55], v[54:55] op_sel:[0,1,0] op_sel_hi:[1,1,0]
s_sub_u32 m0, s26, 66560
v_pk_mul_f32 v[68:69], v[68:69], v[132:133]
buffer_load_dwordx4 v14, s[12:15], s55 offen lds
v_pk_mul_f32 v[70:71], v[70:71], v[134:135]
s_sub_u32 m0, s26, 65536
s_add_u32 s55, s55, 65536
v_exp_f32 v68, v68
buffer_load_dwordx4 v11, s[12:15], s55 offen lds
v_exp_f32 v70, v70
s_sub_u32 m0, s26, 64512
v_exp_f32 v69, v69
buffer_load_dwordx4 v12, s[12:15], s55 offen lds
v_exp_f32 v71, v71
s_sub_u32 m0, s26, 63488
v_pk_fma_f32 v[68:69], v[68:69], v[52:53], v[52:53] op_sel:[0,1,1] op_sel_hi:[1,1,1]
buffer_load_dwordx4 v13, s[12:15], s55 offen lds
v_pk_fma_f32 v[70:71], v[70:71], v[52:53], v[52:53] op_sel:[0,1,1] op_sel_hi:[1,1,1]
s_sub_u32 m0, s26, 62464
v_rcp_f32 v68, v68
buffer_load_dwordx4 v14, s[12:15], s55 offen lds
v_rcp_f32 v70, v70
s_sub_u32 m0, s26, 61440
s_add_u32 s55, s4, 768
v_rcp_f32 v69, v69
buffer_load_dwordx4 v11, s[12:15], s55 offen lds
v_rcp_f32 v71, v71
s_sub_u32 m0, s26, 60416
v_pk_mul_f32 v[132:133], v[132:133], v[68:69]
buffer_load_dwordx4 v12, s[12:15], s55 offen lds
v_pk_mul_f32 v[134:135], v[134:135], v[70:71]
s_sub_u32 m0, s26, 59392
v_pk_fma_f32 v[136:137], v[32:33], v[56:57], v[136:137] op_sel_hi:[1,0,1] neg_lo:[0,1,0] neg_hi:[0,1,0]
buffer_load_dwordx4 v13, s[12:15], s55 offen lds
v_pk_fma_f32 v[138:139], v[34:35], v[56:57], v[138:139] op_sel_hi:[1,0,1] neg_lo:[0,1,0] neg_hi:[0,1,0]
s_sub_u32 m0, s26, 58368
v_pk_mul_f32 v[68:69], v[136:137], v[136:137]
buffer_load_dwordx4 v14, s[12:15], s55 offen lds
v_pk_mul_f32 v[70:71], v[138:139], v[138:139]
s_sub_u32 m0, s26, 57344
s_add_u32 s55, s55, 65536
v_pk_fma_f32 v[68:69], v[68:69], v[58:59], v[58:59] op_sel:[0,1,0] op_sel_hi:[1,1,0]
buffer_load_dwordx4 v11, s[12:15], s55 offen lds
v_pk_fma_f32 v[70:71], v[70:71], v[58:59], v[58:59] op_sel:[0,1,0] op_sel_hi:[1,1,0]
s_sub_u32 m0, s26, 56320
v_pk_mul_f32 v[68:69], v[68:69], v[136:137]
buffer_load_dwordx4 v12, s[12:15], s55 offen lds
v_pk_mul_f32 v[70:71], v[70:71], v[138:139]
s_sub_u32 m0, s26, 55296
v_exp_f32 v68, v68
buffer_load_dwordx4 v13, s[12:15], s55 offen lds
v_exp_f32 v70, v70
s_sub_u32 m0, s26, 54272
v_exp_f32 v69, v69
buffer_load_dwordx4 v14, s[12:15], s55 offen lds
v_exp_f32 v71, v71
v_pk_fma_f32 v[68:69], v[68:69], v[56:57], v[56:57] op_sel:[0,1,1] op_sel_hi:[1,1,1]
v_pk_fma_f32 v[70:71], v[70:71], v[56:57], v[56:57] op_sel:[0,1,1] op_sel_hi:[1,1,1]
v_rcp_f32 v68, v68
v_rcp_f32 v70, v70
v_rcp_f32 v69, v69
v_rcp_f32 v71, v71
v_pk_mul_f32 v[136:137], v[136:137], v[68:69]
v_pk_mul_f32 v[138:139], v[138:139], v[70:71]
v_pk_fma_f32 v[140:141], v[32:33], v[60:61], v[140:141] op_sel_hi:[1,0,1] neg_lo:[0,1,0] neg_hi:[0,1,0]
v_pk_fma_f32 v[142:143], v[34:35], v[60:61], v[142:143] op_sel_hi:[1,0,1] neg_lo:[0,1,0] neg_hi:[0,1,0]
v_pk_mul_f32 v[68:69], v[140:141], v[140:141]
v_pk_mul_f32 v[70:71], v[142:143], v[142:143]
v_pk_fma_f32 v[68:69], v[68:69], v[62:63], v[62:63] op_sel:[0,1,0] op_sel_hi:[1,1,0]
v_pk_fma_f32 v[70:71], v[70:71], v[62:63], v[62:63] op_sel:[0,1,0] op_sel_hi:[1,1,0]
v_pk_mul_f32 v[68:69], v[68:69], v[140:141]
v_pk_mul_f32 v[70:71], v[70:71], v[142:143]
v_exp_f32 v68, v68
v_exp_f32 v70, v70
v_exp_f32 v69, v69
v_exp_f32 v71, v71
v_pk_fma_f32 v[68:69], v[68:69], v[60:61], v[60:61] op_sel:[0,1,1] op_sel_hi:[1,1,1]
v_pk_fma_f32 v[70:71], v[70:71], v[60:61], v[60:61] op_sel:[0,1,1] op_sel_hi:[1,1,1]
v_rcp_f32 v68, v68
v_rcp_f32 v70, v70
v_rcp_f32 v69, v69
v_rcp_f32 v71, v71
v_pk_mul_f32 v[140:141], v[140:141], v[68:69]
v_pk_mul_f32 v[142:143], v[142:143], v[70:71]
v_pk_fma_f32 v[144:145], v[32:33], v[64:65], v[144:145] op_sel_hi:[1,0,1] neg_lo:[0,1,0] neg_hi:[0,1,0]
v_pk_fma_f32 v[146:147], v[34:35], v[64:65], v[146:147] op_sel_hi:[1,0,1] neg_lo:[0,1,0] neg_hi:[0,1,0]
v_pk_mul_f32 v[68:69], v[144:145], v[144:145]
v_pk_mul_f32 v[70:71], v[146:147], v[146:147]
v_pk_fma_f32 v[68:69], v[68:69], v[66:67], v[66:67] op_sel:[0,1,0] op_sel_hi:[1,1,0]
v_pk_fma_f32 v[70:71], v[70:71], v[66:67], v[66:67] op_sel:[0,1,0] op_sel_hi:[1,1,0]
v_pk_mul_f32 v[68:69], v[68:69], v[144:145]
v_pk_mul_f32 v[70:71], v[70:71], v[146:147]
v_exp_f32 v68, v68
v_exp_f32 v70, v70
v_exp_f32 v69, v69
v_exp_f32 v71, v71
v_pk_fma_f32 v[68:69], v[68:69], v[64:65], v[64:65] op_sel:[0,1,1] op_sel_hi:[1,1,1]
v_pk_fma_f32 v[70:71], v[70:71], v[64:65], v[64:65] op_sel:[0,1,1] op_sel_hi:[1,1,1]
v_rcp_f32 v68, v68
v_rcp_f32 v70, v70
v_rcp_f32 v69, v69
v_rcp_f32 v71, v71
v_pk_mul_f32 v[144:145], v[144:145], v[68:69]
v_pk_mul_f32 v[146:147], v[146:147], v[70:71]
s_waitcnt vmcnt(16)
v_cmp_ne_u32 vcc, s6, v4
s_cbranch_vccz Lks_pqo44
s_mov_b32 s37, 0
Lks_poll45:
buffer_load_dword v3, v50, s[8:11], s5 offen sc1
s_add_u32 s37, s37, 1
s_cmp_gt_u32 s37, 131072
s_cbranch_scc1 Lks_pok46
s_waitcnt vmcnt(0)
v_cmp_ne_u32_e64 vcc, s6, v3
s_cbranch_vccnz Lks_poll45
Lks_pok46:
s_waitcnt vmcnt(0)
Lks_pqo44:
s_add_u32 s56, s21, 0
buffer_load_dwordx4 v[116:119], v5, s[8:11], s56 offen offset:0 sc1
buffer_load_dwordx4 v[120:123], v5, s[8:11], s56 offen offset:1024 sc1
buffer_load_dwordx4 v[124:127], v5, s[8:11], s56 offen offset:2048 sc1
buffer_load_dwordx4 v[128:131], v5, s[8:11], s56 offen offset:3072 sc1
s_add_u32 s56, s21, 4096
buffer_load_dwordx4 v[148:151], v5, s[8:11], s56 offen offset:0 sc1
buffer_load_dwordx4 v[152:155], v5, s[8:11], s56 offen offset:1024 sc1
buffer_load_dwordx4 v[156:159], v5, s[8:11], s56 offen offset:2048 sc1
buffer_load_dwordx4 v[160:163], v5, s[8:11], s56 offen offset:3072 sc1
s_add_u32 s56, s21, 8192
buffer_load_dwordx4 v[164:167], v5, s[8:11], s56 offen offset:0 sc1
buffer_load_dwordx4 v[176:179], v5, s[8:11], s56 offen offset:1024 sc1
buffer_load_dwordx4 v[180:183], v5, s[8:11], s56 offen offset:2048 sc1
buffer_load_dwordx4 v[184:187], v5, s[8:11], s56 offen offset:3072 sc1
s_lshl_b32 s34, s20, 10
s_add_u32 s34, s34, 148480
s_mul_i32 s36, s20, 6144
s_add_u32 s36, s36, s34
s_mul_i32 s35, s20, 12288
s_sub_u32 s35, s36, s35
v_add_u32 v2, s36, v5
v_add_u32_e64 v3, s35, v5
v_cvt_pk_bf16_f32 v132, v132, v133
v_cvt_pk_bf16_f32 v133, v134, v135
ds_write_b64 v2, v[132:133] offset:0
v_cvt_pk_bf16_f32 v136, v136, v137
v_cvt_pk_bf16_f32 v137, v138, v139
ds_write_b64 v2, v[136:137] offset:3072
v_cvt_pk_bf16_f32 v140, v140, v141
v_cvt_pk_bf16_f32 v141, v142, v143
ds_write_b64 v3, v[140:141] offset:6144
v_cvt_pk_bf16_f32 v144, v144, v145
v_cvt_pk_bf16_f32 v145, v146, v147
ds_write_b64 v3, v[144:145] offset:9216
s_waitcnt lgkmcnt(0)
Lks_C:
v_mov_b32 v24, v168
v_mov_b32 v25, v169
v_mov_b32 v26, v170
v_mov_b32 v27, v171
v_mov_b32 v28, v172
v_mov_b32 v29, v173
v_mov_b32 v30, v174
v_mov_b32_e64 v31, v175
s_add_u32 s56, s21, 12288
buffer_load_dwordx4 v[188:191], v5, s[8:11], s56 offen offset:0 sc1
buffer_load_dwordx4 v[132:135], v5, s[8:11], s56 offen offset:1024 sc1
buffer_load_dwordx4 v[136:139], v5, s[8:11], s56 offen offset:2048 sc1
buffer_load_dwordx4 v[140:143], v5, s[8:11], s56 offen offset:3072 sc1
s_add_u32 s56, s21, 16384
buffer_load_dwordx4 v[144:147], v5, s[8:11], s56 offen offset:0 sc1
buffer_load_dwordx4 v[168:171], v5, s[8:11], s56 offen offset:1024 sc1
buffer_load_dwordx4 v[172:175], v5, s[8:11], s56 offen offset:2048 sc1
s_waitcnt vmcnt(18)
s_waitcnt vmcnt(17)
v_mfma_f32_16x16x32_bf16 v[52:55], v[116:119], v[192:195], 0
s_mul_i32 s22, s18, 122880
s_add_u32 s22, s22, 0xc00000
v_mfma_f32_16x16x32_bf16 v[68:71], v[116:119], v[196:199], 0
s_lshl_b32 s25, s16, 11
s_add_u32 s26, s22, s25
v_mfma_f32_16x16x32_bf16 v[84:87], v[116:119], v[224:227], 0
s_lshl_b32 s28, s16, 12
s_add_u32 s22, s22, s28
v_mfma_f32_16x16x32_bf16 v[100:103], v[116:119], v[228:231], 0
buffer_load_dwordx4 v[116:119], v5, s[8:11], s56 offen offset:3072 sc1
v_mfma_f32_16x16x32_bf16 v[56:59], v[120:123], v[192:195], 0
s_lshl_b32 s23, s17, 2
s_add_u32 s23, s23, s16
v_mfma_f32_16x16x32_bf16 v[72:75], v[120:123], v[196:199], 0
s_lshl_b32 s36, s23, 5
v_lshl_add_u32 v2, v7, 1, s36
v_mfma_f32_16x16x32_bf16 v[88:91], v[120:123], v[224:227], 0
global_load_ushort v20, v2, s[38:39]
s_xor_b32 s36, s16, 1
v_mfma_f32_16x16x32_bf16 v[104:107], v[120:123], v[228:231], 0
s_add_u32 s56, s21, 20480
buffer_load_dwordx4 v[120:123], v5, s[8:11], s56 offen offset:0 sc1
s_waitcnt vmcnt(18)
v_mfma_f32_16x16x32_bf16 v[60:63], v[124:127], v[192:195], 0
s_mul_i32 s36, s36, 3
s_add_u32 s36, s36, 0
v_mfma_f32_16x16x32_bf16 v[76:79], v[124:127], v[196:199], 0
s_lshl_b32 s35, s36, 12
s_add_u32 s35, s35, 98304
v_mfma_f32_16x16x32_bf16 v[92:95], v[124:127], v[224:227], 0
v_add_u32 v11, s35, v5
s_lshl_b32 s35, s36, 11
v_mfma_f32_16x16x32_bf16 v[108:111], v[124:127], v[228:231], 0
buffer_load_dwordx4 v[124:127], v5, s[8:11], s56 offen offset:1024 sc1
v_mfma_f32_16x16x32_bf16 v[64:67], v[128:131], v[192:195], 0
s_add_u32 s35, s35, 122880
v_add_u32_e64 v16, s35, v5
v_mfma_f32_16x16x32_bf16 v[80:83], v[128:131], v[196:199], 0
s_xor_b32 s36, s16, 2
s_mul_i32 s36, s36, 3
v_mfma_f32_16x16x32_bf16 v[96:99], v[128:131], v[224:227], 0
s_add_u32 s36, s36, 1
s_lshl_b32 s35, s36, 12
v_mfma_f32_16x16x32_bf16 v[112:115], v[128:131], v[228:231], 0
buffer_load_dwordx4 v[128:131], v5, s[8:11], s56 offen offset:2048 sc1
buffer_load_dword v4, v51, s[8:11], s5 offen sc1
s_waitcnt vmcnt(19)
v_mfma_f32_16x16x32_bf16 v[52:55], v[148:151], v[200:203], v[52:55]
s_add_u32 s35, s35, 98304
v_add_u32 v12, s35, v5
v_mfma_f32_16x16x32_bf16 v[68:71], v[148:151], v[204:207], v[68:71]
s_lshl_b32 s35, s36, 11
s_add_u32 s35, s35, 122880
v_mfma_f32_16x16x32_bf16 v[84:87], v[148:151], v[232:235], v[84:87]
v_add_u32_e64 v17, s35, v5
s_xor_b32 s36, s16, 3
v_mfma_f32_16x16x32_bf16 v[100:103], v[148:151], v[236:239], v[100:103]
buffer_load_dwordx4 v[148:151], v5, s[8:11], s56 offen offset:3072 sc1
v_mfma_f32_16x16x32_bf16 v[56:59], v[152:155], v[200:203], v[56:59]
s_mul_i32 s36, s36, 3
s_add_u32 s36, s36, 2
v_mfma_f32_16x16x32_bf16 v[72:75], v[152:155], v[204:207], v[72:75]
s_lshl_b32 s35, s36, 12
s_add_u32 s35, s35, 98304
v_mfma_f32_16x16x32_bf16 v[88:91], v[152:155], v[232:235], v[88:91]
v_add_u32_e64 v13, s35, v5
s_lshl_b32 s35, s36, 11
v_mfma_f32_16x16x32_bf16 v[104:107], v[152:155], v[236:239], v[104:107]
s_add_u32 s56, s21, 24576
buffer_load_dwordx4 v[152:155], v5, s[8:11], s56 offen offset:0 sc1
s_waitcnt vmcnt(19)
v_mfma_f32_16x16x32_bf16 v[60:63], v[156:159], v[200:203], v[60:63]
s_add_u32 s35, s35, 122880
v_add_u32 v18, s35, v5
v_mfma_f32_16x16x32_bf16 v[76:79], v[156:159], v[204:207], v[76:79]
s_mul_i32 s36, s16, 12288
s_add_u32 s36, s36, 98304
v_mfma_f32_16x16x32_bf16 v[92:95], v[156:159], v[232:235], v[92:95]
v_add_u32_e64 v14, s36, v5
s_mul_i32 s36, s16, 6144
v_mfma_f32_16x16x32_bf16 v[108:111], v[156:159], v[236:239], v[108:111]
buffer_load_dwordx4 v[156:159], v5, s[8:11], s56 offen offset:1024 sc1
v_mfma_f32_16x16x32_bf16 v[64:67], v[160:163], v[200:203], v[64:67]
s_add_u32 s36, s36, 122880
v_add_u32_e64 v15, s36, v5
v_mfma_f32_16x16x32_bf16 v[80:83], v[160:163], v[204:207], v[80:83]
v_add_u32 v6, 61440, v5
s_mul_i32 s36, s16, 3072
v_mfma_f32_16x16x32_bf16 v[96:99], v[160:163], v[232:235], v[96:99]
s_add_u32 s36, s36, 147456
v_add_u32_e64 v19, s36, v5
v_mfma_f32_16x16x32_bf16 v[112:115], v[160:163], v[236:239], v[112:115]
buffer_load_dwordx4 v[160:163], v5, s[8:11], s56 offen offset:2048 sc1
s_waitcnt vmcnt(19)
v_mfma_f32_16x16x32_bf16 v[52:55], v[164:167], v[208:211], v[52:55]
s_mul_i32 s32, s23, 24576
s_add_u32 s32, s32, 0x1040000
v_mfma_f32_16x16x32_bf16 v[68:71], v[164:167], v[212:215], v[68:71]
s_mov_b32 s24, s32
s_lshl_b32 s31, s18, 10
v_mfma_f32_16x16x32_bf16 v[84:87], v[164:167], v[240:243], v[84:87]
s_add_u32 s30, s32, s31
s_add_u32 s29, s30, 16384
v_mfma_f32_16x16x32_bf16 v[100:103], v[164:167], v[244:247], v[100:103]
buffer_load_dwordx4 v[164:167], v5, s[8:11], s56 offen offset:3072 sc1
v_mfma_f32_16x16x32_bf16 v[56:59], v[176:179], v[208:211], v[56:59]
s_add_u32 s30, s30, s31
s_lshl_b32 s35, s17, 10
v_mfma_f32_16x16x32_bf16 v[72:75], v[176:179], v[212:215], v[72:75]
s_lshl_b32 s31, s18, 7
s_add_u32 s34, s35, 0x9d8000
v_mfma_f32_16x16x32_bf16 v[88:91], v[176:179], v[240:243], v[88:91]
s_add_u32 s33, s34, s31
v_mov_b32_e64 v36, -1
v_mfma_f32_16x16x32_bf16 v[104:107], v[176:179], v[244:247], v[104:107]
s_add_u32 s56, s21, 28672
buffer_load_dwordx4 v[176:179], v5, s[8:11], s56 offen offset:0 sc1
s_waitcnt vmcnt(19)
v_mfma_f32_16x16x32_bf16 v[60:63], v[180:183], v[208:211], v[60:63]
v_mov_b32 v37, -1
v_mov_b32 v38, -1
v_mfma_f32_16x16x32_bf16 v[76:79], v[180:183], v[212:215], v[76:79]
v_mov_b32 v39, -1
buffer_store_dwordx4 v[36:39], v5, s[8:11], s30 offen sc1
v_mfma_f32_16x16x32_bf16 v[92:95], v[180:183], v[240:243], v[92:95]
v_mfma_f32_16x16x32_bf16 v[108:111], v[180:183], v[244:247], v[108:111]
buffer_load_dwordx4 v[180:183], v5, s[8:11], s56 offen offset:1024 sc1
v_mfma_f32_16x16x32_bf16 v[64:67], v[184:187], v[208:211], v[64:67]
v_mfma_f32_16x16x32_bf16 v[80:83], v[184:187], v[212:215], v[80:83]
buffer_store_dwordx4 v[36:39], v5, s[8:11], s30 offen offset:1024 sc1
v_mfma_f32_16x16x32_bf16 v[96:99], v[184:187], v[240:243], v[96:99]
v_mfma_f32_16x16x32_bf16 v[112:115], v[184:187], v[244:247], v[112:115]
buffer_load_dwordx4 v[184:187], v5, s[8:11], s56 offen offset:2048 sc1
s_waitcnt vmcnt(21)
v_mfma_f32_16x16x32_bf16 v[52:55], v[188:191], v[216:219], v[52:55]
v_mfma_f32_16x16x32_bf16 v[68:71], v[188:191], v[220:223], v[68:71]
buffer_store_dwordx4 v[36:39], v5, s[8:11], s29 offen sc1
v_mfma_f32_16x16x32_bf16 v[84:87], v[188:191], v[248:251], v[84:87]
v_mfma_f32_16x16x32_bf16 v[100:103], v[188:191], v[252:255], v[100:103]
buffer_load_dwordx4 v[188:191], v5, s[8:11], s56 offen offset:3072 sc1
v_mfma_f32_16x16x32_bf16 v[56:59], v[132:135], v[216:219], v[56:59]
v_mfma_f32_16x16x32_bf16 v[72:75], v[132:135], v[220:223], v[72:75]
ds_read_b128 a[80:83], v24 offset:0
v_mfma_f32_16x16x32_bf16 v[88:91], v[132:135], v[248:251], v[88:91]
s_nop 0
ds_read_b128 a[84:87], v25 offset:0
ds_read_b128 a[88:91], v26 offset:0
v_mfma_f32_16x16x32_bf16 v[104:107], v[132:135], v[252:255], v[104:107]
s_add_u32 s56, s21, 32768
buffer_load_dwordx4 v[132:135], v5, s[8:11], s56 offen offset:0 sc1
s_waitcnt vmcnt(22)
v_mfma_f32_16x16x32_bf16 v[60:63], v[136:139], v[216:219], v[60:63]
ds_read_b128 a[92:95], v27 offset:0
ds_read_b128 a[96:99], v28 offset:0
v_mfma_f32_16x16x32_bf16 v[76:79], v[136:139], v[220:223], v[76:79]
ds_read_b128 a[100:103], v29 offset:0
ds_read_b128 a[104:107], v30 offset:0
v_mfma_f32_16x16x32_bf16 v[92:95], v[136:139], v[248:251], v[92:95]
ds_read_b128 a[108:111], v31 offset:0
ds_read_b128 a[160:163], v24 offset:8192
v_mfma_f32_16x16x32_bf16 v[108:111], v[136:139], v[252:255], v[108:111]
buffer_load_dwordx4 v[136:139], v5, s[8:11], s56 offen offset:1024 sc1
v_mfma_f32_16x16x32_bf16 v[64:67], v[140:143], v[216:219], v[64:67]
ds_read_b128 a[164:167], v25 offset:8192
ds_read_b128 a[168:171], v26 offset:8192
v_mfma_f32_16x16x32_bf16 v[80:83], v[140:143], v[220:223], v[80:83]
ds_read_b128 a[172:175], v27 offset:8192
ds_read_b128 a[176:179], v28 offset:8192
v_mfma_f32_16x16x32_bf16 v[96:99], v[140:143], v[248:251], v[96:99]
ds_read_b128 a[180:183], v29 offset:8192
ds_read_b128 a[184:187], v30 offset:8192
v_mfma_f32_16x16x32_bf16 v[112:115], v[140:143], v[252:255], v[112:115]
buffer_load_dwordx4 v[140:143], v5, s[8:11], s56 offen offset:2048 sc1
s_waitcnt vmcnt(22)
v_mfma_f32_16x16x32_bf16 v[52:55], v[144:147], a[0:3], v[52:55]
ds_read_b128 a[188:191], v31 offset:8192
v_subrev_u32 v24, 69632, v24
v_mfma_f32_16x16x32_bf16 v[68:71], v[144:147], a[4:7], v[68:71]
v_subrev_u32 v25, 69632, v25
v_subrev_u32 v26, 69632, v26
v_mfma_f32_16x16x32_bf16 v[84:87], v[144:147], a[32:35], v[84:87]
v_subrev_u32 v27, 69632, v27
v_subrev_u32 v28, 69632, v28
v_mfma_f32_16x16x32_bf16 v[100:103], v[144:147], a[36:39], v[100:103]
buffer_load_dwordx4 v[144:147], v5, s[8:11], s56 offen offset:3072 sc1
v_mfma_f32_16x16x32_bf16 v[56:59], v[168:171], a[0:3], v[56:59]
v_subrev_u32 v29, 69632, v29
v_subrev_u32 v30, 69632, v30
v_mfma_f32_16x16x32_bf16 v[72:75], v[168:171], a[4:7], v[72:75]
v_subrev_u32 v31, 69632, v31
ds_read_b128 a[112:115], v24 offset:0
v_mfma_f32_16x16x32_bf16 v[88:91], v[168:171], a[32:35], v[88:91]
ds_read_b128 a[116:119], v25 offset:0
ds_read_b128 a[120:123], v26 offset:0
v_mfma_f32_16x16x32_bf16 v[104:107], v[168:171], a[36:39], v[104:107]
s_add_u32 s56, s21, 36864
buffer_load_dwordx4 v[168:171], v5, s[8:11], s56 offen offset:0 sc1
s_waitcnt vmcnt(22)
v_mfma_f32_16x16x32_bf16 v[60:63], v[172:175], a[0:3], v[60:63]
ds_read_b128 a[124:127], v27 offset:0
ds_read_b128 a[128:131], v28 offset:0
v_mfma_f32_16x16x32_bf16 v[76:79], v[172:175], a[4:7], v[76:79]
ds_read_b128 a[132:135], v29 offset:0
ds_read_b128 a[136:139], v30 offset:0
v_mfma_f32_16x16x32_bf16 v[92:95], v[172:175], a[32:35], v[92:95]
ds_read_b128 a[140:143], v31 offset:0
ds_read_b128 a[192:195], v24 offset:8192
v_mfma_f32_16x16x32_bf16 v[108:111], v[172:175], a[36:39], v[108:111]
buffer_load_dwordx4 v[172:175], v5, s[8:11], s56 offen offset:1024 sc1
v_mfma_f32_16x16x32_bf16 v[64:67], v[116:119], a[0:3], v[64:67]
ds_read_b128 a[196:199], v25 offset:8192
ds_read_b128 a[200:203], v26 offset:8192
v_mfma_f32_16x16x32_bf16 v[80:83], v[116:119], a[4:7], v[80:83]
ds_read_b128 a[204:207], v27 offset:8192
ds_read_b128 a[208:211], v28 offset:8192
v_mfma_f32_16x16x32_bf16 v[96:99], v[116:119], a[32:35], v[96:99]
ds_read_b128 a[212:215], v29 offset:8192
ds_read_b128 a[216:219], v30 offset:8192
v_mfma_f32_16x16x32_bf16 v[112:115], v[116:119], a[36:39], v[112:115]
buffer_load_dwordx4 v[116:119], v5, s[8:11], s56 offen offset:2048 sc1
s_waitcnt vmcnt(19)
v_cmp_ne_u32 vcc, s6, v4
s_cbranch_vccz Lks_fok47
s_mov_b32 s37, 0
Lks_poll48:
buffer_load_dword v3, v51, s[8:11], s5 offen sc1
s_add_u32 s37, s37, 1
s_cmp_gt_u32 s37, 131072
s_cbranch_scc1 Lks_pok49
s_waitcnt vmcnt(0)
v_cmp_ne_u32_e64 vcc, s6, v3
s_cbranch_vccnz Lks_poll48
Lks_pok49:
s_waitcnt vmcnt(0)
Lks_fok47:
v_mfma_f32_16x16x32_bf16 v[52:55], v[120:123], a[8:11], v[52:55]
ds_read_b128 a[220:223], v31 offset:8192
v_mfma_f32_16x16x32_bf16 v[68:71], v[120:123], a[12:15], v[68:71]
v_mfma_f32_16x16x32_bf16 v[84:87], v[120:123], a[40:43], v[84:87]
v_mfma_f32_16x16x32_bf16 v[100:103], v[120:123], a[44:47], v[100:103]
buffer_load_dwordx4 v[120:123], v5, s[8:11], s56 offen offset:3072 sc1
v_mfma_f32_16x16x32_bf16 v[56:59], v[124:127], a[8:11], v[56:59]
v_mfma_f32_16x16x32_bf16 v[72:75], v[124:127], a[12:15], v[72:75]
v_mfma_f32_16x16x32_bf16 v[88:91], v[124:127], a[40:43], v[88:91]
v_mfma_f32_16x16x32_bf16 v[104:107], v[124:127], a[44:47], v[104:107]
s_add_u32 s56, s21, 40960
buffer_load_dwordx4 v[124:127], v5, s[8:11], s56 offen offset:0 sc1
s_waitcnt vmcnt(20)
v_mfma_f32_16x16x32_bf16 v[60:63], v[128:131], a[8:11], v[60:63]
v_mfma_f32_16x16x32_bf16 v[76:79], v[128:131], a[12:15], v[76:79]
v_mfma_f32_16x16x32_bf16 v[92:95], v[128:131], a[40:43], v[92:95]
v_mfma_f32_16x16x32_bf16 v[108:111], v[128:131], a[44:47], v[108:111]
buffer_load_dwordx4 v[128:131], v5, s[8:11], s56 offen offset:1024 sc1
v_mfma_f32_16x16x32_bf16 v[64:67], v[148:151], a[8:11], v[64:67]
v_mfma_f32_16x16x32_bf16 v[80:83], v[148:151], a[12:15], v[80:83]
v_mfma_f32_16x16x32_bf16 v[96:99], v[148:151], a[40:43], v[96:99]
v_mfma_f32_16x16x32_bf16 v[112:115], v[148:151], a[44:47], v[112:115]
buffer_load_dwordx4 v[148:151], v5, s[8:11], s56 offen offset:2048 sc1
s_waitcnt vmcnt(20)
v_mfma_f32_16x16x32_bf16 v[52:55], v[152:155], a[16:19], v[52:55]
v_mfma_f32_16x16x32_bf16 v[68:71], v[152:155], a[20:23], v[68:71]
v_mfma_f32_16x16x32_bf16 v[84:87], v[152:155], a[48:51], v[84:87]
v_mfma_f32_16x16x32_bf16 v[100:103], v[152:155], a[52:55], v[100:103]
buffer_load_dwordx4 v[152:155], v5, s[8:11], s56 offen offset:3072 sc1
v_mfma_f32_16x16x32_bf16 v[56:59], v[156:159], a[16:19], v[56:59]
v_mfma_f32_16x16x32_bf16 v[72:75], v[156:159], a[20:23], v[72:75]
v_mfma_f32_16x16x32_bf16 v[88:91], v[156:159], a[48:51], v[88:91]
v_mfma_f32_16x16x32_bf16 v[104:107], v[156:159], a[52:55], v[104:107]
s_add_u32 s56, s21, 45056
buffer_load_dwordx4 v[156:159], v5, s[8:11], s56 offen offset:0 sc1
s_waitcnt vmcnt(20)
v_mfma_f32_16x16x32_bf16 v[60:63], v[160:163], a[16:19], v[60:63]
v_mfma_f32_16x16x32_bf16 v[76:79], v[160:163], a[20:23], v[76:79]
v_mfma_f32_16x16x32_bf16 v[92:95], v[160:163], a[48:51], v[92:95]
v_mfma_f32_16x16x32_bf16 v[108:111], v[160:163], a[52:55], v[108:111]
buffer_load_dwordx4 v[160:163], v5, s[8:11], s56 offen offset:1024 sc1
v_mfma_f32_16x16x32_bf16 v[64:67], v[164:167], a[16:19], v[64:67]
v_mfma_f32_16x16x32_bf16 v[80:83], v[164:167], a[20:23], v[80:83]
v_mfma_f32_16x16x32_bf16 v[96:99], v[164:167], a[48:51], v[96:99]
v_mfma_f32_16x16x32_bf16 v[112:115], v[164:167], a[52:55], v[112:115]
buffer_load_dwordx4 v[164:167], v5, s[8:11], s56 offen offset:2048 sc1
s_waitcnt vmcnt(19)
v_mfma_f32_16x16x32_bf16 v[52:55], v[176:179], a[24:27], v[52:55]
v_mfma_f32_16x16x32_bf16 v[68:71], v[176:179], a[28:31], v[68:71]
v_mfma_f32_16x16x32_bf16 v[84:87], v[176:179], a[56:59], v[84:87]
v_mfma_f32_16x16x32_bf16 v[100:103], v[176:179], a[60:63], v[100:103]
buffer_load_dwordx4 v[176:179], v5, s[8:11], s56 offen offset:3072 sc1
v_mfma_f32_16x16x32_bf16 v[56:59], v[180:183], a[24:27], v[56:59]
v_mfma_f32_16x16x32_bf16 v[72:75], v[180:183], a[28:31], v[72:75]
v_mfma_f32_16x16x32_bf16 v[88:91], v[180:183], a[56:59], v[88:91]
v_mfma_f32_16x16x32_bf16 v[104:107], v[180:183], a[60:63], v[104:107]
s_add_u32 s56, s21, 49152
buffer_load_dwordx4 v[180:183], v5, s[8:11], s56 offen offset:0 sc1
s_waitcnt vmcnt(17)
v_mfma_f32_16x16x32_bf16 v[60:63], v[184:187], a[24:27], v[60:63]
v_mfma_f32_16x16x32_bf16 v[76:79], v[184:187], a[28:31], v[76:79]
v_mfma_f32_16x16x32_bf16 v[92:95], v[184:187], a[56:59], v[92:95]
v_mfma_f32_16x16x32_bf16 v[108:111], v[184:187], a[60:63], v[108:111]
buffer_load_dwordx4 v[184:187], v5, s[8:11], s56 offen offset:1024 sc1
v_mfma_f32_16x16x32_bf16 v[64:67], v[188:191], a[24:27], v[64:67]
v_mfma_f32_16x16x32_bf16 v[80:83], v[188:191], a[28:31], v[80:83]
v_mfma_f32_16x16x32_bf16 v[96:99], v[188:191], a[56:59], v[96:99]
v_mfma_f32_16x16x32_bf16 v[112:115], v[188:191], a[60:63], v[112:115]
buffer_load_dwordx4 v[188:191], v5, s[8:11], s56 offen offset:2048 sc1
s_waitcnt lgkmcnt(0)
s_waitcnt vmcnt(17)
v_mfma_f32_16x16x32_bf16 v[52:55], v[132:135], a[80:83], v[52:55]
v_mfma_f32_16x16x32_bf16 v[68:71], v[132:135], a[84:87], v[68:71]
v_mfma_f32_16x16x32_bf16 v[84:87], v[132:135], a[160:163], v[84:87]
v_mfma_f32_16x16x32_bf16 v[100:103], v[132:135], a[164:167], v[100:103]
buffer_load_dwordx4 v[132:135], v5, s[8:11], s56 offen offset:3072 sc1
v_mfma_f32_16x16x32_bf16 v[56:59], v[136:139], a[80:83], v[56:59]
v_mfma_f32_16x16x32_bf16 v[72:75], v[136:139], a[84:87], v[72:75]
v_mfma_f32_16x16x32_bf16 v[88:91], v[136:139], a[160:163], v[88:91]
v_mfma_f32_16x16x32_bf16 v[104:107], v[136:139], a[164:167], v[104:107]
s_add_u32 s56, s21, 53248
buffer_load_dwordx4 v[136:139], v5, s[8:11], s56 offen offset:0 sc1
s_waitcnt vmcnt(17)
v_mfma_f32_16x16x32_bf16 v[60:63], v[140:143], a[80:83], v[60:63]
v_mfma_f32_16x16x32_bf16 v[76:79], v[140:143], a[84:87], v[76:79]
v_mfma_f32_16x16x32_bf16 v[92:95], v[140:143], a[160:163], v[92:95]
v_mfma_f32_16x16x32_bf16 v[108:111], v[140:143], a[164:167], v[108:111]
buffer_load_dwordx4 v[140:143], v5, s[8:11], s56 offen offset:1024 sc1
v_mfma_f32_16x16x32_bf16 v[64:67], v[144:147], a[80:83], v[64:67]
v_mfma_f32_16x16x32_bf16 v[80:83], v[144:147], a[84:87], v[80:83]
v_mfma_f32_16x16x32_bf16 v[96:99], v[144:147], a[160:163], v[96:99]
v_mfma_f32_16x16x32_bf16 v[112:115], v[144:147], a[164:167], v[112:115]
buffer_load_dwordx4 v[144:147], v5, s[8:11], s56 offen offset:2048 sc1
s_barrier
s_cmp_lg_u32 s16, 0
s_cbranch_scc1 Lks_sig50
v_mov_b32 v2, 0
v_mov_b32 v3, s6
s_mov_b64 exec, 1
buffer_store_dword v3, v2, s[8:11], s33 offen sc1
s_mov_b64 exec, -1
Lks_sig50:
ds_read_b128 v[24:27], v19 offset:0
ds_read_b128 v[28:31], v19 offset:1024
ds_read_b128 v[32:35], v19 offset:2048
s_waitcnt vmcnt(17)
v_mfma_f32_16x16x32_bf16 v[52:55], v[168:171], a[88:91], v[52:55]
v_mfma_f32_16x16x32_bf16 v[68:71], v[168:171], a[92:95], v[68:71]
v_mfma_f32_16x16x32_bf16 v[84:87], v[168:171], a[168:171], v[84:87]
v_mfma_f32_16x16x32_bf16 v[100:103], v[168:171], a[172:175], v[100:103]
buffer_load_dwordx4 v[168:171], v5, s[8:11], s56 offen offset:3072 sc1
v_mfma_f32_16x16x32_bf16 v[56:59], v[172:175], a[88:91], v[56:59]
v_mfma_f32_16x16x32_bf16 v[72:75], v[172:175], a[92:95], v[72:75]
v_mfma_f32_16x16x32_bf16 v[88:91], v[172:175], a[168:171], v[88:91]
v_mfma_f32_16x16x32_bf16 v[104:107], v[172:175], a[172:175], v[104:107]
s_add_u32 s56, s21, 57344
buffer_load_dwordx4 v[172:175], v5, s[8:11], s56 offen offset:0 sc1
s_waitcnt vmcnt(17)
v_mfma_f32_16x16x32_bf16 v[60:63], v[116:119], a[88:91], v[60:63]
v_mfma_f32_16x16x32_bf16 v[76:79], v[116:119], a[92:95], v[76:79]
v_mfma_f32_16x16x32_bf16 v[92:95], v[116:119], a[168:171], v[92:95]
v_mfma_f32_16x16x32_bf16 v[108:111], v[116:119], a[172:175], v[108:111]
buffer_load_dwordx4 v[116:119], v5, s[8:11], s56 offen offset:1024 sc1
v_mfma_f32_16x16x32_bf16 v[64:67], v[120:123], a[88:91], v[64:67]
v_mfma_f32_16x16x32_bf16 v[80:83], v[120:123], a[92:95], v[80:83]
v_mfma_f32_16x16x32_bf16 v[96:99], v[120:123], a[168:171], v[96:99]
v_mfma_f32_16x16x32_bf16 v[112:115], v[120:123], a[172:175], v[112:115]
buffer_load_dwordx4 v[120:123], v5, s[8:11], s56 offen offset:2048 sc1
s_waitcnt vmcnt(17)
v_mfma_f32_16x16x32_bf16 v[52:55], v[124:127], a[96:99], v[52:55]
v_mfma_f32_16x16x32_bf16 v[68:71], v[124:127], a[100:103], v[68:71]
v_mfma_f32_16x16x32_bf16 v[84:87], v[124:127], a[176:179], v[84:87]
v_mfma_f32_16x16x32_bf16 v[100:103], v[124:127], a[180:183], v[100:103]
buffer_load_dwordx4 v[124:127], v5, s[8:11], s56 offen offset:3072 sc1
v_mfma_f32_16x16x32_bf16 v[56:59], v[128:131], a[96:99], v[56:59]
v_mfma_f32_16x16x32_bf16 v[72:75], v[128:131], a[100:103], v[72:75]
v_mfma_f32_16x16x32_bf16 v[88:91], v[128:131], a[176:179], v[88:91]
v_mfma_f32_16x16x32_bf16 v[104:107], v[128:131], a[180:183], v[104:107]
s_add_u32 s56, s21, 61440
buffer_load_dwordx4 v[128:131], v5, s[8:11], s56 offen offset:0 sc1
s_waitcnt vmcnt(17)
v_mfma_f32_16x16x32_bf16 v[60:63], v[148:151], a[96:99], v[60:63]
v_mfma_f32_16x16x32_bf16 v[76:79], v[148:151], a[100:103], v[76:79]
v_mfma_f32_16x16x32_bf16 v[92:95], v[148:151], a[176:179], v[92:95]
v_mfma_f32_16x16x32_bf16 v[108:111], v[148:151], a[180:183], v[108:111]
buffer_load_dwordx4 v[148:151], v5, s[8:11], s56 offen offset:1024 sc1
v_mfma_f32_16x16x32_bf16 v[64:67], v[152:155], a[96:99], v[64:67]
v_mfma_f32_16x16x32_bf16 v[80:83], v[152:155], a[100:103], v[80:83]
v_mfma_f32_16x16x32_bf16 v[96:99], v[152:155], a[176:179], v[96:99]
v_mfma_f32_16x16x32_bf16 v[112:115], v[152:155], a[180:183], v[112:115]
buffer_load_dwordx4 v[152:155], v5, s[8:11], s56 offen offset:2048 sc1
s_waitcnt vmcnt(17)
v_mfma_f32_16x16x32_bf16 v[52:55], v[156:159], a[104:107], v[52:55]
v_mfma_f32_16x16x32_bf16 v[68:71], v[156:159], a[108:111], v[68:71]
v_mfma_f32_16x16x32_bf16 v[84:87], v[156:159], a[184:187], v[84:87]
v_mfma_f32_16x16x32_bf16 v[100:103], v[156:159], a[188:191], v[100:103]
buffer_load_dwordx4 v[156:159], v5, s[8:11], s56 offen offset:3072 sc1
v_mfma_f32_16x16x32_bf16 v[56:59], v[160:163], a[104:107], v[56:59]
v_mfma_f32_16x16x32_bf16 v[72:75], v[160:163], a[108:111], v[72:75]
v_mfma_f32_16x16x32_bf16 v[88:91], v[160:163], a[184:187], v[88:91]
v_mfma_f32_16x16x32_bf16 v[104:107], v[160:163], a[188:191], v[104:107]
s_add_u32 s56, s54, 0
buffer_load_dwordx4 v[160:163], v5, s[8:11], s56 offen offset:0 sc1
s_waitcnt vmcnt(17)
v_mfma_f32_16x16x32_bf16 v[60:63], v[164:167], a[104:107], v[60:63]
v_mfma_f32_16x16x32_bf16 v[76:79], v[164:167], a[108:111], v[76:79]
v_mfma_f32_16x16x32_bf16 v[92:95], v[164:167], a[184:187], v[92:95]
v_mfma_f32_16x16x32_bf16 v[108:111], v[164:167], a[188:191], v[108:111]
buffer_load_dwordx4 v[164:167], v5, s[8:11], s56 offen offset:1024 sc1
v_mfma_f32_16x16x32_bf16 v[64:67], v[176:179], a[104:107], v[64:67]
v_mfma_f32_16x16x32_bf16 v[80:83], v[176:179], a[108:111], v[80:83]
v_mfma_f32_16x16x32_bf16 v[96:99], v[176:179], a[184:187], v[96:99]
v_mfma_f32_16x16x32_bf16 v[112:115], v[176:179], a[188:191], v[112:115]
buffer_load_dwordx4 v[176:179], v5, s[8:11], s56 offen offset:2048 sc1
s_waitcnt vmcnt(17)
v_mfma_f32_16x16x32_bf16 v[52:55], v[180:183], a[112:115], v[52:55]
v_mfma_f32_16x16x32_bf16 v[68:71], v[180:183], a[116:119], v[68:71]
v_mfma_f32_16x16x32_bf16 v[84:87], v[180:183], a[192:195], v[84:87]
v_mfma_f32_16x16x32_bf16 v[100:103], v[180:183], a[196:199], v[100:103]
buffer_load_dwordx4 v[180:183], v5, s[8:11], s56 offen offset:3072 sc1
v_mfma_f32_16x16x32_bf16 v[56:59], v[184:187], a[112:115], v[56:59]
v_mfma_f32_16x16x32_bf16 v[72:75], v[184:187], a[116:119], v[72:75]
v_mfma_f32_16x16x32_bf16 v[88:91], v[184:187], a[192:195], v[88:91]
v_mfma_f32_16x16x32_bf16 v[104:107], v[184:187], a[196:199], v[104:107]
s_add_u32 s56, s54, 4096
buffer_load_dwordx4 v[184:187], v5, s[8:11], s56 offen offset:0 sc1
s_waitcnt vmcnt(17)
v_mfma_f32_16x16x32_bf16 v[60:63], v[188:191], a[112:115], v[60:63]
v_mfma_f32_16x16x32_bf16 v[76:79], v[188:191], a[116:119], v[76:79]
v_mfma_f32_16x16x32_bf16 v[92:95], v[188:191], a[192:195], v[92:95]
v_mfma_f32_16x16x32_bf16 v[108:111], v[188:191], a[196:199], v[108:111]
buffer_load_dwordx4 v[188:191], v5, s[8:11], s56 offen offset:1024 sc1
v_mfma_f32_16x16x32_bf16 v[64:67], v[132:135], a[112:115], v[64:67]
v_mfma_f32_16x16x32_bf16 v[80:83], v[132:135], a[116:119], v[80:83]
v_mfma_f32_16x16x32_bf16 v[96:99], v[132:135], a[192:195], v[96:99]
v_mfma_f32_16x16x32_bf16 v[112:115], v[132:135], a[196:199], v[112:115]
buffer_load_dwordx4 v[132:135], v5, s[8:11], s56 offen offset:2048 sc1
buffer_load_dword v4, v51, s[8:11], s34 offen sc1
s_waitcnt vmcnt(18)
v_mfma_f32_16x16x32_bf16 v[52:55], v[136:139], a[120:123], v[52:55]
v_mfma_f32_16x16x32_bf16 v[68:71], v[136:139], a[124:127], v[68:71]
v_mfma_f32_16x16x32_bf16 v[84:87], v[136:139], a[200:203], v[84:87]
v_mfma_f32_16x16x32_bf16 v[100:103], v[136:139], a[204:207], v[100:103]
buffer_load_dwordx4 v[136:139], v5, s[8:11], s56 offen offset:3072 sc1
v_mfma_f32_16x16x32_bf16 v[56:59], v[140:143], a[120:123], v[56:59]
v_mfma_f32_16x16x32_bf16 v[72:75], v[140:143], a[124:127], v[72:75]
v_mfma_f32_16x16x32_bf16 v[88:91], v[140:143], a[200:203], v[88:91]
v_mfma_f32_16x16x32_bf16 v[104:107], v[140:143], a[204:207], v[104:107]
s_add_u32 s56, s54, 8192
buffer_load_dwordx4 v[140:143], v5, s[8:11], s56 offen offset:0 sc1
s_waitcnt vmcnt(18)
v_mfma_f32_16x16x32_bf16 v[60:63], v[144:147], a[120:123], v[60:63]
v_mfma_f32_16x16x32_bf16 v[76:79], v[144:147], a[124:127], v[76:79]
v_mfma_f32_16x16x32_bf16 v[92:95], v[144:147], a[200:203], v[92:95]
v_mfma_f32_16x16x32_bf16 v[108:111], v[144:147], a[204:207], v[108:111]
buffer_load_dwordx4 v[144:147], v5, s[8:11], s56 offen offset:1024 sc1
v_mfma_f32_16x16x32_bf16 v[64:67], v[168:171], a[120:123], v[64:67]
v_mfma_f32_16x16x32_bf16 v[80:83], v[168:171], a[124:127], v[80:83]
v_mfma_f32_16x16x32_bf16 v[96:99], v[168:171], a[200:203], v[96:99]
v_mfma_f32_16x16x32_bf16 v[112:115], v[168:171], a[204:207], v[112:115]
buffer_load_dwordx4 v[168:171], v5, s[8:11], s56 offen offset:2048 sc1
s_waitcnt vmcnt(18)
v_mfma_f32_16x16x32_bf16 v[52:55], v[172:175], a[128:131], v[52:55]
v_mfma_f32_16x16x32_bf16 v[68:71], v[172:175], a[132:135], v[68:71]
v_mfma_f32_16x16x32_bf16 v[84:87], v[172:175], a[208:211], v[84:87]
v_mfma_f32_16x16x32_bf16 v[100:103], v[172:175], a[212:215], v[100:103]
buffer_load_dwordx4 v[172:175], v5, s[8:11], s56 offen offset:3072 sc1
v_mfma_f32_16x16x32_bf16 v[56:59], v[116:119], a[128:131], v[56:59]
v_mfma_f32_16x16x32_bf16 v[72:75], v[116:119], a[132:135], v[72:75]
v_mfma_f32_16x16x32_bf16 v[88:91], v[116:119], a[208:211], v[88:91]
v_mfma_f32_16x16x32_bf16 v[104:107], v[116:119], a[212:215], v[104:107]
s_add_u32 s56, s54, 12288
buffer_load_dwordx4 v[116:119], v5, s[8:11], s56 offen offset:0 sc1
s_waitcnt vmcnt(18)
v_mfma_f32_16x16x32_bf16 v[60:63], v[120:123], a[128:131], v[60:63]
v_mfma_f32_16x16x32_bf16 v[76:79], v[120:123], a[132:135], v[76:79]
v_mfma_f32_16x16x32_bf16 v[92:95], v[120:123], a[208:211], v[92:95]
v_mfma_f32_16x16x32_bf16 v[108:111], v[120:123], a[212:215], v[108:111]
buffer_load_dwordx4 v[120:123], v5, s[8:11], s56 offen offset:1024 sc1
v_mfma_f32_16x16x32_bf16 v[64:67], v[124:127], a[128:131], v[64:67]
v_mfma_f32_16x16x32_bf16 v[80:83], v[124:127], a[132:135], v[80:83]
v_mfma_f32_16x16x32_bf16 v[96:99], v[124:127], a[208:211], v[96:99]
v_mfma_f32_16x16x32_bf16 v[112:115], v[124:127], a[212:215], v[112:115]
buffer_load_dwordx4 v[124:127], v5, s[8:11], s56 offen offset:2048 sc1
v_lshlrev_b32 v20, 16, v20
s_waitcnt vmcnt(18)
v_mfma_f32_16x16x32_bf16 v[52:55], v[128:131], a[136:139], v[52:55]
v_mfma_f32_16x16x32_bf16 v[68:71], v[128:131], a[140:143], v[68:71]
v_mfma_f32_16x16x32_bf16 v[84:87], v[128:131], a[216:219], v[84:87]
v_mfma_f32_16x16x32_bf16 v[100:103], v[128:131], a[220:223], v[100:103]
buffer_load_dwordx4 v[128:131], v5, s[8:11], s56 offen offset:3072 sc1
v_mfma_f32_16x16x32_bf16 v[56:59], v[148:151], a[136:139], v[56:59]
v_mfma_f32_16x16x32_bf16 v[72:75], v[148:151], a[140:143], v[72:75]
v_mfma_f32_16x16x32_bf16 v[88:91], v[148:151], a[216:219], v[88:91]
v_mfma_f32_16x16x32_bf16 v[104:107], v[148:151], a[220:223], v[104:107]
s_add_u32 s56, s54, 16384
buffer_load_dwordx4 v[148:151], v5, s[8:11], s56 offen offset:0 sc1
s_waitcnt vmcnt(18)
v_mfma_f32_16x16x32_bf16 v[60:63], v[152:155], a[136:139], v[60:63]
v_mfma_f32_16x16x32_bf16 v[76:79], v[152:155], a[140:143], v[76:79]
v_mfma_f32_16x16x32_bf16 v[92:95], v[152:155], a[216:219], v[92:95]
v_mfma_f32_16x16x32_bf16 v[108:111], v[152:155], a[220:223], v[108:111]
buffer_load_dwordx4 v[152:155], v5, s[8:11], s56 offen offset:1024 sc1
v_mfma_f32_16x16x32_bf16 v[64:67], v[156:159], a[136:139], v[64:67]
v_mfma_f32_16x16x32_bf16 v[80:83], v[156:159], a[140:143], v[80:83]
v_mfma_f32_16x16x32_bf16 v[96:99], v[156:159], a[216:219], v[96:99]
v_mfma_f32_16x16x32_bf16 v[112:115], v[156:159], a[220:223], v[112:115]
buffer_load_dwordx4 v[156:159], v5, s[8:11], s56 offen offset:2048 sc1
s_waitcnt vmcnt(18)
v_mfma_f32_16x16x32_bf16 a[224:227], v[160:163], v[192:195], 0
ds_write_b128 v11, v[68:71] offset:0
v_mfma_f32_16x16x32_bf16 a[232:235], v[160:163], v[196:199], 0
ds_write_b128 v12, v[84:87] offset:0
v_mfma_f32_16x16x32_bf16 a[240:243], v[160:163], v[224:227], 0
ds_write_b128 v13, v[100:103] offset:0
v_mfma_f32_16x16x32_bf16 a[248:251], v[160:163], v[228:231], 0
buffer_load_dwordx4 v[160:163], v5, s[8:11], s56 offen offset:3072 sc1
v_mfma_f32_16x16x32_bf16 a[228:231], v[164:167], v[192:195], 0
ds_write_b128 v11, v[72:75] offset:1024
v_mfma_f32_16x16x32_bf16 a[236:239], v[164:167], v[196:199], 0
ds_write_b128 v12, v[88:91] offset:1024
v_mfma_f32_16x16x32_bf16 a[244:247], v[164:167], v[224:227], 0
ds_write_b128 v13, v[104:107] offset:1024
v_mfma_f32_16x16x32_bf16 a[252:255], v[164:167], v[228:231], 0
s_add_u32 s56, s54, 20480
buffer_load_dwordx4 v[164:167], v5, s[8:11], s56 offen offset:0 sc1
s_waitcnt vmcnt(18)
v_mfma_f32_16x16x32_bf16 a[224:227], v[176:179], v[200:203], a[224:227]
ds_write_b128 v11, v[76:79] offset:2048
v_mfma_f32_16x16x32_bf16 a[232:235], v[176:179], v[204:207], a[232:235]
ds_write_b128 v12, v[92:95] offset:2048
v_mfma_f32_16x16x32_bf16 a[240:243], v[176:179], v[232:235], a[240:243]
ds_write_b128 v13, v[108:111] offset:2048
v_mfma_f32_16x16x32_bf16 a[248:251], v[176:179], v[236:239], a[248:251]
buffer_load_dwordx4 v[176:179], v5, s[8:11], s56 offen offset:1024 sc1
v_mfma_f32_16x16x32_bf16 a[228:231], v[180:183], v[200:203], a[228:231]
ds_write_b128 v11, v[80:83] offset:3072
v_mfma_f32_16x16x32_bf16 a[236:239], v[180:183], v[204:207], a[236:239]
ds_write_b128 v12, v[96:99] offset:3072
v_mfma_f32_16x16x32_bf16 a[244:247], v[180:183], v[232:235], a[244:247]
ds_write_b128 v13, v[112:115] offset:3072
v_mfma_f32_16x16x32_bf16 a[252:255], v[180:183], v[236:239], a[252:255]
buffer_load_dwordx4 v[180:183], v5, s[8:11], s56 offen offset:2048 sc1
s_waitcnt vmcnt(18)
v_mfma_f32_16x16x32_bf16 a[224:227], v[184:187], v[208:211], a[224:227]
v_add_f32 v52, v20, v52
v_add_f32 v53, v20, v53
v_mfma_f32_16x16x32_bf16 a[232:235], v[184:187], v[212:215], a[232:235]
v_add_f32 v54, v20, v54
v_add_f32 v55, v20, v55
v_mfma_f32_16x16x32_bf16 a[240:243], v[184:187], v[240:243], a[240:243]
v_add_f32 v56, v20, v56
v_add_f32 v57, v20, v57
v_mfma_f32_16x16x32_bf16 a[248:251], v[184:187], v[244:247], a[248:251]
buffer_load_dwordx4 v[184:187], v5, s[8:11], s56 offen offset:3072 sc1
v_mfma_f32_16x16x32_bf16 a[228:231], v[188:191], v[208:211], a[228:231]
v_add_f32 v58, v20, v58
v_add_f32 v59, v20, v59
v_mfma_f32_16x16x32_bf16 a[236:239], v[188:191], v[212:215], a[236:239]
v_add_f32 v60, v20, v60
v_add_f32 v61, v20, v61
v_mfma_f32_16x16x32_bf16 a[244:247], v[188:191], v[240:243], a[244:247]
v_add_f32 v62, v20, v62
v_add_f32 v63, v20, v63
v_mfma_f32_16x16x32_bf16 a[252:255], v[188:191], v[244:247], a[252:255]
s_add_u32 s56, s54, 24576
buffer_load_dwordx4 v[188:191], v5, s[8:11], s56 offen offset:0 sc1
s_waitcnt vmcnt(17)
v_mfma_f32_16x16x32_bf16 a[224:227], v[132:135], v[216:219], a[224:227]
v_add_f32 v64, v20, v64
v_add_f32 v65, v20, v65
v_mfma_f32_16x16x32_bf16 a[232:235], v[132:135], v[220:223], a[232:235]
v_add_f32 v66, v20, v66
v_add_f32_e64 v67, v20, v67
v_mfma_f32_16x16x32_bf16 a[240:243], v[132:135], v[248:251], a[240:243]
v_mfma_f32_16x16x32_bf16 a[248:251], v[132:135], v[252:255], a[248:251]
buffer_load_dwordx4 v[132:135], v5, s[8:11], s56 offen offset:1024 sc1
v_mfma_f32_16x16x32_bf16 a[228:231], v[136:139], v[216:219], a[228:231]
v_mfma_f32_16x16x32_bf16 a[236:239], v[136:139], v[220:223], a[236:239]
v_mfma_f32_16x16x32_bf16 a[244:247], v[136:139], v[248:251], a[244:247]
v_mfma_f32_16x16x32_bf16 a[252:255], v[136:139], v[252:255], a[252:255]
buffer_load_dwordx4 v[136:139], v5, s[8:11], s56 offen offset:2048 sc1
v_cmp_ne_u32 vcc, s6, v4
s_cbranch_vccz Lks_fok51
s_mov_b32 s37, 0
Lks_poll52:
buffer_load_dword v3, v51, s[8:11], s34 offen sc1
s_add_u32 s37, s37, 1
s_cmp_gt_u32 s37, 131072
s_cbranch_scc1 Lks_pok53
s_waitcnt vmcnt(0)
v_cmp_ne_u32 vcc, s6, v3
s_cbranch_vccnz Lks_poll52
Lks_pok53:
s_waitcnt vmcnt(0)
Lks_fok51:
s_waitcnt lgkmcnt(0)
s_barrier
s_waitcnt vmcnt(17)
v_mfma_f32_16x16x32_bf16 a[224:227], v[140:143], a[0:3], a[224:227]
ds_read_b128 v[68:71], v14 offset:0
ds_read_b128 v[84:87], v14 offset:4096
v_mfma_f32_16x16x32_bf16 a[232:235], v[140:143], a[4:7], a[232:235]
ds_read_b128 v[100:103], v14 offset:8192
ds_read_b128 v[72:75], v14 offset:1024
v_mfma_f32_16x16x32_bf16 a[240:243], v[140:143], a[32:35], a[240:243]
ds_read_b128 v[88:91], v14 offset:5120
ds_read_b128 v[104:107], v14 offset:9216
v_mfma_f32_16x16x32_bf16 a[248:251], v[140:143], a[36:39], a[248:251]
buffer_load_dwordx4 v[140:143], v5, s[8:11], s56 offen offset:3072 sc1
v_mfma_f32_16x16x32_bf16 a[228:231], v[144:147], a[0:3], a[228:231]
ds_read_b128 v[76:79], v14 offset:2048
ds_read_b128 v[92:95], v14 offset:6144
v_mfma_f32_16x16x32_bf16 a[236:239], v[144:147], a[4:7], a[236:239]
ds_read_b128 v[108:111], v14 offset:10240
ds_read_b128 v[80:83], v14 offset:3072
v_mfma_f32_16x16x32_bf16 a[244:247], v[144:147], a[32:35], a[244:247]
ds_read_b128 v[96:99], v14 offset:7168
ds_read_b128 v[112:115], v14 offset:11264
v_mfma_f32_16x16x32_bf16 a[252:255], v[144:147], a[36:39], a[252:255]
s_add_u32 s56, s54, 28672
buffer_load_dwordx4 v[144:147], v5, s[8:11], s56 offen offset:0 sc1
s_waitcnt vmcnt(17)
v_mfma_f32_16x16x32_bf16 a[224:227], v[168:171], a[8:11], a[224:227]
v_lshlrev_b32 v36, 16, v24
v_and_b32 v37, 0xffff0000, v24
v_mfma_f32_16x16x32_bf16 a[232:235], v[168:171], a[12:15], a[232:235]
v_lshlrev_b32_e64 v38, 16, v25
v_and_b32 v39, 0xffff0000, v25
v_mfma_f32_16x16x32_bf16 a[240:243], v[168:171], a[40:43], a[240:243]
s_waitcnt lgkmcnt(9)
v_add_f32 v68, v68, v84
v_mfma_f32_16x16x32_bf16 a[248:251], v[168:171], a[44:47], a[248:251]
buffer_load_dwordx4 v[168:171], v5, s[8:11], s56 offen offset:1024 sc1
v_mfma_f32_16x16x32_bf16 a[228:231], v[172:175], a[8:11], a[228:231]
v_add_f32 v52, v52, v100
v_add_f32 v69, v69, v85
v_mfma_f32_16x16x32_bf16 a[236:239], v[172:175], a[12:15], a[236:239]
v_add_f32 v53, v53, v101
v_add_f32 v70, v70, v86
v_mfma_f32_16x16x32_bf16 a[244:247], v[172:175], a[40:43], a[244:247]
v_add_f32 v54, v54, v102
v_add_f32 v71, v71, v87
v_mfma_f32_16x16x32_bf16 a[252:255], v[172:175], a[44:47], a[252:255]
buffer_load_dwordx4 v[172:175], v5, s[8:11], s56 offen offset:2048 sc1
s_waitcnt vmcnt(17)
v_mfma_f32_16x16x32_bf16 a[224:227], v[116:119], a[16:19], a[224:227]
v_add_f32 v55, v55, v103
v_add_f32 v52, v52, v68
v_mfma_f32_16x16x32_bf16 a[232:235], v[116:119], a[20:23], a[232:235]
v_add_f32 v53, v53, v69
v_add_f32 v54, v54, v70
v_mfma_f32_16x16x32_bf16 a[240:243], v[116:119], a[48:51], a[240:243]
v_add_f32 v55, v55, v71
v_mul_f32_e64 v52, v52, v36
v_mfma_f32_16x16x32_bf16 a[248:251], v[116:119], a[52:55], a[248:251]
buffer_load_dwordx4 v[116:119], v5, s[8:11], s56 offen offset:3072 sc1
v_mfma_f32_16x16x32_bf16 a[228:231], v[120:123], a[16:19], a[228:231]
v_mul_f32 v53, v53, v37
v_mul_f32 v54, v54, v38
v_mfma_f32_16x16x32_bf16 a[236:239], v[120:123], a[20:23], a[236:239]
v_mul_f32_e64 v55, v55, v39
v_cvt_pk_bf16_f32 v52, v52, v53
v_mfma_f32_16x16x32_bf16 a[244:247], v[120:123], a[48:51], a[244:247]
v_cvt_pk_bf16_f32 v53, v54, v55
v_lshlrev_b32_e64 v36, 16, v26
s_add_u32 s27, s22, 0
s_add_u32 m0, s28, 0
v_mfma_f32_16x16x32_bf16 a[252:255], v[120:123], a[52:55], a[252:255]
buffer_load_dwordx4 v5, s[8:11], s27 offen offset:0 sc1 lds
s_waitcnt vmcnt(17)
v_mfma_f32_16x16x32_bf16 a[224:227], v[124:127], a[24:27], a[224:227]
v_and_b32 v37, 0xffff0000, v26
v_lshlrev_b32 v38, 16, v27
v_mfma_f32_16x16x32_bf16 a[232:235], v[124:127], a[28:31], a[232:235]
v_and_b32 v39, 0xffff0000, v27
s_waitcnt lgkmcnt(6)
v_mfma_f32_16x16x32_bf16 a[240:243], v[124:127], a[56:59], a[240:243]
v_add_f32 v72, v72, v88
v_add_f32_e64 v56, v56, v104
v_mfma_f32_16x16x32_bf16 a[248:251], v[124:127], a[60:63], a[248:251]
buffer_load_dwordx4 v5, s[8:11], s27 offen offset:1024 sc1 lds
v_mfma_f32_16x16x32_bf16 a[228:231], v[128:131], a[24:27], a[228:231]
v_add_f32 v73, v73, v89
v_add_f32 v57, v57, v105
v_mfma_f32_16x16x32_bf16 a[236:239], v[128:131], a[28:31], a[236:239]
v_add_f32 v74, v74, v90
v_add_f32 v58, v58, v106
v_mfma_f32_16x16x32_bf16 a[244:247], v[128:131], a[56:59], a[244:247]
v_add_f32 v75, v75, v91
v_add_f32 v59, v59, v107
v_mfma_f32_16x16x32_bf16 a[252:255], v[128:131], a[60:63], a[252:255]
buffer_load_dwordx4 v5, s[8:11], s27 offen offset:2048 sc1 lds
s_waitcnt vmcnt(17)
v_mfma_f32_16x16x32_bf16 a[224:227], v[148:151], a[80:83], a[224:227]
v_add_f32 v56, v56, v72
v_add_f32 v57, v57, v73
v_mfma_f32_16x16x32_bf16 a[232:235], v[148:151], a[84:87], a[232:235]
v_add_f32 v58, v58, v74
v_add_f32 v59, v59, v75
v_mfma_f32_16x16x32_bf16 a[240:243], v[148:151], a[160:163], a[240:243]
v_mul_f32 v56, v56, v36
v_mul_f32_e64 v57, v57, v37
v_mfma_f32_16x16x32_bf16 a[248:251], v[148:151], a[164:167], a[248:251]
buffer_load_dwordx4 v5, s[8:11], s27 offen offset:3072 sc1 lds
v_mfma_f32_16x16x32_bf16 a[228:231], v[152:155], a[80:83], a[228:231]
v_mul_f32 v58, v58, v38
v_mul_f32 v59, v59, v39
v_mfma_f32_16x16x32_bf16 a[236:239], v[152:155], a[84:87], a[236:239]
v_cvt_pk_bf16_f32 v54, v56, v57
v_cvt_pk_bf16_f32 v55, v58, v59
v_mfma_f32_16x16x32_bf16 a[244:247], v[152:155], a[160:163], a[244:247]
buffer_store_dwordx4 v[52:55], v5, s[8:11], s30 offen offset:0 sc1
v_lshlrev_b32_e64 v36, 16, v28
s_add_u32 s27, s22, 16384
s_add_u32 m0, s28, 16384
v_mfma_f32_16x16x32_bf16 a[252:255], v[152:155], a[164:167], a[252:255]
buffer_load_dwordx4 v5, s[8:11], s27 offen offset:0 sc1 lds
s_waitcnt vmcnt(18)
v_mfma_f32_16x16x32_bf16 a[224:227], v[156:159], a[88:91], a[224:227]
v_and_b32 v37, 0xffff0000, v28
v_lshlrev_b32 v38, 16, v29
v_mfma_f32_16x16x32_bf16 a[232:235], v[156:159], a[92:95], a[232:235]
v_and_b32 v39, 0xffff0000, v29
s_waitcnt lgkmcnt(3)
v_mfma_f32_16x16x32_bf16 a[240:243], v[156:159], a[168:171], a[240:243]
v_add_f32 v76, v76, v92
v_add_f32_e64 v60, v60, v108
v_mfma_f32_16x16x32_bf16 a[248:251], v[156:159], a[172:175], a[248:251]
buffer_load_dwordx4 v5, s[8:11], s27 offen offset:1024 sc1 lds
v_mfma_f32_16x16x32_bf16 a[228:231], v[160:163], a[88:91], a[228:231]
v_add_f32 v77, v77, v93
v_add_f32 v61, v61, v109
v_mfma_f32_16x16x32_bf16 a[236:239], v[160:163], a[92:95], a[236:239]
v_add_f32 v78, v78, v94
v_add_f32 v62, v62, v110
v_mfma_f32_16x16x32_bf16 a[244:247], v[160:163], a[168:171], a[244:247]
v_add_f32 v79, v79, v95
v_add_f32 v63, v63, v111
v_mfma_f32_16x16x32_bf16 a[252:255], v[160:163], a[172:175], a[252:255]
buffer_load_dwordx4 v5, s[8:11], s27 offen offset:2048 sc1 lds
s_waitcnt vmcnt(18)
v_mfma_f32_16x16x32_bf16 a[224:227], v[164:167], a[96:99], a[224:227]
v_add_f32 v60, v60, v76
v_add_f32 v61, v61, v77
v_mfma_f32_16x16x32_bf16 a[232:235], v[164:167], a[100:103], a[232:235]
v_add_f32 v62, v62, v78
v_add_f32 v63, v63, v79
v_mfma_f32_16x16x32_bf16 a[240:243], v[164:167], a[176:179], a[240:243]
v_mul_f32 v60, v60, v36
v_mul_f32_e64 v61, v61, v37
v_mfma_f32_16x16x32_bf16 a[248:251], v[164:167], a[180:183], a[248:251]
buffer_load_dwordx4 v5, s[8:11], s27 offen offset:3072 sc1 lds
v_mfma_f32_16x16x32_bf16 a[228:231], v[176:179], a[96:99], a[228:231]
v_mul_f32 v62, v62, v38
v_mul_f32 v63, v63, v39
v_mfma_f32_16x16x32_bf16 a[236:239], v[176:179], a[100:103], a[236:239]
v_cvt_pk_bf16_f32 v60, v60, v61
v_cvt_pk_bf16_f32 v61, v62, v63
v_mfma_f32_16x16x32_bf16 a[244:247], v[176:179], a[176:179], a[244:247]
v_lshlrev_b32_e64 v36, 16, v30
v_and_b32 v37, 0xffff0000, v30
s_add_u32 s27, s22, 32768
s_add_u32 m0, s28, 32768
v_mfma_f32_16x16x32_bf16 a[252:255], v[176:179], a[180:183], a[252:255]
buffer_load_dwordx4 v5, s[8:11], s27 offen offset:0 sc1 lds
s_waitcnt vmcnt(18)
v_mfma_f32_16x16x32_bf16 a[224:227], v[180:183], a[104:107], a[224:227]
v_lshlrev_b32 v38, 16, v31
v_and_b32 v39, 0xffff0000, v31
v_mfma_f32_16x16x32_bf16 a[232:235], v[180:183], a[108:111], a[232:235]
s_waitcnt lgkmcnt(0)
v_add_f32 v80, v80, v96
v_mfma_f32_16x16x32_bf16 a[240:243], v[180:183], a[184:187], a[240:243]
v_add_f32 v64, v64, v112
v_add_f32 v81, v81, v97
v_mfma_f32_16x16x32_bf16 a[248:251], v[180:183], a[188:191], a[248:251]
buffer_load_dwordx4 v5, s[8:11], s27 offen offset:1024 sc1 lds
v_mfma_f32_16x16x32_bf16 a[228:231], v[184:187], a[104:107], a[228:231]
v_add_f32 v65, v65, v113
v_add_f32 v82, v82, v98
v_mfma_f32_16x16x32_bf16 a[236:239], v[184:187], a[108:111], a[236:239]
v_add_f32 v66, v66, v114
v_add_f32 v83, v83, v99
v_mfma_f32_16x16x32_bf16 a[244:247], v[184:187], a[184:187], a[244:247]
v_add_f32 v67, v67, v115
v_add_f32 v64, v64, v80
v_mfma_f32_16x16x32_bf16 a[252:255], v[184:187], a[188:191], a[252:255]
buffer_load_dwordx4 v5, s[8:11], s27 offen offset:2048 sc1 lds
s_waitcnt vmcnt(18)
v_mfma_f32_16x16x32_bf16 a[224:227], v[188:191], a[112:115], a[224:227]
v_add_f32 v65, v65, v81
v_add_f32 v66, v66, v82
v_mfma_f32_16x16x32_bf16 a[232:235], v[188:191], a[116:119], a[232:235]
v_add_f32 v67, v67, v83
v_mul_f32 v64, v64, v36
v_mfma_f32_16x16x32_bf16 a[240:243], v[188:191], a[192:195], a[240:243]
v_mul_f32 v65, v65, v37
v_mul_f32_e64 v66, v66, v38
v_mfma_f32_16x16x32_bf16 a[248:251], v[188:191], a[196:199], a[248:251]
buffer_load_dwordx4 v5, s[8:11], s27 offen offset:3072 sc1 lds
v_mfma_f32_16x16x32_bf16 a[228:231], v[132:135], a[112:115], a[228:231]
v_mul_f32_e64 v67, v67, v39
v_cvt_pk_bf16_f32 v62, v64, v65
v_mfma_f32_16x16x32_bf16 a[236:239], v[132:135], a[116:119], a[236:239]
v_cvt_pk_bf16_f32 v63, v66, v67
buffer_store_dwordx4 v[60:63], v5, s[8:11], s30 offen offset:1024 sc1
v_mfma_f32_16x16x32_bf16 a[244:247], v[132:135], a[192:195], a[244:247]
s_add_u32 s27, s22, 49152
s_add_u32 m0, s28, 49152
v_mfma_f32_16x16x32_bf16 a[252:255], v[132:135], a[196:199], a[252:255]
buffer_load_dwordx4 v5, s[8:11], s27 offen offset:0 sc1 lds
s_waitcnt vmcnt(19)
v_mfma_f32_16x16x32_bf16 a[224:227], v[136:139], a[120:123], a[224:227]
v_mfma_f32_16x16x32_bf16 a[232:235], v[136:139], a[124:127], a[232:235]
v_mfma_f32_16x16x32_bf16 a[240:243], v[136:139], a[200:203], a[240:243]
v_mfma_f32_16x16x32_bf16 a[248:251], v[136:139], a[204:207], a[248:251]
buffer_load_dwordx4 v5, s[8:11], s27 offen offset:1024 sc1 lds
v_mfma_f32_16x16x32_bf16 a[228:231], v[140:143], a[120:123], a[228:231]
v_mfma_f32_16x16x32_bf16 a[236:239], v[140:143], a[124:127], a[236:239]
v_mfma_f32_16x16x32_bf16 a[244:247], v[140:143], a[200:203], a[244:247]
v_mfma_f32_16x16x32_bf16 a[252:255], v[140:143], a[204:207], a[252:255]
buffer_load_dwordx4 v5, s[8:11], s27 offen offset:2048 sc1 lds
s_barrier
s_waitcnt vmcnt(19)
v_mfma_f32_16x16x32_bf16 a[224:227], v[144:147], a[128:131], a[224:227]
v_mfma_f32_16x16x32_bf16 a[232:235], v[144:147], a[132:135], a[232:235]
v_mfma_f32_16x16x32_bf16 a[240:243], v[144:147], a[208:211], a[240:243]
v_mfma_f32_16x16x32_bf16 a[248:251], v[144:147], a[212:215], a[248:251]
buffer_load_dwordx4 v5, s[8:11], s27 offen offset:3072 sc1 lds
v_mfma_f32_16x16x32_bf16 a[228:231], v[168:171], a[128:131], a[228:231]
v_mfma_f32_16x16x32_bf16 a[236:239], v[168:171], a[132:135], a[236:239]
v_mfma_f32_16x16x32_bf16 a[244:247], v[168:171], a[208:211], a[244:247]
s_add_u32 s27, s22, 65536
s_add_u32 m0, s28, 65536
v_mfma_f32_16x16x32_bf16 a[252:255], v[168:171], a[212:215], a[252:255]
buffer_load_dwordx4 v5, s[8:11], s27 offen offset:0 sc1 lds
s_waitcnt vmcnt(19)
v_mfma_f32_16x16x32_bf16 a[224:227], v[172:175], a[136:139], a[224:227]
v_mfma_f32_16x16x32_bf16 a[232:235], v[172:175], a[140:143], a[232:235]
v_mfma_f32_16x16x32_bf16 a[240:243], v[172:175], a[216:219], a[240:243]
v_mfma_f32_16x16x32_bf16 a[248:251], v[172:175], a[220:223], a[248:251]
buffer_load_dwordx4 v5, s[8:11], s27 offen offset:1024 sc1 lds
v_mfma_f32_16x16x32_bf16 a[228:231], v[116:119], a[136:139], a[228:231]
v_mfma_f32_16x16x32_bf16 a[236:239], v[116:119], a[140:143], a[236:239]
v_mfma_f32_16x16x32_bf16 a[244:247], v[116:119], a[216:219], a[244:247]
v_mfma_f32_16x16x32_bf16 a[252:255], v[116:119], a[220:223], a[252:255]
buffer_load_dwordx4 v5, s[8:11], s27 offen offset:2048 sc1 lds
ds_write_b128 v16, a[232:235] offset:0
s_nop 3
s_nop 0
ds_write_b128 v16, a[236:239] offset:1024
ds_write_b128 v17, a[240:243] offset:0
ds_write_b128 v17, a[244:247] offset:1024
ds_write_b128 v18, a[248:251] offset:0
ds_write_b128 v18, a[252:255] offset:1024
v_accvgpr_read_b32 v84, a224
v_accvgpr_read_b32 v85, a225
v_accvgpr_read_b32 v86, a226
v_accvgpr_read_b32 v87, a227
v_accvgpr_read_b32 v88, a228
v_accvgpr_read_b32 v89, a229
v_accvgpr_read_b32 v90, a230
v_accvgpr_read_b32 v91, a231
buffer_load_dwordx4 v[52:55], v5, s[8:11], s32 offen offset:0 sc1
buffer_load_dwordx4 v[56:59], v5, s[8:11], s32 offen offset:1024 sc1
buffer_load_dwordx4 v[60:63], v5, s[8:11], s32 offen offset:2048 sc1
buffer_load_dwordx4 v[64:67], v5, s[8:11], s32 offen offset:3072 sc1
s_add_u32 s32, s32, 4096
buffer_load_dwordx4 v[68:71], v5, s[8:11], s32 offen offset:0 sc1
buffer_load_dwordx4 v[72:75], v5, s[8:11], s32 offen offset:1024 sc1
buffer_load_dwordx4 v[76:79], v5, s[8:11], s32 offen offset:2048 sc1
buffer_load_dwordx4 v[80:83], v5, s[8:11], s32 offen offset:3072 sc1
s_waitcnt vmcnt(16)
s_waitcnt lgkmcnt(0)
s_barrier
s_nop 0
ds_read_b128 v[92:95], v15 offset:0
ds_read_b128 v[100:103], v15 offset:2048
ds_read_b128 v[108:111], v15 offset:4096
ds_read_b128 v[96:99], v15 offset:1024
ds_read_b128 v[104:107], v15 offset:3072
ds_read_b128 v[112:115], v15 offset:5120
buffer_load_dwordx4 v5, s[8:11], s27 offen offset:3072 sc1 lds
v_lshlrev_b32_e64 v36, 16, v32
v_and_b32 v37, 0xffff0000, v32
v_pk_add_f32 v[84:85], v[84:85], v[20:21] op_sel_hi:[1,0]
v_lshlrev_b32_e64 v38, 16, v33
v_and_b32 v39, 0xffff0000, v33
v_pk_add_f32 v[86:87], v[86:87], v[20:21] op_sel_hi:[1,0]
s_waitcnt lgkmcnt(3)
s_add_u32 s27, s22, 81920
s_add_u32 m0, s28, 81920
s_nop 0
buffer_load_dwordx4 v5, s[8:11], s27 offen offset:0 sc1 lds
v_pk_add_f32 v[92:93], v[92:93], v[100:101]
v_pk_add_f32 v[84:85], v[84:85], v[108:109]
v_pk_add_f32 v[94:95], v[94:95], v[102:103]
v_pk_add_f32 v[86:87], v[86:87], v[110:111]
v_pk_add_f32 v[84:85], v[84:85], v[92:93]
v_pk_mul_f32 v[84:85], v[84:85], v[36:37]
v_pk_add_f32 v[86:87], v[86:87], v[94:95]
v_pk_mul_f32 v[86:87], v[86:87], v[38:39]
v_cvt_pk_bf16_f32 v84, v84, v85
v_cvt_pk_bf16_f32 v85, v86, v87
buffer_load_dwordx4 v5, s[8:11], s27 offen offset:1024 sc1 lds
buffer_load_dwordx4 v5, s[8:11], s27 offen offset:2048 sc1 lds
v_lshlrev_b32_e64 v36, 16, v34
v_and_b32 v37, 0xffff0000, v34
v_pk_add_f32 v[88:89], v[88:89], v[20:21] op_sel_hi:[1,0]
v_lshlrev_b32_e64 v38, 16, v35
v_and_b32 v39, 0xffff0000, v35
v_pk_add_f32 v[90:91], v[90:91], v[20:21] op_sel_hi:[1,0]
s_waitcnt lgkmcnt(0)
s_nop 0
buffer_load_dwordx4 v5, s[8:11], s27 offen offset:3072 sc1 lds
v_pk_add_f32 v[96:97], v[96:97], v[104:105]
v_pk_add_f32 v[88:89], v[88:89], v[112:113]
v_pk_add_f32 v[98:99], v[98:99], v[106:107]
v_pk_add_f32 v[90:91], v[90:91], v[114:115]
v_pk_add_f32 v[88:89], v[88:89], v[96:97]
v_pk_mul_f32 v[88:89], v[88:89], v[36:37]
v_pk_add_f32 v[90:91], v[90:91], v[98:99]
v_pk_mul_f32 v[90:91], v[90:91], v[38:39]
v_cvt_pk_bf16_f32 v86, v88, v89
v_cvt_pk_bf16_f32 v87, v90, v91
s_add_u32 s27, s22, 98304
s_add_u32 m0, s28, 98304
s_nop 0
s_nop 0
buffer_load_dwordx4 v5, s[8:11], s27 offen offset:0 sc1 lds
buffer_store_dwordx4 v[84:87], v5, s[8:11], s29 offen sc1
s_add_u32 s32, s32, 4096
buffer_load_dwordx4 v[192:195], v5, s[8:11], s32 offen offset:0 sc1
buffer_load_dwordx4 v[196:199], v5, s[8:11], s32 offen offset:1024 sc1
s_mul_i32 s33, s23, 20480
s_mul_i32 s34, s18, 160
s_add_u32 s33, s33, s34
v_mul_u32_u24 v9, 1280, v7
v_lshl_add_u32 v10, v8, 3, v9
v_and_b32 v3, 1, v8
v_lshl_add_u32 v9, v3, 5, v9
v_lshrrev_b32 v3, 1, v8
v_lshl_add_u32 v9, v3, 4, v9
v_lshlrev_b32 v232, 16, v40
v_and_b32 v233, 0xffff0000, v40
v_lshlrev_b32 v234, 16, v41
v_and_b32 v235, 0xffff0000, v41
v_lshlrev_b32 v236, 16, v42
v_and_b32 v237, 0xffff0000, v42
v_lshlrev_b32 v238, 16, v43
v_and_b32 v239, 0xffff0000, v43
v_lshlrev_b32 v240, 16, v44
v_and_b32 v241, 0xffff0000, v44
v_lshlrev_b32 v242, 16, v45
v_and_b32 v243, 0xffff0000, v45
v_lshlrev_b32 v244, 16, v46
v_and_b32 v245, 0xffff0000, v46
v_lshlrev_b32 v246, 16, v47
v_and_b32 v247, 0xffff0000, v47
v_lshlrev_b32 v248, 16, v48
v_and_b32 v249, 0xffff0000, v48
v_lshlrev_b32_e64 v250, 16, v49
v_and_b32 v251, 0xffff0000, v49
ds_read_b128 a[0:3], v5 offset:0
ds_read_b128 a[4:7], v5 offset:1024
ds_read_b128 a[8:11], v5 offset:2048
ds_read_b128 a[12:15], v5 offset:3072
ds_read_b128 a[16:19], v5 offset:4096
ds_read_b128 a[20:23], v5 offset:5120
ds_read_b128 a[24:27], v5 offset:6144
ds_read_b128 a[28:31], v5 offset:7168
ds_read_b128 a[32:35], v5 offset:8192
ds_read_b128 a[36:39], v5 offset:9216
s_waitcnt vmcnt(9)
s_mov_b32 s37, 0
Lks_p2r54:
v_max3_u32 v2, v52, v53, v54
v_max3_u32 v3, v55, v56, v57
v_max3_u32 v3, v3, v58, v59
v_max3_u32 v2, v2, v60, v61
v_max3_u32 v3, v3, v62, v63
v_max3_u32 v2, v2, v64, v65
v_max3_u32 v3, v3, v66, v67
v_max3_u32 v2, v2, v68, v69
v_max3_u32 v3, v3, v70, v71
v_max3_u32 v2, v2, v72, v73
v_max3_u32 v3, v3, v74, v75
v_max3_u32 v2, v2, v76, v77
v_max3_u32 v3, v3, v78, v79
v_max3_u32 v2, v2, v80, v81
v_max3_u32 v3, v3, v82, v83
v_max_u32 v2, v2, v3
v_cmp_eq_u32 vcc, -1, v2
s_cbranch_vccz Lks_p2o55
s_add_u32 s37, s37, 1
s_cmp_gt_u32 s37, 16384
s_cbranch_scc1 Lks_p2o55
s_add_u32 s36, s24, 0
buffer_load_dwordx4 v[52:55], v5, s[8:11], s36 offen offset:0 sc1
buffer_load_dwordx4 v[56:59], v5, s[8:11], s36 offen offset:1024 sc1
buffer_load_dwordx4 v[60:63], v5, s[8:11], s36 offen offset:2048 sc1
buffer_load_dwordx4 v[64:67], v5, s[8:11], s36 offen offset:3072 sc1
s_add_u32 s36, s24, 4096
buffer_load_dwordx4 v[68:71], v5, s[8:11], s36 offen offset:0 sc1
buffer_load_dwordx4 v[72:75], v5, s[8:11], s36 offen offset:1024 sc1
buffer_load_dwordx4 v[76:79], v5, s[8:11], s36 offen offset:2048 sc1
buffer_load_dwordx4 v[80:83], v5, s[8:11], s36 offen offset:3072 sc1
s_waitcnt vmcnt(0)
s_branch Lks_p2r54
Lks_p2o55:
s_waitcnt lgkmcnt(5)
v_mfma_f32_16x16x32_bf16 v[232:235], a[0:3], v[52:55], v[232:235]
buffer_load_dwordx4 v[200:203], v5, s[8:11], s32 offen offset:2048 sc1
ds_read_b128 a[40:43], v5 offset:10240
v_mfma_f32_16x16x32_bf16 v[236:239], a[4:7], v[52:55], v[236:239]
ds_read_b128 a[44:47], v5 offset:11264
v_mfma_f32_16x16x32_bf16 v[240:243], a[8:11], v[52:55], v[240:243]
ds_read_b128 a[48:51], v5 offset:12288
v_mfma_f32_16x16x32_bf16 v[244:247], a[12:15], v[52:55], v[244:247]
buffer_load_dwordx4 v[204:207], v5, s[8:11], s32 offen offset:3072 sc1
ds_read_b128 a[52:55], v5 offset:13312
v_mfma_f32_16x16x32_bf16 v[248:251], a[16:19], v[52:55], v[248:251]
ds_read_b128 a[56:59], v5 offset:14336
s_waitcnt lgkmcnt(5)
v_mfma_f32_16x16x32_bf16 v[232:235], a[20:23], v[56:59], v[232:235]
s_add_u32 s32, s32, 4096
buffer_load_dwordx4 v[208:211], v5, s[8:11], s32 offen offset:0 sc1
ds_read_b128 a[0:3], v5 offset:15360
v_mfma_f32_16x16x32_bf16 v[236:239], a[24:27], v[56:59], v[236:239]
ds_read_b128 a[4:7], v5 offset:16384
v_mfma_f32_16x16x32_bf16 v[240:243], a[28:31], v[56:59], v[240:243]
ds_read_b128 a[8:11], v5 offset:17408
v_mfma_f32_16x16x32_bf16 v[244:247], a[32:35], v[56:59], v[244:247]
buffer_load_dwordx4 v[212:215], v5, s[8:11], s32 offen offset:1024 sc1
ds_read_b128 a[12:15], v5 offset:18432
v_mfma_f32_16x16x32_bf16 v[248:251], a[36:39], v[56:59], v[248:251]
ds_read_b128 a[16:19], v5 offset:19456
s_waitcnt lgkmcnt(5)
v_mfma_f32_16x16x32_bf16 v[232:235], a[40:43], v[60:63], v[232:235]
buffer_load_dwordx4 v[216:219], v5, s[8:11], s32 offen offset:2048 sc1
ds_read_b128 a[20:23], v5 offset:20480
v_mfma_f32_16x16x32_bf16 v[236:239], a[44:47], v[60:63], v[236:239]
ds_read_b128 a[24:27], v5 offset:21504
v_mfma_f32_16x16x32_bf16 v[240:243], a[48:51], v[60:63], v[240:243]
ds_read_b128 a[28:31], v5 offset:22528
v_mfma_f32_16x16x32_bf16 v[244:247], a[52:55], v[60:63], v[244:247]
buffer_load_dwordx4 v[220:223], v5, s[8:11], s32 offen offset:3072 sc1
ds_read_b128 a[32:35], v5 offset:23552
v_mfma_f32_16x16x32_bf16 v[248:251], a[56:59], v[60:63], v[248:251]
ds_read_b128 a[36:39], v5 offset:24576
s_waitcnt lgkmcnt(5)
v_mfma_f32_16x16x32_bf16 v[232:235], a[0:3], v[64:67], v[232:235]
buffer_load_dwordx4 v5, s[8:11], s27 offen offset:1024 sc1 lds
ds_read_b128 a[40:43], v5 offset:25600
v_mfma_f32_16x16x32_bf16 v[236:239], a[4:7], v[64:67], v[236:239]
ds_read_b128 a[44:47], v5 offset:26624
v_mfma_f32_16x16x32_bf16 v[240:243], a[8:11], v[64:67], v[240:243]
ds_read_b128 a[48:51], v5 offset:27648
v_mfma_f32_16x16x32_bf16 v[244:247], a[12:15], v[64:67], v[244:247]
buffer_load_dwordx4 v5, s[8:11], s27 offen offset:2048 sc1 lds
ds_read_b128 a[52:55], v5 offset:28672
v_mfma_f32_16x16x32_bf16 v[248:251], a[16:19], v[64:67], v[248:251]
ds_read_b128 a[56:59], v5 offset:29696
s_waitcnt lgkmcnt(5)
v_mfma_f32_16x16x32_bf16 v[232:235], a[20:23], v[68:71], v[232:235]
buffer_load_dwordx4 v5, s[8:11], s27 offen offset:3072 sc1 lds
ds_read_b128 a[0:3], v5 offset:30720
v_mfma_f32_16x16x32_bf16 v[236:239], a[24:27], v[68:71], v[236:239]
ds_read_b128 a[4:7], v5 offset:31744
v_mfma_f32_16x16x32_bf16 v[240:243], a[28:31], v[68:71], v[240:243]
ds_read_b128 a[8:11], v5 offset:32768
s_add_u32 s27, s26, 114688
s_add_u32 m0, s25, 114688
v_mfma_f32_16x16x32_bf16 v[244:247], a[32:35], v[68:71], v[244:247]
buffer_load_dwordx4 v5, s[8:11], s27 offen offset:0 sc1 lds
ds_read_b128 a[12:15], v5 offset:33792
v_mfma_f32_16x16x32_bf16 v[248:251], a[36:39], v[68:71], v[248:251]
ds_read_b128 a[16:19], v5 offset:34816
s_waitcnt vmcnt(18)
s_barrier
s_waitcnt lgkmcnt(5)
v_mfma_f32_16x16x32_bf16 v[232:235], a[40:43], v[72:75], v[232:235]
buffer_load_dwordx4 v5, s[8:11], s27 offen offset:1024 sc1 lds
ds_read_b128 a[20:23], v5 offset:35840
v_mfma_f32_16x16x32_bf16 v[236:239], a[44:47], v[72:75], v[236:239]
ds_read_b128 a[24:27], v5 offset:36864
v_mfma_f32_16x16x32_bf16 v[240:243], a[48:51], v[72:75], v[240:243]
ds_read_b128 a[28:31], v5 offset:37888
v_mfma_f32_16x16x32_bf16 v[244:247], a[52:55], v[72:75], v[244:247]
ds_read_b128 a[32:35], v5 offset:38912
v_mfma_f32_16x16x32_bf16 v[248:251], a[56:59], v[72:75], v[248:251]
ds_read_b128 a[36:39], v5 offset:39936
s_waitcnt lgkmcnt(5)
v_mfma_f32_16x16x32_bf16 v[232:235], a[0:3], v[76:79], v[232:235]
ds_read_b128 a[40:43], v5 offset:40960
v_mfma_f32_16x16x32_bf16 v[236:239], a[4:7], v[76:79], v[236:239]
ds_read_b128 a[44:47], v5 offset:41984
v_mfma_f32_16x16x32_bf16 v[240:243], a[8:11], v[76:79], v[240:243]
ds_read_b128 a[48:51], v5 offset:43008
v_mfma_f32_16x16x32_bf16 v[244:247], a[12:15], v[76:79], v[244:247]
ds_read_b128 a[52:55], v5 offset:44032
v_mfma_f32_16x16x32_bf16 v[248:251], a[16:19], v[76:79], v[248:251]
ds_read_b128 a[56:59], v5 offset:45056
s_waitcnt lgkmcnt(5)
v_mfma_f32_16x16x32_bf16 v[232:235], a[20:23], v[80:83], v[232:235]
ds_read_b128 a[0:3], v5 offset:46080
v_mfma_f32_16x16x32_bf16 v[236:239], a[24:27], v[80:83], v[236:239]
ds_read_b128 a[4:7], v5 offset:47104
v_mfma_f32_16x16x32_bf16 v[240:243], a[28:31], v[80:83], v[240:243]
ds_read_b128 a[8:11], v5 offset:48128
v_mfma_f32_16x16x32_bf16 v[244:247], a[32:35], v[80:83], v[244:247]
ds_read_b128 a[12:15], v5 offset:49152
v_mfma_f32_16x16x32_bf16 v[248:251], a[36:39], v[80:83], v[248:251]
ds_read_b128 a[16:19], v5 offset:50176
s_waitcnt vmcnt(5)
s_mov_b32 s37, 0
Lks_p2r56:
v_max3_u32 v2, v192, v193, v194
v_max3_u32 v3, v195, v196, v197
v_max3_u32 v3, v3, v198, v199
v_max3_u32 v2, v2, v200, v201
v_max3_u32 v3, v3, v202, v203
v_max3_u32 v2, v2, v204, v205
v_max3_u32 v3, v3, v206, v207
v_max3_u32 v2, v2, v208, v209
v_max3_u32 v3, v3, v210, v211
v_max3_u32 v2, v2, v212, v213
v_max3_u32 v3, v3, v214, v215
v_max3_u32 v2, v2, v216, v217
v_max3_u32 v3, v3, v218, v219
v_max3_u32 v2, v2, v220, v221
v_max3_u32 v3, v3, v222, v223
v_max_u32 v2, v2, v3
v_cmp_eq_u32 vcc, -1, v2
s_cbranch_vccz Lks_p2o57
s_add_u32 s37, s37, 1
s_cmp_gt_u32 s37, 16384
s_cbranch_scc1 Lks_p2o57
s_nop 0
s_add_u32 s36, s24, 8192
buffer_load_dwordx4 v[192:195], v5, s[8:11], s36 offen offset:0 sc1
buffer_load_dwordx4 v[196:199], v5, s[8:11], s36 offen offset:1024 sc1
buffer_load_dwordx4 v[200:203], v5, s[8:11], s36 offen offset:2048 sc1
buffer_load_dwordx4 v[204:207], v5, s[8:11], s36 offen offset:3072 sc1
s_add_u32 s36, s24, 12288
buffer_load_dwordx4 v[208:211], v5, s[8:11], s36 offen offset:0 sc1
buffer_load_dwordx4 v[212:215], v5, s[8:11], s36 offen offset:1024 sc1
buffer_load_dwordx4 v[216:219], v5, s[8:11], s36 offen offset:2048 sc1
buffer_load_dwordx4 v[220:223], v5, s[8:11], s36 offen offset:3072 sc1
s_waitcnt vmcnt(0)
s_branch Lks_p2r56
Lks_p2o57:
s_waitcnt lgkmcnt(5)
v_mfma_f32_16x16x32_bf16 v[232:235], a[40:43], v[192:195], v[232:235]
ds_read_b128 a[20:23], v5 offset:51200
v_mfma_f32_16x16x32_bf16 v[236:239], a[44:47], v[192:195], v[236:239]
ds_read_b128 a[24:27], v5 offset:52224
v_mfma_f32_16x16x32_bf16 v[240:243], a[48:51], v[192:195], v[240:243]
ds_read_b128 a[28:31], v5 offset:53248
v_mfma_f32_16x16x32_bf16 v[244:247], a[52:55], v[192:195], v[244:247]
ds_read_b128 a[32:35], v5 offset:54272
v_mfma_f32_16x16x32_bf16 v[248:251], a[56:59], v[192:195], v[248:251]
ds_read_b128 a[36:39], v5 offset:55296
s_waitcnt lgkmcnt(5)
v_mfma_f32_16x16x32_bf16 v[232:235], a[0:3], v[196:199], v[232:235]
ds_read_b128 a[40:43], v5 offset:56320
v_mfma_f32_16x16x32_bf16 v[236:239], a[4:7], v[196:199], v[236:239]
ds_read_b128 a[44:47], v5 offset:57344
v_mfma_f32_16x16x32_bf16 v[240:243], a[8:11], v[196:199], v[240:243]
ds_read_b128 a[48:51], v5 offset:58368
v_mfma_f32_16x16x32_bf16 v[244:247], a[12:15], v[196:199], v[244:247]
ds_read_b128 a[52:55], v5 offset:59392
v_mfma_f32_16x16x32_bf16 v[248:251], a[16:19], v[196:199], v[248:251]
ds_read_b128 a[56:59], v5 offset:60416
s_waitcnt lgkmcnt(5)
v_mfma_f32_16x16x32_bf16 v[232:235], a[20:23], v[200:203], v[232:235]
s_add_u32 s32, s32, 4096
buffer_load_dwordx4 v[224:227], v5, s[8:11], s32 offen offset:0 sc1
ds_read_b128 a[0:3], v6 offset:0
v_mfma_f32_16x16x32_bf16 v[236:239], a[24:27], v[200:203], v[236:239]
buffer_load_dwordx4 v[228:231], v5, s[8:11], s32 offen offset:1024 sc1
ds_read_b128 a[4:7], v6 offset:1024
v_mfma_f32_16x16x32_bf16 v[240:243], a[28:31], v[200:203], v[240:243]
ds_read_b128 a[8:11], v6 offset:2048
v_mfma_f32_16x16x32_bf16 v[244:247], a[32:35], v[200:203], v[244:247]
buffer_load_dwordx4 v[116:119], v5, s[8:11], s32 offen offset:2048 sc1
ds_read_b128 a[12:15], v6 offset:3072
v_mfma_f32_16x16x32_bf16 v[248:251], a[36:39], v[200:203], v[248:251]
ds_read_b128 a[16:19], v6 offset:4096
s_waitcnt lgkmcnt(5)
v_mfma_f32_16x16x32_bf16 v[232:235], a[40:43], v[204:207], v[232:235]
buffer_load_dwordx4 v[120:123], v5, s[8:11], s32 offen offset:3072 sc1
ds_read_b128 a[20:23], v6 offset:5120
v_mfma_f32_16x16x32_bf16 v[236:239], a[44:47], v[204:207], v[236:239]
s_add_u32 s32, s32, 4096
buffer_load_dwordx4 v[124:127], v5, s[8:11], s32 offen offset:0 sc1
ds_read_b128 a[24:27], v6 offset:6144
v_mfma_f32_16x16x32_bf16 v[240:243], a[48:51], v[204:207], v[240:243]
ds_read_b128 a[28:31], v6 offset:7168
v_mfma_f32_16x16x32_bf16 v[244:247], a[52:55], v[204:207], v[244:247]
buffer_load_dwordx4 v[128:131], v5, s[8:11], s32 offen offset:1024 sc1
ds_read_b128 a[32:35], v6 offset:8192
v_mfma_f32_16x16x32_bf16 v[248:251], a[56:59], v[204:207], v[248:251]
ds_read_b128 a[36:39], v6 offset:9216
s_waitcnt lgkmcnt(5)
v_mfma_f32_16x16x32_bf16 v[232:235], a[0:3], v[208:211], v[232:235]
buffer_load_dwordx4 v[132:135], v5, s[8:11], s32 offen offset:2048 sc1
ds_read_b128 a[40:43], v6 offset:10240
v_mfma_f32_16x16x32_bf16 v[236:239], a[4:7], v[208:211], v[236:239]
buffer_load_dwordx4 v[136:139], v5, s[8:11], s32 offen offset:3072 sc1
ds_read_b128 a[44:47], v6 offset:11264
v_mfma_f32_16x16x32_bf16 v[240:243], a[8:11], v[208:211], v[240:243]
ds_read_b128 a[48:51], v6 offset:12288
v_mfma_f32_16x16x32_bf16 v[244:247], a[12:15], v[208:211], v[244:247]
ds_read_b128 a[52:55], v6 offset:13312
v_mfma_f32_16x16x32_bf16 v[248:251], a[16:19], v[208:211], v[248:251]
ds_read_b128 a[56:59], v6 offset:14336
s_waitcnt vmcnt(8)
s_barrier
s_waitcnt lgkmcnt(5)
v_mfma_f32_16x16x32_bf16 v[232:235], a[20:23], v[212:215], v[232:235]
ds_read_b128 a[0:3], v6 offset:15360
v_mfma_f32_16x16x32_bf16 v[236:239], a[24:27], v[212:215], v[236:239]
ds_read_b128 a[4:7], v6 offset:16384
v_mfma_f32_16x16x32_bf16 v[240:243], a[28:31], v[212:215], v[240:243]
ds_read_b128 a[8:11], v6 offset:17408
v_mfma_f32_16x16x32_bf16 v[244:247], a[32:35], v[212:215], v[244:247]
ds_read_b128 a[12:15], v6 offset:18432
v_mfma_f32_16x16x32_bf16 v[248:251], a[36:39], v[212:215], v[248:251]
ds_read_b128 a[16:19], v6 offset:19456
s_waitcnt lgkmcnt(5)
v_mfma_f32_16x16x32_bf16 v[232:235], a[40:43], v[216:219], v[232:235]
ds_read_b128 a[20:23], v6 offset:20480
v_mfma_f32_16x16x32_bf16 v[236:239], a[44:47], v[216:219], v[236:239]
ds_read_b128 a[24:27], v6 offset:21504
v_mfma_f32_16x16x32_bf16 v[240:243], a[48:51], v[216:219], v[240:243]
ds_read_b128 a[28:31], v6 offset:22528
v_mfma_f32_16x16x32_bf16 v[244:247], a[52:55], v[216:219], v[244:247]
ds_read_b128 a[32:35], v6 offset:23552
v_mfma_f32_16x16x32_bf16 v[248:251], a[56:59], v[216:219], v[248:251]
ds_read_b128 a[36:39], v6 offset:24576
s_waitcnt lgkmcnt(5)
v_mfma_f32_16x16x32_bf16 v[232:235], a[0:3], v[220:223], v[232:235]
ds_read_b128 a[40:43], v6 offset:25600
v_mfma_f32_16x16x32_bf16 v[236:239], a[4:7], v[220:223], v[236:239]
ds_read_b128 a[44:47], v6 offset:26624
v_mfma_f32_16x16x32_bf16 v[240:243], a[8:11], v[220:223], v[240:243]
ds_read_b128 a[48:51], v6 offset:27648
v_mfma_f32_16x16x32_bf16 v[244:247], a[12:15], v[220:223], v[244:247]
ds_read_b128 a[52:55], v6 offset:28672
v_mfma_f32_16x16x32_bf16 v[248:251], a[16:19], v[220:223], v[248:251]
ds_read_b128 a[56:59], v6 offset:29696
s_waitcnt vmcnt(4)
s_mov_b32 s37, 0
Lks_p2r58:
v_max3_u32 v2, v224, v225, v226
v_max3_u32 v3, v227, v228, v229
v_max3_u32 v3, v3, v230, v231
v_max3_u32 v2, v2, v116, v117
v_max3_u32 v3, v3, v118, v119
v_max3_u32 v2, v2, v120, v121
v_max3_u32 v3, v3, v122, v123
v_max_u32 v2, v2, v3
v_cmp_eq_u32 vcc, -1, v2
s_cbranch_vccz Lks_p2o59
s_add_u32 s37, s37, 1
s_cmp_gt_u32 s37, 16384
s_cbranch_scc1 Lks_p2o59
s_nop 0
s_add_u32 s36, s24, 16384
buffer_load_dwordx4 v[224:227], v5, s[8:11], s36 offen offset:0 sc1
buffer_load_dwordx4 v[228:231], v5, s[8:11], s36 offen offset:1024 sc1
buffer_load_dwordx4 v[116:119], v5, s[8:11], s36 offen offset:2048 sc1
buffer_load_dwordx4 v[120:123], v5, s[8:11], s36 offen offset:3072 sc1
s_waitcnt vmcnt(0)
s_branch Lks_p2r58
Lks_p2o59:
s_waitcnt lgkmcnt(5)
v_mfma_f32_16x16x32_bf16 v[232:235], a[20:23], v[224:227], v[232:235]
ds_read_b128 a[0:3], v6 offset:30720
v_mfma_f32_16x16x32_bf16 v[236:239], a[24:27], v[224:227], v[236:239]
ds_read_b128 a[4:7], v6 offset:31744
v_mfma_f32_16x16x32_bf16 v[240:243], a[28:31], v[224:227], v[240:243]
ds_read_b128 a[8:11], v6 offset:32768
v_mfma_f32_16x16x32_bf16 v[244:247], a[32:35], v[224:227], v[244:247]
ds_read_b128 a[12:15], v6 offset:33792
v_mfma_f32_16x16x32_bf16 v[248:251], a[36:39], v[224:227], v[248:251]
ds_read_b128 a[16:19], v6 offset:34816
s_waitcnt lgkmcnt(5)
v_mfma_f32_16x16x32_bf16 v[232:235], a[40:43], v[228:231], v[232:235]
ds_read_b128 a[20:23], v6 offset:35840
v_mfma_f32_16x16x32_bf16 v[236:239], a[44:47], v[228:231], v[236:239]
ds_read_b128 a[24:27], v6 offset:36864
v_mfma_f32_16x16x32_bf16 v[240:243], a[48:51], v[228:231], v[240:243]
ds_read_b128 a[28:31], v6 offset:37888
v_mfma_f32_16x16x32_bf16 v[244:247], a[52:55], v[228:231], v[244:247]
ds_read_b128 a[32:35], v6 offset:38912
v_mfma_f32_16x16x32_bf16 v[248:251], a[56:59], v[228:231], v[248:251]
ds_read_b128 a[36:39], v6 offset:39936
s_waitcnt lgkmcnt(5)
v_mfma_f32_16x16x32_bf16 v[232:235], a[0:3], v[116:119], v[232:235]
ds_read_b128 a[40:43], v6 offset:40960
v_mfma_f32_16x16x32_bf16 v[236:239], a[4:7], v[116:119], v[236:239]
ds_read_b128 a[44:47], v6 offset:41984
v_mfma_f32_16x16x32_bf16 v[240:243], a[8:11], v[116:119], v[240:243]
ds_read_b128 a[48:51], v6 offset:43008
v_mfma_f32_16x16x32_bf16 v[244:247], a[12:15], v[116:119], v[244:247]
ds_read_b128 a[52:55], v6 offset:44032
v_mfma_f32_16x16x32_bf16 v[248:251], a[16:19], v[116:119], v[248:251]
ds_read_b128 a[56:59], v6 offset:45056
s_waitcnt lgkmcnt(5)
v_mfma_f32_16x16x32_bf16 v[232:235], a[20:23], v[120:123], v[232:235]
ds_read_b128 a[0:3], v6 offset:46080
v_mfma_f32_16x16x32_bf16 v[236:239], a[24:27], v[120:123], v[236:239]
ds_read_b128 a[4:7], v6 offset:47104
v_mfma_f32_16x16x32_bf16 v[240:243], a[28:31], v[120:123], v[240:243]
ds_read_b128 a[8:11], v6 offset:48128
v_mfma_f32_16x16x32_bf16 v[244:247], a[32:35], v[120:123], v[244:247]
ds_read_b128 a[12:15], v6 offset:49152
v_mfma_f32_16x16x32_bf16 v[248:251], a[36:39], v[120:123], v[248:251]
ds_read_b128 a[16:19], v6 offset:50176
s_waitcnt vmcnt(0)
s_mov_b32 s37, 0
Lks_p2r60:
v_max3_u32 v2, v124, v125, v126
v_max3_u32 v3, v127, v128, v129
v_max3_u32 v3, v3, v130, v131
v_max3_u32 v2, v2, v132, v133
v_max3_u32 v3, v3, v134, v135
v_max3_u32 v2, v2, v136, v137
v_max3_u32 v3, v3, v138, v139
v_max_u32 v2, v2, v3
v_cmp_eq_u32 vcc, -1, v2
s_cbranch_vccz Lks_p2o61
s_add_u32 s37, s37, 1
s_cmp_gt_u32 s37, 16384
s_cbranch_scc1 Lks_p2o61
s_nop 0
s_add_u32 s36, s24, 20480
buffer_load_dwordx4 v[124:127], v5, s[8:11], s36 offen offset:0 sc1
buffer_load_dwordx4 v[128:131], v5, s[8:11], s36 offen offset:1024 sc1
buffer_load_dwordx4 v[132:135], v5, s[8:11], s36 offen offset:2048 sc1
buffer_load_dwordx4 v[136:139], v5, s[8:11], s36 offen offset:3072 sc1
s_waitcnt vmcnt(0)
s_branch Lks_p2r60
Lks_p2o61:
s_waitcnt lgkmcnt(5)
v_mfma_f32_16x16x32_bf16 v[232:235], a[40:43], v[124:127], v[232:235]
ds_read_b128 a[20:23], v6 offset:51200
v_mfma_f32_16x16x32_bf16 v[236:239], a[44:47], v[124:127], v[236:239]
ds_read_b128 a[24:27], v6 offset:52224
v_mfma_f32_16x16x32_bf16 v[240:243], a[48:51], v[124:127], v[240:243]
ds_read_b128 a[28:31], v6 offset:53248
v_mfma_f32_16x16x32_bf16 v[244:247], a[52:55], v[124:127], v[244:247]
ds_read_b128 a[32:35], v6 offset:54272
v_mfma_f32_16x16x32_bf16 v[248:251], a[56:59], v[124:127], v[248:251]
ds_read_b128 a[36:39], v6 offset:55296
s_waitcnt lgkmcnt(5)
v_mfma_f32_16x16x32_bf16 v[232:235], a[0:3], v[128:131], v[232:235]
ds_read_b128 a[40:43], v6 offset:56320
v_mfma_f32_16x16x32_bf16 v[236:239], a[4:7], v[128:131], v[236:239]
ds_read_b128 a[44:47], v6 offset:57344
v_mfma_f32_16x16x32_bf16 v[240:243], a[8:11], v[128:131], v[240:243]
ds_read_b128 a[48:51], v6 offset:58368
v_mfma_f32_16x16x32_bf16 v[244:247], a[12:15], v[128:131], v[244:247]
ds_read_b128 a[52:55], v6 offset:59392
v_mfma_f32_16x16x32_bf16 v[248:251], a[16:19], v[128:131], v[248:251]
ds_read_b128 a[56:59], v6 offset:60416
s_waitcnt lgkmcnt(5)
v_mfma_f32_16x16x32_bf16 v[232:235], a[20:23], v[132:135], v[232:235]
s_waitcnt lgkmcnt(0)
v_mfma_f32_16x16x32_bf16 v[232:235], a[40:43], v[136:139], v[232:235]
v_mfma_f32_16x16x32_bf16 v[236:239], a[24:27], v[132:135], v[236:239]
v_mfma_f32_16x16x32_bf16 v[236:239], a[44:47], v[136:139], v[236:239]
v_mfma_f32_16x16x32_bf16 v[240:243], a[28:31], v[132:135], v[240:243]
s_nop 4
v_cvt_pk_bf16_f32 v232, v232, v233
v_cvt_pk_bf16_f32 v233, v234, v235
v_mfma_f32_16x16x32_bf16 v[240:243], a[48:51], v[136:139], v[240:243]
v_mfma_f32_16x16x32_bf16 v[244:247], a[32:35], v[132:135], v[244:247]
v_cvt_pk_bf16_f32 v234, v236, v237
v_cvt_pk_bf16_f32 v235, v238, v239
v_mfma_f32_16x16x32_bf16 v[244:247], a[52:55], v[136:139], v[244:247]
v_permlane16_swap_b32 v232, v234
v_permlane16_swap_b32 v233, v235
v_mfma_f32_16x16x32_bf16 v[248:251], a[36:39], v[132:135], v[248:251]
buffer_store_dwordx4 v[232:235], v9, s[40:43], s33 offen offset:0
v_cvt_pk_bf16_f32 v240, v240, v241
v_mfma_f32_16x16x32_bf16 v[248:251], a[56:59], v[136:139], v[248:251]
v_cvt_pk_bf16_f32 v241, v242, v243
s_nop 0
v_cvt_pk_bf16_f32 v242, v244, v245
v_cvt_pk_bf16_f32 v243, v246, v247
s_nop 0
v_permlane16_swap_b32 v240, v242
v_permlane16_swap_b32 v241, v243
buffer_store_dwordx4 v[240:243], v9, s[40:43], s33 offen offset:64
v_cvt_pk_bf16_f32 v248, v248, v249
v_cvt_pk_bf16_f32 v249, v250, v251
buffer_store_dwordx2 v[248:249], v10, s[40:43], s33 offen offset:128
s_endpgm
Lks_end:
s_endpgm
Lcode_end:
.section .rodata,"a"
.p2align 6
.amdhsa_kernel sequential_preLN__ssm_conv_s4d__mixer_gmlp__prompt_kernel
  .amdhsa_next_free_vgpr 512
  .amdhsa_next_free_sgpr 60
  .amdhsa_accum_offset 256
  .amdhsa_group_segment_fixed_size 0
  .amdhsa_kernarg_size 120
  .amdhsa_user_sgpr_count 2
  .amdhsa_user_sgpr_kernarg_segment_ptr 1
  .amdhsa_system_sgpr_workgroup_id_x 1
.end_amdhsa_kernel
```
